```python
import torch

def _softmax(x, axis=-1):
    return torch.softmax(x, dim=axis)
def _gelu(x):
    return torch.nn.functional.gelu(x, approximate="tanh")
def _silu(x):
    return torch.nn.functional.silu(x)
def _sigmoid(x):
    return torch.sigmoid(x)
def _layernorm(x, axis=-1, eps=1e-5):
    m = x.mean(dim=axis, keepdim=True)
    v = x.var(dim=axis, keepdim=True, unbiased=False)
    return (x - m) / torch.sqrt(v + eps)
def _scatter_add(tgt, idx, src, axis=0):
    return tgt.clone().index_add_(axis, idx, src)
def _segment_sum(src, seg, n):
    out = torch.zeros((n,) + src.shape[1:], dtype=src.dtype)
    return out.index_add_(0, seg, src)
def _pad(x, pw):
    flat = tuple(v for pair in reversed(pw) for v in pair)
    return torch.nn.functional.pad(x, flat)

kernel_name = 'interleave_layers__gqa_block_cached__mixer_token_mlp__decode'

def setup_inputs():

    _w = (lambda a: (lambda t: t.to(torch.bfloat16) if t.is_floating_point() else t)(torch.as_tensor(a)))
    def _A_setup():
        B, Sq, D = 8, 1, 448
        Hq, Hkv, Sk, Dh = 16, 8, 8192, 256
        assert Hq % Hkv == 0, (Hq, Hkv)
        return {
            "x": _w((lambda *s: torch.randn(*s, dtype=torch.bfloat16) * 0.05)(B, Sq, D)),
            "k_cache": _w((lambda *s: torch.randn(*s, dtype=torch.bfloat16) * 0.8)(B, Hkv, Sk, Dh)),
            "v_cache": _w((lambda *s: torch.randn(*s, dtype=torch.bfloat16) * 1.6)(B, Hkv, Sk, Dh)),
            "wq": _w((lambda *s: torch.randn(*s, dtype=torch.bfloat16) * 0.8)(D, Hq * Dh) * (D ** -0.5)),
            "wo": _w((lambda *s: torch.randn(*s, dtype=torch.bfloat16) * 1.6)(Hq * Dh, D) * ((Hq * Dh) ** -0.5)),
        }
    _A_in = _A_setup()

    def _B_setup():
        B, S, D, F = 8, 1, 448, 1792
        return {
            "x": _w((lambda *s: torch.randn(*s, dtype=torch.bfloat16) * 0.05)(B, S, D)),
            "w1": _w((lambda *s: torch.randn(*s, dtype=torch.bfloat16) * 0.8)(S, F) * (S ** -0.5)),
            "b1": _w((lambda *s: torch.randn(*s, dtype=torch.bfloat16) * 0.8)(F) * 0.02),
            "w2": _w((lambda *s: torch.randn(*s, dtype=torch.bfloat16) * 0.2)(F, S) * (F ** -0.5)),
            "b2": _w((lambda *s: torch.randn(*s, dtype=torch.bfloat16) * 0.2)(S) * 0.02),
        }
    _B_in = _B_setup()

    return {
        "A_x": _A_in["x"],
        "A_k_cache": _A_in["k_cache"],
        "A_v_cache": _A_in["v_cache"],
        "A_wq": _A_in["wq"],
        "A_wo": _A_in["wo"],
        "B_x": _B_in["x"],
        "B_w1": _B_in["w1"],
        "B_b1": _B_in["b1"],
        "B_w2": _B_in["w2"],
        "B_b2": _B_in["b2"],
    }

def reference(A_x, A_k_cache, A_v_cache, A_wq, A_wo, B_x, B_w1, B_b1, B_w2, B_b2):
    def _A_ref(x, k_cache, v_cache, wq, wo):
        B, Sq, D = x.shape
        Hq, Dh = 16, 256
        Hkv = k_cache.shape[1]
        rep = Hq // Hkv
        q = (lambda x, *d: x.permute(*d))((x @ wq).reshape(B, Sq, Hq, Dh), 0, 2, 1, 3)
        k = (lambda x, n, axis: torch.repeat_interleave(x, n, dim=axis))(k_cache, rep, axis=1)
        v = (lambda x, n, axis: torch.repeat_interleave(x, n, dim=axis))(v_cache, rep, axis=1)
        scores = torch.einsum("bhqd,bhkd->bhqk", q, k) * (Dh ** -0.5)
        p = _softmax(scores, axis=-1)
        o = torch.einsum("bhqk,bhkd->bhqd", p, v)
        return (lambda x, *d: x.permute(*d))(o, 0, 2, 1, 3).reshape(B, Sq, Hq * Dh) @ wo

    def _B_ref(x, w1, b1, w2, b2):
        B, S, D = x.shape
        h = _layernorm(x, axis=-1)
        u = torch.einsum("bsd,sf->bdf", h, w1) + b1
        u = _gelu(u)
        y = torch.einsum("bdf,fs->bds", u, w2) + b2
        return (lambda x, *d: x.permute(*d))(y, 0, 2, 1)

    x = A_x
    x = x + _A_ref(_layernorm(x, axis=-1), A_k_cache, A_v_cache, A_wq, A_wo)
    x = x + _B_ref(_layernorm(x, axis=-1), B_w1, B_b1, B_w2, B_b2)
    x = x + _A_ref(_layernorm(x, axis=-1), A_k_cache, A_v_cache, A_wq, A_wo)
    x = x + _B_ref(_layernorm(x, axis=-1), B_w1, B_b1, B_w2, B_b2)
    return x
```

```asm
; @launch grid=(256,1,1) block=(256,1,1) lds=163840
.amdgcn_target "amdgcn-amd-amdhsa--gfx950"
.text
.globl interleave_layers__gqa_block_cached__mixer_token_mlp__decode_kernel
.p2align 8
.type interleave_layers__gqa_block_cached__mixer_token_mlp__decode_kernel,@function
interleave_layers__gqa_block_cached__mixer_token_mlp__decode_kernel:
    s_cmp_ge_u32 s2, 256
    s_cbranch_scc1 L_end
    s_load_dwordx16 s[64:79], s[0:1], 0
    s_load_dwordx8 s[80:87], s[0:1], 64
    s_load_dwordx2 s[88:89], s[0:1], 96
    s_and_b32 s100, s2, 7
    s_lshr_b32 s101, s2, 3
    v_and_b32 v1, 63, v0
    v_lshrrev_b32 v48, 6, v0
    v_mov_b32 v63, 0
    v_readfirstlane_b32 s52, v48
    v_bfe_u32 v2, v1, 2, 2
    v_lshlrev_b32 v2, 9, v2
    v_lshrrev_b32 v48, 4, v1
    v_lshl_add_u32 v2, v48, 6, v2
    v_and_b32 v49, 3, v1
    v_lshl_add_u32 v2, v49, 4, v2
    v_lshlrev_b32 v3, 9, v48
    v_and_b32 v49, 15, v1
    v_lshl_add_u32 v3, v49, 4, v3
    s_lshr_b32 s3, s2, 3
    s_add_u32 s53, s2, s3
    s_and_b32 s53, s53, 7
    s_lshl_b32 s54, s3, 2
    s_sub_u32 s94, s2, 240
    s_lshr_b32 s95, s94, 1
    s_and_b32 s96, s94, 1
    s_lshl_b32 s96, s96, 2
    s_add_u32 s96, s96, 120
    s_cmp_ge_u32 s2, 240
    s_cselect_b32 s53, s95, s53
    s_cselect_b32 s54, s96, s54
    s_add_u32 s54, s54, s52
    s_lshl_b32 s95, s53, 22
    s_lshl_b32 s58, s54, 13
    s_add_u32 s58, s58, s95
    s_lshl_b32 s59, s54, 11
    s_add_u32 s59, s59, s95
    s_add_u32 s59, s59, 3932160
    s_lshl_b32 s90, s53, 15
    s_lshl_b32 s95, s3, 9
    s_add_u32 s90, s90, s95
    s_lshl_b32 s91, s53, 13
    s_lshl_b32 s95, s3, 7
    s_add_u32 s91, s91, s95
    s_add_u32 s91, s91, 0x500000
    s_lshl_b32 s92, s53, 10
    s_add_u32 s92, s92, 0x490000
    s_mov_b32 s55, 0x3db8aa3b
    s_mov_b32 s93, 400000
    s_mov_b32 s98, 0
    s_mov_b32 s99, -1
    v_and_b32 v48, 1, v1
    v_lshlrev_b32 v48, 4, v48
    v_mov_b32 v49, 0xffff
    v_lshlrev_b32 v48, v48, v49
    v_bfe_u32 v49, v1, 1, 2
    v_cmp_eq_u32 vcc, 0, v49
    s_nop 1
    v_cndmask_b32 v4, 0, v48, vcc
    v_cmp_eq_u32 vcc, 1, v49
    s_nop 1
    v_cndmask_b32 v5, 0, v48, vcc
    v_cmp_eq_u32 vcc, 2, v49
    s_nop 1
    v_cndmask_b32 v6, 0, v48, vcc
    v_cmp_eq_u32 vcc, 3, v49
    s_nop 1
    v_cndmask_b32 v7, 0, v48, vcc
    s_waitcnt lgkmcnt(0)
    s_mov_b32 s4, s66
    s_and_b32 s5, s67, 0xffff
    s_mov_b32 s6, 0x10000000
    s_mov_b32 s7, 0x00020000
    s_mov_b32 s8, s68
    s_and_b32 s9, s69, 0xffff
    s_mov_b32 s10, 0x10000000
    s_mov_b32 s11, 0x00020000
    s_mov_b32 s12, s88
    s_and_b32 s13, s89, 0xffff
    s_mov_b32 s14, 0x600000
    s_mov_b32 s15, 0x00020000
    s_mov_b32 s24, s64
    s_and_b32 s25, s65, 0xffff
    s_mov_b32 s26, 0x1c00
    s_mov_b32 s27, 0x00020000
    s_mov_b32 s16, s70
    s_and_b32 s17, s71, 0xffff
    s_mov_b32 s18, 0x380000
    s_mov_b32 s19, 0x00020000
    s_mov_b32 s20, s72
    s_and_b32 s21, s73, 0xffff
    s_mov_b32 s22, 0x380000
    s_mov_b32 s23, 0x00020000
    s_mov_b32 s36, s76
    s_and_b32 s37, s77, 0xffff
    s_mov_b32 s38, 0xe00
    s_mov_b32 s39, 0x00020000
    s_mov_b32 s40, s78
    s_and_b32 s41, s79, 0xffff
    s_mov_b32 s42, 0xe00
    s_mov_b32 s43, 0x00020000
    s_mov_b32 s44, s80
    s_and_b32 s45, s81, 0xffff
    s_mov_b32 s46, 0xe00
    s_mov_b32 s47, 0x00020000
    s_mov_b32 s48, s82
    s_and_b32 s49, s83, 0xffff
    s_mov_b32 s50, 0x2
    s_mov_b32 s51, 0x00020000
    s_mov_b32 s28, s84
    s_and_b32 s29, s85, 0xffff
    s_mov_b32 s30, 0x1c00
    s_mov_b32 s31, 0x00020000
    s_mov_b32 s32, s86
    s_and_b32 s33, s87, 0xffff
    s_mov_b32 s34, 0x100
    s_mov_b32 s35, 0x00020000
    s_cmp_ge_u32 s2, 240
    s_cbranch_scc1 L_service
    s_lshl_b32 s97, s2, 2
    s_add_u32 s97, s97, s52
    s_mul_i32 s97, s97, 0x9e3779b1
    s_lshr_b32 s94, s97, 17
    s_and_b32 s94, s94, 0x1800
    s_or_b32 s58, s58, s94
    s_lshr_b32 s95, s97, 30
    s_add_u32 s94, s95, 0
    s_and_b32 s94, s94, 3
    s_and_b32 s96, s94, 1
    s_lshl_b32 s96, s96, 13
    s_xor_b32 s96, s96, s58
    s_mul_i32 s94, s94, 983040
    s_add_u32 s84, s94, s96
    s_add_u32 s94, s95, 1
    s_and_b32 s94, s94, 3
    s_and_b32 s96, s94, 1
    s_lshl_b32 s96, s96, 13
    s_xor_b32 s96, s96, s58
    s_mul_i32 s94, s94, 983040
    s_add_u32 s85, s94, s96
    s_add_u32 s94, s95, 2
    s_and_b32 s94, s94, 3
    s_and_b32 s96, s94, 1
    s_lshl_b32 s96, s96, 13
    s_xor_b32 s96, s96, s58
    s_mul_i32 s94, s94, 983040
    s_add_u32 s86, s94, s96
    s_add_u32 s94, s95, 3
    s_and_b32 s94, s94, 3
    s_and_b32 s96, s94, 1
    s_lshl_b32 s96, s96, 13
    s_xor_b32 s96, s96, s58
    s_mul_i32 s94, s94, 983040
    s_add_u32 s87, s94, s96
    v_lshlrev_b32 v48, 4, v0
    buffer_load_dwordx4 v[64:67], v48, s[36:39], 0 offen
    buffer_load_dwordx4 v[68:71], v48, s[40:43], 0 offen
    buffer_load_dwordx4 v[72:75], v48, s[44:47], 0 offen
    v_mov_b32 v49, 0
    buffer_load_ushort v76, v49, s[48:51], 0 offen
    s_lshl_b32 s97, s101, 2
    s_add_u32 s97, s97, s52
    s_mov_b32 s3, s100
    v_lshrrev_b32 v28, 5, v1
    v_mul_u32_u24 v29, 4096, v28
    v_bfe_u32 v30, v1, 3, 2
    v_lshl_add_u32 v29, v30, 13, v29
    v_and_b32 v30, 7, v1
    v_lshl_add_u32 v29, v30, 6, v29
    v_mul_u32_u24 v28, 0x1c0000, v28
    v_and_b32 v30, 31, v1
    v_lshl_add_u32 v28, v30, 6, v28
    s_lshl_b32 s94, s3, 9
    s_lshl_b32 s95, s97, 15
    s_add_u32 s94, s94, s95
    buffer_load_dword v31, v29, s[16:19], s94 offen
    s_mul_i32 s94, s3, 229376
    s_lshl_b32 s95, s97, 11
    s_add_u32 s94, s94, s95
    buffer_load_dword v31, v28, s[20:23], s94 offen
    s_getpc_b64 s[72:73]
L_pc:
    s_sub_u32 s72, s72, L_pc-interleave_layers__gqa_block_cached__mixer_token_mlp__decode_kernel
    s_subb_u32 s73, s73, 0
    s_and_b32 s73, s73, 0xffff
    s_mov_b32 s74, L_code_end-interleave_layers__gqa_block_cached__mixer_token_mlp__decode_kernel
    s_mov_b32 s75, 0x00020000
    s_and_b32 s94, s54, 15
    s_lshl_b32 s94, s94, 12
    v_lshlrev_b32 v32, 6, v1
    buffer_load_dword v31, v32, s[72:75], s94 offen
    s_add_u32 s56, s84, 0x0
    buffer_load_dwordx4 a[0:3], v2, s[4:7], s56 offen offset:0 nt
    buffer_load_dwordx4 a[4:7], v2, s[4:7], s56 offen offset:256 nt
    buffer_load_dwordx4 a[8:11], v3, s[8:11], s56 offen offset:0 nt
    buffer_load_dwordx4 a[12:15], v3, s[8:11], s56 offen offset:256 nt
    s_xor_b32 s57, s56, 2048
    buffer_load_dwordx4 a[16:19], v2, s[4:7], s57 offen offset:0 nt
    buffer_load_dwordx4 a[20:23], v2, s[4:7], s57 offen offset:256 nt
    buffer_load_dwordx4 a[24:27], v3, s[8:11], s57 offen offset:0 nt
    buffer_load_dwordx4 a[28:31], v3, s[8:11], s57 offen offset:256 nt
    s_xor_b32 s57, s56, 4096
    buffer_load_dwordx4 a[32:35], v2, s[4:7], s57 offen offset:0 nt
    buffer_load_dwordx4 a[36:39], v2, s[4:7], s57 offen offset:256 nt
    buffer_load_dwordx4 a[40:43], v3, s[8:11], s57 offen offset:0 nt
    buffer_load_dwordx4 a[44:47], v3, s[8:11], s57 offen offset:256 nt
    s_xor_b32 s57, s56, 6144
    buffer_load_dwordx4 a[48:51], v2, s[4:7], s57 offen offset:0 nt
    buffer_load_dwordx4 a[52:55], v2, s[4:7], s57 offen offset:256 nt
    buffer_load_dwordx4 a[56:59], v3, s[8:11], s57 offen offset:0 nt
    buffer_load_dwordx4 a[60:63], v3, s[8:11], s57 offen offset:256 nt
    s_add_u32 s56, s85, 0x0
    buffer_load_dwordx4 a[64:67], v2, s[4:7], s56 offen offset:0 nt
    buffer_load_dwordx4 a[68:71], v2, s[4:7], s56 offen offset:256 nt
    buffer_load_dwordx4 a[72:75], v3, s[8:11], s56 offen offset:0 nt
    buffer_load_dwordx4 a[76:79], v3, s[8:11], s56 offen offset:256 nt
    v_lshrrev_b32 v50, 5, v1
    v_lshlrev_b32 v50, 14, v50
    v_and_b32 v61, 31, v1
    v_lshl_add_u32 v50, v61, 4, v50
    v_lshlrev_b32 v51, 7, v1
    v_and_b32 v60, 31, v1
    v_cmp_eq_u32 vcc, 0, v60
    v_mov_b32 v61, 0x40000000
    s_nop 0
    v_cndmask_b32 v51, v61, v51, vcc
    v_and_b32 v60, 8, v1
    v_lshlrev_b32 v60, 6, v60
    v_lshrrev_b32 v61, 4, v1
    v_lshl_add_u32 v60, v61, 6, v60
    v_and_b32 v61, 3, v1
    v_lshl_add_u32 v60, v61, 4, v60
    v_mov_b32 v32, 160512
    v_mov_b32 v34, 0
    v_mov_b32 v35, 0
    ds_write_b64 v32, v[34:35]
    ds_write_b64 v32, v[34:35] offset:8
    s_lshl_b32 s3, s52, 12
    v_lshlrev_b32 v62, 4, v1
    v_add_u32 v62, s3, v62
    s_lshl_b32 s68, s53, 22
    s_add_u32 s68, s68, 4177920
    s_waitcnt vmcnt(20)
    v_lshlrev_b32 v80, 16, v64
    v_lshlrev_b32 v81, 16, v68
    v_and_b32 v82, 0xffff0000, v64
    v_and_b32 v83, 0xffff0000, v68
    v_lshlrev_b32 v96, 16, v72
    v_and_b32 v97, 0xffff0000, v72
    v_lshlrev_b32 v84, 16, v65
    v_lshlrev_b32 v85, 16, v69
    v_and_b32 v86, 0xffff0000, v65
    v_and_b32 v87, 0xffff0000, v69
    v_lshlrev_b32 v98, 16, v73
    v_and_b32 v99, 0xffff0000, v73
    v_lshlrev_b32 v88, 16, v66
    v_lshlrev_b32 v89, 16, v70
    v_and_b32 v90, 0xffff0000, v66
    v_and_b32 v91, 0xffff0000, v70
    v_lshlrev_b32 v100, 16, v74
    v_and_b32 v101, 0xffff0000, v74
    v_lshlrev_b32 v92, 16, v67
    v_lshlrev_b32 v93, 16, v71
    v_and_b32 v94, 0xffff0000, v67
    v_and_b32 v95, 0xffff0000, v71
    v_lshlrev_b32 v102, 16, v75
    v_and_b32 v103, 0xffff0000, v75
    v_lshlrev_b32 v76, 16, v76
    v_lshlrev_b32 v48, 6, v0
    v_add_u32 v48, 124928, v48
    v_lshlrev_b32 v49, 5, v0
    v_add_u32 v49, 139264, v49
    v_readfirstlane_b32 s78, v76
    v_cmp_gt_u32 vcc, 224, v0
    s_and_saveexec_b64 s[64:65], vcc
    ds_write_b128 v48, v[80:83] offset:0
    ds_write_b128 v48, v[84:87] offset:16
    ds_write_b128 v48, v[88:91] offset:32
    ds_write_b128 v48, v[92:95] offset:48
    ds_write_b128 v49, v[96:99] offset:0
    ds_write_b128 v49, v[100:103] offset:16
    s_mov_b64 exec, -1
    s_mov_b32 s76, 0xbdd2d3e8
    s_mov_b32 s77, 0xbdd2d3e8
    s_waitcnt lgkmcnt(0)
    s_barrier
    v_and_b32 v41, 3, v1
    v_lshlrev_b32 v41, 2, v41
    buffer_load_dword v40, v41, s[32:35], 0 offen offset:240 sc1
    s_xor_b32 s57, s56, 2048
    buffer_load_dwordx4 a[80:83], v2, s[4:7], s57 offen offset:0 nt
    buffer_load_dwordx4 a[84:87], v2, s[4:7], s57 offen offset:256 nt
    buffer_load_dwordx4 a[88:91], v3, s[8:11], s57 offen offset:0 nt
    buffer_load_dwordx4 a[92:95], v3, s[8:11], s57 offen offset:256 nt
    s_xor_b32 s57, s56, 4096
    buffer_load_dwordx4 a[96:99], v2, s[4:7], s57 offen offset:0 nt
    buffer_load_dwordx4 a[100:103], v2, s[4:7], s57 offen offset:256 nt
    buffer_load_dwordx4 a[104:107], v3, s[8:11], s57 offen offset:0 nt
    buffer_load_dwordx4 a[108:111], v3, s[8:11], s57 offen offset:256 nt
    s_xor_b32 s57, s56, 6144
    buffer_load_dwordx4 a[112:115], v2, s[4:7], s57 offen offset:0 nt
    buffer_load_dwordx4 a[116:119], v2, s[4:7], s57 offen offset:256 nt
    buffer_load_dwordx4 a[120:123], v3, s[8:11], s57 offen offset:0 nt
    buffer_load_dwordx4 a[124:127], v3, s[8:11], s57 offen offset:256 nt
    s_call_b64 s[60:61], TINI
    s_mov_b32 s94, 2
    s_call_b64 s[60:61], TBL
    s_add_u32 s56, s86, 0x0
    buffer_load_dwordx4 a[128:131], v2, s[4:7], s56 offen offset:0 nt
    buffer_load_dwordx4 a[132:135], v2, s[4:7], s56 offen offset:256 nt
    buffer_load_dwordx4 a[136:139], v3, s[8:11], s56 offen offset:0 nt
    buffer_load_dwordx4 a[140:143], v3, s[8:11], s56 offen offset:256 nt
    s_mov_b32 s94, 2
    s_call_b64 s[60:61], TBL
    s_xor_b32 s57, s56, 2048
    buffer_load_dwordx4 a[144:147], v2, s[4:7], s57 offen offset:0 nt
    buffer_load_dwordx4 a[148:151], v2, s[4:7], s57 offen offset:256 nt
    buffer_load_dwordx4 a[152:155], v3, s[8:11], s57 offen offset:0 nt
    buffer_load_dwordx4 a[156:159], v3, s[8:11], s57 offen offset:256 nt
    s_xor_b32 s57, s56, 4096
    buffer_load_dwordx4 a[160:163], v2, s[4:7], s57 offen offset:0 nt
    buffer_load_dwordx4 a[164:167], v2, s[4:7], s57 offen offset:256 nt
    buffer_load_dwordx4 a[168:171], v3, s[8:11], s57 offen offset:0 nt
    buffer_load_dwordx4 a[172:175], v3, s[8:11], s57 offen offset:256 nt
    s_mov_b32 s94, 2
    s_call_b64 s[60:61], TBL
    s_xor_b32 s57, s56, 6144
    buffer_load_dwordx4 a[176:179], v2, s[4:7], s57 offen offset:0 nt
    buffer_load_dwordx4 a[180:183], v2, s[4:7], s57 offen offset:256 nt
    buffer_load_dwordx4 a[184:187], v3, s[8:11], s57 offen offset:0 nt
    buffer_load_dwordx4 a[188:191], v3, s[8:11], s57 offen offset:256 nt
    s_add_u32 s56, s87, 0x0
    buffer_load_dwordx4 a[192:195], v2, s[4:7], s56 offen offset:0 nt
    buffer_load_dwordx4 a[196:199], v2, s[4:7], s56 offen offset:256 nt
    buffer_load_dwordx4 a[200:203], v3, s[8:11], s56 offen offset:0 nt
    buffer_load_dwordx4 a[204:207], v3, s[8:11], s56 offen offset:256 nt
    s_waitcnt vmcnt(32)
    s_branch Lfc_2
Lfr_1:
    s_sub_u32 s93, s93, 1
    s_cbranch_scc1 L_end
    buffer_load_dword v40, v41, s[32:35], 0 offen offset:240 sc1
    s_waitcnt vmcnt(0)
Lfc_2:
    v_and_b32 v40, 0x01010101, v40
    v_cmp_ne_u32 vcc, 0x01010101, v40
    s_cbranch_vccnz Lfr_1
    s_add_u32 s94, s92, 0x0
    buffer_load_dwordx4 v[8:11], v60, s[12:15], s94 offen offset:0 sc1
    buffer_load_dwordx4 v[12:15], v60, s[12:15], s94 offen offset:256 sc1
    s_sub_u32 s66, s54, 0
    s_lshl_b32 s94, s66, 11
    s_add_u32 s94, s94, s68
    s_add_u32 s94, s94, 0x0
    s_cmp_lt_u32 s66, 8
    s_cselect_b32 s94, s94, 0x40000000
    buffer_load_dwordx4 a[208:211], v2, s[4:7], s94 offen offset:0 nt
    buffer_load_dwordx4 a[212:215], v2, s[4:7], s94 offen offset:256 nt
    buffer_load_dwordx4 a[216:219], v3, s[8:11], s94 offen offset:0 nt
    buffer_load_dwordx4 a[220:223], v3, s[8:11], s94 offen offset:256 nt
    s_mov_b32 s94, 2
    s_call_b64 s[60:61], TBL
    s_xor_b32 s57, s56, 2048
    buffer_load_dwordx4 a[224:227], v2, s[4:7], s57 offen offset:0 nt
    buffer_load_dwordx4 a[228:231], v2, s[4:7], s57 offen offset:256 nt
    buffer_load_dwordx4 a[232:235], v3, s[8:11], s57 offen offset:0 nt
    buffer_load_dwordx4 a[236:239], v3, s[8:11], s57 offen offset:256 nt
    s_mov_b32 s94, 2
    s_call_b64 s[60:61], TBL
    s_xor_b32 s57, s56, 4096
    buffer_load_dwordx4 a[240:243], v2, s[4:7], s57 offen offset:0 nt
    buffer_load_dwordx4 a[244:247], v2, s[4:7], s57 offen offset:256 nt
    buffer_load_dwordx4 a[248:251], v3, s[8:11], s57 offen offset:0 nt
    buffer_load_dwordx4 a[252:255], v3, s[8:11], s57 offen offset:256 nt
    s_xor_b32 s57, s56, 6144
    buffer_load_dwordx4 v[112:115], v2, s[4:7], s57 offen offset:0 nt
    buffer_load_dwordx4 v[116:119], v2, s[4:7], s57 offen offset:256 nt
    buffer_load_dwordx4 v[120:123], v3, s[8:11], s57 offen offset:0 nt
    buffer_load_dwordx4 v[124:127], v3, s[8:11], s57 offen offset:256 nt
    s_call_b64 s[60:61], INIT
    s_waitcnt vmcnt(46)
    s_waitcnt vmcnt(42)
    s_waitcnt vmcnt(38)
    s_waitcnt vmcnt(34)
    s_waitcnt vmcnt(30)
    s_waitcnt vmcnt(26)
    s_waitcnt vmcnt(22)
    s_waitcnt vmcnt(18)
    s_waitcnt vmcnt(16)
    s_add_u32 s100, s92, 0x0
    s_branch Lchk_5
Lretry_4:
    buffer_load_dwordx4 v[8:11], v60, s[12:15], s100 offen offset:0 sc1
    buffer_load_dwordx4 v[12:15], v60, s[12:15], s100 offen offset:256 sc1
    s_waitcnt vmcnt(0)
Lchk_5:
    v_max_u32 v61, v8, v9
    v_max3_u32 v61, v61, v10, v11
    v_max3_u32 v61, v61, v12, v13
    v_max3_u32 v61, v61, v14, v15
    v_cmp_eq_u32 vcc, -1, v61
    s_cbranch_vccz Lok_3
    s_sub_u32 s93, s93, 1
    s_cbranch_scc1 L_end
    s_branch Lretry_4
Lok_3:
    v_mfma_f32_16x16x32_bf16 v[24:27], a[0:3], v[8:11], 0
    v_mfma_f32_16x16x32_bf16 v[28:31], a[16:19], v[8:11], 0
    v_mfma_f32_16x16x32_bf16 v[32:35], a[32:35], v[8:11], 0
    v_mfma_f32_16x16x32_bf16 v[36:39], a[48:51], v[8:11], 0
    v_mfma_f32_16x16x32_bf16 v[24:27], a[4:7], v[12:15], v[24:27]
    v_mfma_f32_16x16x32_bf16 v[28:31], a[20:23], v[12:15], v[28:31]
    v_mfma_f32_16x16x32_bf16 v[32:35], a[36:39], v[12:15], v[32:35]
    v_mfma_f32_16x16x32_bf16 v[36:39], a[52:55], v[12:15], v[36:39]
    s_call_b64 s[60:61], SM4
    v_mfma_f32_16x16x32_bf16 v[16:19], v[24:27], a[8:11], v[16:19]
    v_mfma_f32_16x16x32_bf16 v[20:23], v[24:27], a[12:15], v[20:23]
    v_mfma_f32_16x16x32_bf16 v[16:19], v[28:31], a[24:27], v[16:19]
    v_mfma_f32_16x16x32_bf16 v[20:23], v[28:31], a[28:31], v[20:23]
    v_mfma_f32_16x16x32_bf16 v[16:19], v[32:35], a[40:43], v[16:19]
    v_mfma_f32_16x16x32_bf16 v[20:23], v[32:35], a[44:47], v[20:23]
    v_mfma_f32_16x16x32_bf16 v[16:19], v[36:39], a[56:59], v[16:19]
    v_mfma_f32_16x16x32_bf16 v[20:23], v[36:39], a[60:63], v[20:23]
    ds_write_b128 v62, a[0:3] offset:0
    ds_write_b128 v62, a[4:7] offset:1024
    ds_write_b128 v62, a[8:11] offset:2048
    ds_write_b128 v62, a[12:15] offset:3072
    ds_write_b128 v62, a[16:19] offset:16384
    ds_write_b128 v62, a[20:23] offset:17408
    ds_write_b128 v62, a[24:27] offset:18432
    ds_write_b128 v62, a[28:31] offset:19456
    ds_write_b128 v62, a[32:35] offset:32768
    ds_write_b128 v62, a[36:39] offset:33792
    ds_write_b128 v62, a[40:43] offset:34816
    ds_write_b128 v62, a[44:47] offset:35840
    ds_write_b128 v62, a[48:51] offset:49152
    ds_write_b128 v62, a[52:55] offset:50176
    ds_write_b128 v62, a[56:59] offset:51200
    ds_write_b128 v62, a[60:63] offset:52224
    s_waitcnt lgkmcnt(0)
    s_cmp_ge_u32 s66, 8
    s_cbranch_scc1 Lnx_6
    s_waitcnt vmcnt(12)
    v_mfma_f32_16x16x32_bf16 v[24:27], a[208:211], v[8:11], 0
    v_mfma_f32_16x16x32_bf16 v[24:27], a[212:215], v[12:15], v[24:27]
    s_call_b64 s[60:61], SM1
    v_mfma_f32_16x16x32_bf16 v[16:19], v[24:27], a[216:219], v[16:19]
    v_mfma_f32_16x16x32_bf16 v[20:23], v[24:27], a[220:223], v[20:23]
Lnx_6:
    s_sub_u32 s66, s54, 8
    s_lshl_b32 s94, s66, 11
    s_add_u32 s94, s94, s68
    s_add_u32 s94, s94, 0x2000000
    s_cmp_lt_u32 s66, 8
    s_cselect_b32 s94, s94, 0x40000000
    buffer_load_dwordx4 v[128:131], v2, s[4:7], s94 offen offset:0 nt
    buffer_load_dwordx4 v[132:135], v2, s[4:7], s94 offen offset:256 nt
    buffer_load_dwordx4 v[136:139], v3, s[8:11], s94 offen offset:0 nt
    buffer_load_dwordx4 v[140:143], v3, s[8:11], s94 offen offset:256 nt
    v_mfma_f32_16x16x32_bf16 v[24:27], a[64:67], v[8:11], 0
    v_mfma_f32_16x16x32_bf16 v[28:31], a[80:83], v[8:11], 0
    v_mfma_f32_16x16x32_bf16 v[32:35], a[96:99], v[8:11], 0
    v_mfma_f32_16x16x32_bf16 v[36:39], a[112:115], v[8:11], 0
    v_mfma_f32_16x16x32_bf16 v[24:27], a[68:71], v[12:15], v[24:27]
    v_mfma_f32_16x16x32_bf16 v[28:31], a[84:87], v[12:15], v[28:31]
    v_mfma_f32_16x16x32_bf16 v[32:35], a[100:103], v[12:15], v[32:35]
    v_mfma_f32_16x16x32_bf16 v[36:39], a[116:119], v[12:15], v[36:39]
    s_call_b64 s[60:61], SM4
    v_mfma_f32_16x16x32_bf16 v[16:19], v[24:27], a[72:75], v[16:19]
    v_mfma_f32_16x16x32_bf16 v[20:23], v[24:27], a[76:79], v[20:23]
    v_mfma_f32_16x16x32_bf16 v[16:19], v[28:31], a[88:91], v[16:19]
    v_mfma_f32_16x16x32_bf16 v[20:23], v[28:31], a[92:95], v[20:23]
    v_mfma_f32_16x16x32_bf16 v[16:19], v[32:35], a[104:107], v[16:19]
    v_mfma_f32_16x16x32_bf16 v[20:23], v[32:35], a[108:111], v[20:23]
    v_mfma_f32_16x16x32_bf16 v[16:19], v[36:39], a[120:123], v[16:19]
    v_mfma_f32_16x16x32_bf16 v[20:23], v[36:39], a[124:127], v[20:23]
    v_add_u32 v49, 65536, v62
    ds_write_b128 v49, a[64:67] offset:0
    ds_write_b128 v49, a[68:71] offset:1024
    ds_write_b128 v49, a[72:75] offset:2048
    ds_write_b128 v49, a[76:79] offset:3072
    s_waitcnt lgkmcnt(0)
    s_add_u32 s56, s59, 0x0
    buffer_load_dwordx4 v[144:147], v2, s[4:7], s56 offen offset:0 nt
    buffer_load_dwordx4 v[148:151], v2, s[4:7], s56 offen offset:256 nt
    buffer_load_dwordx4 v[152:155], v3, s[8:11], s56 offen offset:0 nt
    buffer_load_dwordx4 v[156:159], v3, s[8:11], s56 offen offset:256 nt
    v_mfma_f32_16x16x32_bf16 v[24:27], a[128:131], v[8:11], 0
    v_mfma_f32_16x16x32_bf16 v[28:31], a[144:147], v[8:11], 0
    v_mfma_f32_16x16x32_bf16 v[32:35], a[160:163], v[8:11], 0
    v_mfma_f32_16x16x32_bf16 v[36:39], a[176:179], v[8:11], 0
    v_mfma_f32_16x16x32_bf16 v[24:27], a[132:135], v[12:15], v[24:27]
    v_mfma_f32_16x16x32_bf16 v[28:31], a[148:151], v[12:15], v[28:31]
    v_mfma_f32_16x16x32_bf16 v[32:35], a[164:167], v[12:15], v[32:35]
    v_mfma_f32_16x16x32_bf16 v[36:39], a[180:183], v[12:15], v[36:39]
    s_call_b64 s[60:61], SM4
    v_mfma_f32_16x16x32_bf16 v[16:19], v[24:27], a[136:139], v[16:19]
    v_mfma_f32_16x16x32_bf16 v[20:23], v[24:27], a[140:143], v[20:23]
    v_mfma_f32_16x16x32_bf16 v[16:19], v[28:31], a[152:155], v[16:19]
    v_mfma_f32_16x16x32_bf16 v[20:23], v[28:31], a[156:159], v[20:23]
    v_mfma_f32_16x16x32_bf16 v[16:19], v[32:35], a[168:171], v[16:19]
    v_mfma_f32_16x16x32_bf16 v[20:23], v[32:35], a[172:175], v[20:23]
    v_mfma_f32_16x16x32_bf16 v[16:19], v[36:39], a[184:187], v[16:19]
    v_mfma_f32_16x16x32_bf16 v[20:23], v[36:39], a[188:191], v[20:23]
    s_add_u32 s56, s84, 0x2000000
    buffer_load_dwordx4 v[160:163], v2, s[4:7], s56 offen offset:0 nt
    buffer_load_dwordx4 v[164:167], v2, s[4:7], s56 offen offset:256 nt
    buffer_load_dwordx4 v[168:171], v3, s[8:11], s56 offen offset:0 nt
    buffer_load_dwordx4 v[172:175], v3, s[8:11], s56 offen offset:256 nt
    s_waitcnt vmcnt(20)
    s_waitcnt vmcnt(16)
    s_waitcnt vmcnt(12)
    s_xor_b32 s57, s56, 2048
    buffer_load_dwordx4 v[176:179], v2, s[4:7], s57 offen offset:0 nt
    buffer_load_dwordx4 v[180:183], v2, s[4:7], s57 offen offset:256 nt
    buffer_load_dwordx4 v[184:187], v3, s[8:11], s57 offen offset:0 nt
    buffer_load_dwordx4 v[188:191], v3, s[8:11], s57 offen offset:256 nt
    v_mfma_f32_16x16x32_bf16 v[24:27], a[192:195], v[8:11], 0
    v_mfma_f32_16x16x32_bf16 v[28:31], a[224:227], v[8:11], 0
    v_mfma_f32_16x16x32_bf16 v[32:35], a[240:243], v[8:11], 0
    v_mfma_f32_16x16x32_bf16 v[36:39], v[112:115], v[8:11], 0
    v_mfma_f32_16x16x32_bf16 v[24:27], a[196:199], v[12:15], v[24:27]
    v_mfma_f32_16x16x32_bf16 v[28:31], a[228:231], v[12:15], v[28:31]
    v_mfma_f32_16x16x32_bf16 v[32:35], a[244:247], v[12:15], v[32:35]
    v_mfma_f32_16x16x32_bf16 v[36:39], v[116:119], v[12:15], v[36:39]
    s_call_b64 s[60:61], SM4
    v_mfma_f32_16x16x32_bf16 v[16:19], v[24:27], a[200:203], v[16:19]
    v_mfma_f32_16x16x32_bf16 v[20:23], v[24:27], a[204:207], v[20:23]
    v_mfma_f32_16x16x32_bf16 v[16:19], v[28:31], a[232:235], v[16:19]
    v_mfma_f32_16x16x32_bf16 v[20:23], v[28:31], a[236:239], v[20:23]
    v_mfma_f32_16x16x32_bf16 v[16:19], v[32:35], a[248:251], v[16:19]
    v_mfma_f32_16x16x32_bf16 v[20:23], v[32:35], a[252:255], v[20:23]
    v_mfma_f32_16x16x32_bf16 v[16:19], v[36:39], v[120:123], v[16:19]
    v_mfma_f32_16x16x32_bf16 v[20:23], v[36:39], v[124:127], v[20:23]
    s_waitcnt vmcnt(8)
    s_xor_b32 s57, s56, 4096
    buffer_load_dwordx4 v[192:195], v2, s[4:7], s57 offen offset:0 nt
    buffer_load_dwordx4 v[196:199], v2, s[4:7], s57 offen offset:256 nt
    buffer_load_dwordx4 v[200:203], v3, s[8:11], s57 offen offset:0 nt
    buffer_load_dwordx4 v[204:207], v3, s[8:11], s57 offen offset:256 nt
    v_mfma_f32_16x16x32_bf16 v[24:27], v[144:147], v[8:11], 0
    v_mfma_f32_16x16x32_bf16 v[24:27], v[148:151], v[12:15], v[24:27]
    s_call_b64 s[60:61], SM1
    v_mfma_f32_16x16x32_bf16 v[16:19], v[24:27], v[152:155], v[16:19]
    v_mfma_f32_16x16x32_bf16 v[20:23], v[24:27], v[156:159], v[20:23]
    s_add_u32 s94, s92, 0x2000
    buffer_load_dwordx4 v[8:11], v60, s[12:15], s94 offen offset:0 sc1
    buffer_load_dwordx4 v[12:15], v60, s[12:15], s94 offen offset:256 sc1
    s_mov_b32 s96, 147456
    s_call_b64 s[60:61], REC
    s_call_b64 s[60:61], ARR
    s_cmp_eq_u32 s94, 3
    s_cbranch_scc1 Lal_7
    s_mov_b32 s56, 0x40000000
    s_mov_b32 s57, 0x40000000
    s_call_b64 s[60:61], MST
    s_branch Lad_9
Lal_7:
    s_mov_b32 s96, 147456
    s_add_u32 s56, s90, 0x0
    s_add_u32 s57, s91, 0x0
    s_call_b64 s[60:61], MRG
    v_mov_b32 v32, 160516
    v_mov_b32 v33, 1
    ds_write_b32 v32, v33
Lad_9:
    s_mov_b32 s94, 2
    s_call_b64 s[60:61], TBL
    s_add_u32 s56, s84, 0x2000000
    s_xor_b32 s57, s56, 6144
    buffer_load_dwordx4 v[208:211], v2, s[4:7], s57 offen offset:0 nt
    buffer_load_dwordx4 v[212:215], v2, s[4:7], s57 offen offset:256 nt
    buffer_load_dwordx4 v[216:219], v3, s[8:11], s57 offen offset:0 nt
    buffer_load_dwordx4 v[220:223], v3, s[8:11], s57 offen offset:256 nt
    s_add_u32 s56, s85, 0x2000000
    buffer_load_dwordx4 v[224:227], v2, s[4:7], s56 offen offset:0 nt
    buffer_load_dwordx4 v[228:231], v2, s[4:7], s56 offen offset:256 nt
    buffer_load_dwordx4 v[232:235], v3, s[8:11], s56 offen offset:0 nt
    buffer_load_dwordx4 v[236:239], v3, s[8:11], s56 offen offset:256 nt
    s_mov_b32 s94, 2
    s_call_b64 s[60:61], TBL
    s_xor_b32 s57, s56, 2048
    buffer_load_dwordx4 v[240:243], v2, s[4:7], s57 offen offset:0 nt
    buffer_load_dwordx4 v[244:247], v2, s[4:7], s57 offen offset:256 nt
    buffer_load_dwordx4 v[248:251], v3, s[8:11], s57 offen offset:0 nt
    buffer_load_dwordx4 v[252:255], v3, s[8:11], s57 offen offset:256 nt
    s_call_b64 s[60:61], TFIN
    v_and_b32 v52, 3, v1
    s_lshl_b32 s94, s52, 4
    s_add_u32 s94, s94, 160576
    v_lshl_add_u32 v52, v52, 2, s94
    ds_write_b32 v52, v24
    s_waitcnt lgkmcnt(0)
    s_barrier
    s_cmp_lg_u32 s52, 3
    s_cbranch_scc1 Lts_10
    v_lshlrev_b32 v52, 4, v1
    v_and_b32 v53, 48, v52
    v_add_u32 v53, 160576, v53
    ds_read_b128 v[24:27], v53
    v_cmp_gt_u32 vcc, 8, v1
    v_mov_b32 v61, 0x40000000
    s_nop 0
    v_cndmask_b32 v52, v61, v52, vcc
    s_lshl_b32 s94, s2, 7
    s_add_u32 s94, s94, 0x4b0000
    s_waitcnt lgkmcnt(0)
    buffer_store_dwordx4 v[24:27], v52, s[12:15], s94 offen sc1
    s_nop 1
Lts_10:
    s_xor_b32 s57, s56, 4096
    buffer_load_dwordx4 a[0:3], v2, s[4:7], s57 offen offset:0 nt
    buffer_load_dwordx4 a[4:7], v2, s[4:7], s57 offen offset:256 nt
    buffer_load_dwordx4 a[8:11], v3, s[8:11], s57 offen offset:0 nt
    buffer_load_dwordx4 a[12:15], v3, s[8:11], s57 offen offset:256 nt
    s_waitcnt vmcnt(28)
    s_waitcnt vmcnt(24)
    s_waitcnt vmcnt(20)
    s_waitcnt vmcnt(18)
    s_add_u32 s100, s92, 0x2000
    s_branch Lchk_13
Lretry_12:
    buffer_load_dwordx4 v[8:11], v60, s[12:15], s100 offen offset:0 sc1
    buffer_load_dwordx4 v[12:15], v60, s[12:15], s100 offen offset:256 sc1
    s_waitcnt vmcnt(0)
Lchk_13:
    v_max_u32 v61, v8, v9
    v_max3_u32 v61, v61, v10, v11
    v_max3_u32 v61, v61, v12, v13
    v_max3_u32 v61, v61, v14, v15
    v_cmp_eq_u32 vcc, -1, v61
    s_cbranch_vccz Lok_11
    s_sub_u32 s93, s93, 1
    s_cbranch_scc1 L_end
    s_branch Lretry_12
Lok_11:
    s_waitcnt vmcnt(12)
    v_mfma_f32_16x16x32_bf16 v[24:27], v[160:163], v[8:11], 0
    v_mfma_f32_16x16x32_bf16 v[28:31], v[176:179], v[8:11], 0
    v_mfma_f32_16x16x32_bf16 v[32:35], v[192:195], v[8:11], 0
    v_mfma_f32_16x16x32_bf16 v[36:39], v[208:211], v[8:11], 0
    v_mfma_f32_16x16x32_bf16 v[24:27], v[164:167], v[12:15], v[24:27]
    v_mfma_f32_16x16x32_bf16 v[28:31], v[180:183], v[12:15], v[28:31]
    v_mfma_f32_16x16x32_bf16 v[32:35], v[196:199], v[12:15], v[32:35]
    v_mfma_f32_16x16x32_bf16 v[36:39], v[212:215], v[12:15], v[36:39]
    s_call_b64 s[60:61], SM4
    v_mfma_f32_16x16x32_bf16 v[16:19], v[24:27], v[168:171], v[16:19]
    v_mfma_f32_16x16x32_bf16 v[20:23], v[24:27], v[172:175], v[20:23]
    v_mfma_f32_16x16x32_bf16 v[16:19], v[28:31], v[184:187], v[16:19]
    v_mfma_f32_16x16x32_bf16 v[20:23], v[28:31], v[188:191], v[20:23]
    v_mfma_f32_16x16x32_bf16 v[16:19], v[32:35], v[200:203], v[16:19]
    v_mfma_f32_16x16x32_bf16 v[20:23], v[32:35], v[204:207], v[20:23]
    v_mfma_f32_16x16x32_bf16 v[16:19], v[36:39], v[216:219], v[16:19]
    v_mfma_f32_16x16x32_bf16 v[20:23], v[36:39], v[220:223], v[20:23]
    v_add_u32 v49, 65536, v62
    ds_write_b128 v49, v[160:163] offset:16384
    ds_write_b128 v49, v[164:167] offset:17408
    ds_write_b128 v49, v[168:171] offset:18432
    ds_write_b128 v49, v[172:175] offset:19456
    v_add_u32 v49, 65536, v62
    ds_write_b128 v49, v[176:179] offset:32768
    ds_write_b128 v49, v[180:183] offset:33792
    ds_write_b128 v49, v[184:187] offset:34816
    ds_write_b128 v49, v[188:191] offset:35840
    v_add_u32 v49, 65536, v62
    ds_write_b128 v49, v[192:195] offset:49152
    ds_write_b128 v49, v[196:199] offset:50176
    ds_write_b128 v49, v[200:203] offset:51200
    ds_write_b128 v49, v[204:207] offset:52224
    v_add_u32 v49, 131072, v62
    ds_write_b128 v49, v[208:211] offset:0
    ds_write_b128 v49, v[212:215] offset:1024
    ds_write_b128 v49, v[216:219] offset:2048
    ds_write_b128 v49, v[220:223] offset:3072
    s_waitcnt lgkmcnt(0)
    s_cmp_ge_u32 s66, 8
    s_cbranch_scc1 Lnx_14
    v_mfma_f32_16x16x32_bf16 v[24:27], v[128:131], v[8:11], 0
    v_mfma_f32_16x16x32_bf16 v[24:27], v[132:135], v[12:15], v[24:27]
    s_call_b64 s[60:61], SM1
    v_mfma_f32_16x16x32_bf16 v[16:19], v[24:27], v[136:139], v[16:19]
    v_mfma_f32_16x16x32_bf16 v[20:23], v[24:27], v[140:143], v[20:23]
Lnx_14:
    s_xor_b32 s57, s56, 6144
    buffer_load_dwordx4 a[16:19], v2, s[4:7], s57 offen offset:0 nt
    buffer_load_dwordx4 a[20:23], v2, s[4:7], s57 offen offset:256 nt
    buffer_load_dwordx4 a[24:27], v3, s[8:11], s57 offen offset:0 nt
    buffer_load_dwordx4 a[28:31], v3, s[8:11], s57 offen offset:256 nt
    s_waitcnt vmcnt(12)
    s_waitcnt vmcnt(8)
    s_add_u32 s56, s86, 0x2000000
    buffer_load_dwordx4 a[32:35], v2, s[4:7], s56 offen offset:0 nt
    buffer_load_dwordx4 a[36:39], v2, s[4:7], s56 offen offset:256 nt
    buffer_load_dwordx4 a[40:43], v3, s[8:11], s56 offen offset:0 nt
    buffer_load_dwordx4 a[44:47], v3, s[8:11], s56 offen offset:256 nt
    s_waitcnt vmcnt(8)
    s_xor_b32 s57, s56, 2048
    buffer_load_dwordx4 a[48:51], v2, s[4:7], s57 offen offset:0 nt
    buffer_load_dwordx4 a[52:55], v2, s[4:7], s57 offen offset:256 nt
    buffer_load_dwordx4 a[56:59], v3, s[8:11], s57 offen offset:0 nt
    buffer_load_dwordx4 a[60:63], v3, s[8:11], s57 offen offset:256 nt
    s_waitcnt vmcnt(8)
    s_xor_b32 s57, s56, 4096
    buffer_load_dwordx4 a[208:211], v2, s[4:7], s57 offen offset:0 nt
    buffer_load_dwordx4 a[212:215], v2, s[4:7], s57 offen offset:256 nt
    buffer_load_dwordx4 a[216:219], v3, s[8:11], s57 offen offset:0 nt
    buffer_load_dwordx4 a[220:223], v3, s[8:11], s57 offen offset:256 nt
    v_mfma_f32_16x16x32_bf16 v[24:27], v[224:227], v[8:11], 0
    v_mfma_f32_16x16x32_bf16 v[28:31], v[240:243], v[8:11], 0
    v_mfma_f32_16x16x32_bf16 v[32:35], a[0:3], v[8:11], 0
    v_mfma_f32_16x16x32_bf16 v[36:39], a[16:19], v[8:11], 0
    v_mfma_f32_16x16x32_bf16 v[24:27], v[228:231], v[12:15], v[24:27]
    v_mfma_f32_16x16x32_bf16 v[28:31], v[244:247], v[12:15], v[28:31]
    v_mfma_f32_16x16x32_bf16 v[32:35], a[4:7], v[12:15], v[32:35]
    v_mfma_f32_16x16x32_bf16 v[36:39], a[20:23], v[12:15], v[36:39]
    s_call_b64 s[60:61], SM4
    v_mfma_f32_16x16x32_bf16 v[16:19], v[24:27], v[232:235], v[16:19]
    v_mfma_f32_16x16x32_bf16 v[20:23], v[24:27], v[236:239], v[20:23]
    v_mfma_f32_16x16x32_bf16 v[16:19], v[28:31], v[248:251], v[16:19]
    v_mfma_f32_16x16x32_bf16 v[20:23], v[28:31], v[252:255], v[20:23]
    v_mfma_f32_16x16x32_bf16 v[16:19], v[32:35], a[8:11], v[16:19]
    v_mfma_f32_16x16x32_bf16 v[20:23], v[32:35], a[12:15], v[20:23]
    v_mfma_f32_16x16x32_bf16 v[16:19], v[36:39], a[24:27], v[16:19]
    v_mfma_f32_16x16x32_bf16 v[20:23], v[36:39], a[28:31], v[20:23]
    s_waitcnt vmcnt(8)
    s_xor_b32 s57, s56, 6144
    buffer_load_dwordx4 a[64:67], v2, s[4:7], s57 offen offset:0 nt
    buffer_load_dwordx4 a[68:71], v2, s[4:7], s57 offen offset:256 nt
    buffer_load_dwordx4 a[72:75], v3, s[8:11], s57 offen offset:0 nt
    buffer_load_dwordx4 a[76:79], v3, s[8:11], s57 offen offset:256 nt
    s_waitcnt vmcnt(8)
    s_add_u32 s56, s87, 0x2000000
    buffer_load_dwordx4 v[64:67], v2, s[4:7], s56 offen offset:0 nt
    buffer_load_dwordx4 v[68:71], v2, s[4:7], s56 offen offset:256 nt
    buffer_load_dwordx4 v[72:75], v3, s[8:11], s56 offen offset:0 nt
    buffer_load_dwordx4 v[76:79], v3, s[8:11], s56 offen offset:256 nt
    s_waitcnt vmcnt(8)
    s_xor_b32 s57, s56, 2048
    buffer_load_dwordx4 v[80:83], v2, s[4:7], s57 offen offset:0 nt
    buffer_load_dwordx4 v[84:87], v2, s[4:7], s57 offen offset:256 nt
    buffer_load_dwordx4 v[88:91], v3, s[8:11], s57 offen offset:0 nt
    buffer_load_dwordx4 v[92:95], v3, s[8:11], s57 offen offset:256 nt
    s_waitcnt vmcnt(8)
    s_xor_b32 s57, s56, 4096
    buffer_load_dwordx4 v[96:99], v2, s[4:7], s57 offen offset:0 nt
    buffer_load_dwordx4 v[100:103], v2, s[4:7], s57 offen offset:256 nt
    buffer_load_dwordx4 v[104:107], v3, s[8:11], s57 offen offset:0 nt
    buffer_load_dwordx4 v[108:111], v3, s[8:11], s57 offen offset:256 nt
    v_mfma_f32_16x16x32_bf16 v[24:27], a[32:35], v[8:11], 0
    v_mfma_f32_16x16x32_bf16 v[28:31], a[48:51], v[8:11], 0
    v_mfma_f32_16x16x32_bf16 v[32:35], a[208:211], v[8:11], 0
    v_mfma_f32_16x16x32_bf16 v[36:39], a[64:67], v[8:11], 0
    v_mfma_f32_16x16x32_bf16 v[24:27], a[36:39], v[12:15], v[24:27]
    v_mfma_f32_16x16x32_bf16 v[28:31], a[52:55], v[12:15], v[28:31]
    v_mfma_f32_16x16x32_bf16 v[32:35], a[212:215], v[12:15], v[32:35]
    v_mfma_f32_16x16x32_bf16 v[36:39], a[68:71], v[12:15], v[36:39]
    s_call_b64 s[60:61], SM4
    v_mfma_f32_16x16x32_bf16 v[16:19], v[24:27], a[40:43], v[16:19]
    v_mfma_f32_16x16x32_bf16 v[20:23], v[24:27], a[44:47], v[20:23]
    v_mfma_f32_16x16x32_bf16 v[16:19], v[28:31], a[56:59], v[16:19]
    v_mfma_f32_16x16x32_bf16 v[20:23], v[28:31], a[60:63], v[20:23]
    v_mfma_f32_16x16x32_bf16 v[16:19], v[32:35], a[216:219], v[16:19]
    v_mfma_f32_16x16x32_bf16 v[20:23], v[32:35], a[220:223], v[20:23]
    v_mfma_f32_16x16x32_bf16 v[16:19], v[36:39], a[72:75], v[16:19]
    v_mfma_f32_16x16x32_bf16 v[20:23], v[36:39], a[76:79], v[20:23]
    s_waitcnt vmcnt(8)
    s_xor_b32 s57, s56, 6144
    buffer_load_dwordx4 v[160:163], v2, s[4:7], s57 offen offset:0 nt
    buffer_load_dwordx4 v[164:167], v2, s[4:7], s57 offen offset:256 nt
    buffer_load_dwordx4 v[168:171], v3, s[8:11], s57 offen offset:0 nt
    buffer_load_dwordx4 v[172:175], v3, s[8:11], s57 offen offset:256 nt
    s_waitcnt vmcnt(8)
    s_add_u32 s56, s59, 0x2000000
    buffer_load_dwordx4 v[176:179], v2, s[4:7], s56 offen offset:0 nt
    buffer_load_dwordx4 v[180:183], v2, s[4:7], s56 offen offset:256 nt
    buffer_load_dwordx4 v[184:187], v3, s[8:11], s56 offen offset:0 nt
    buffer_load_dwordx4 v[188:191], v3, s[8:11], s56 offen offset:256 nt
    s_waitcnt vmcnt(8)
    s_add_u32 s56, s84, 0x4000000
    buffer_load_dwordx4 v[192:195], v2, s[4:7], s56 offen offset:0 nt
    buffer_load_dwordx4 v[196:199], v2, s[4:7], s56 offen offset:256 nt
    buffer_load_dwordx4 v[200:203], v3, s[8:11], s56 offen offset:0 nt
    buffer_load_dwordx4 v[204:207], v3, s[8:11], s56 offen offset:256 nt
    s_waitcnt vmcnt(8)
    s_add_u32 s94, s92, 0x10000
    buffer_load_dwordx4 v[52:55], v60, s[12:15], s94 offen offset:0 sc1
    buffer_load_dwordx4 v[56:59], v60, s[12:15], s94 offen offset:256 sc1
    s_xor_b32 s57, s56, 2048
    buffer_load_dwordx4 v[208:211], v2, s[4:7], s57 offen offset:0 nt
    buffer_load_dwordx4 v[212:215], v2, s[4:7], s57 offen offset:256 nt
    buffer_load_dwordx4 v[216:219], v3, s[8:11], s57 offen offset:0 nt
    buffer_load_dwordx4 v[220:223], v3, s[8:11], s57 offen offset:256 nt
    v_mfma_f32_16x16x32_bf16 v[24:27], v[64:67], v[8:11], 0
    v_mfma_f32_16x16x32_bf16 v[28:31], v[80:83], v[8:11], 0
    v_mfma_f32_16x16x32_bf16 v[32:35], v[96:99], v[8:11], 0
    v_mfma_f32_16x16x32_bf16 v[36:39], v[160:163], v[8:11], 0
    v_mfma_f32_16x16x32_bf16 v[24:27], v[68:71], v[12:15], v[24:27]
    v_mfma_f32_16x16x32_bf16 v[28:31], v[84:87], v[12:15], v[28:31]
    v_mfma_f32_16x16x32_bf16 v[32:35], v[100:103], v[12:15], v[32:35]
    v_mfma_f32_16x16x32_bf16 v[36:39], v[164:167], v[12:15], v[36:39]
    s_call_b64 s[60:61], SM4
    v_mfma_f32_16x16x32_bf16 v[16:19], v[24:27], v[72:75], v[16:19]
    v_mfma_f32_16x16x32_bf16 v[20:23], v[24:27], v[76:79], v[20:23]
    v_mfma_f32_16x16x32_bf16 v[16:19], v[28:31], v[88:91], v[16:19]
    v_mfma_f32_16x16x32_bf16 v[20:23], v[28:31], v[92:95], v[20:23]
    v_mfma_f32_16x16x32_bf16 v[16:19], v[32:35], v[104:107], v[16:19]
    v_mfma_f32_16x16x32_bf16 v[20:23], v[32:35], v[108:111], v[20:23]
    v_mfma_f32_16x16x32_bf16 v[16:19], v[36:39], v[168:171], v[16:19]
    v_mfma_f32_16x16x32_bf16 v[20:23], v[36:39], v[172:175], v[20:23]
    s_waitcnt vmcnt(10)
    s_xor_b32 s57, s56, 4096
    buffer_load_dwordx4 v[128:131], v2, s[4:7], s57 offen offset:0 nt
    buffer_load_dwordx4 v[132:135], v2, s[4:7], s57 offen offset:256 nt
    buffer_load_dwordx4 v[136:139], v3, s[8:11], s57 offen offset:0 nt
    buffer_load_dwordx4 v[140:143], v3, s[8:11], s57 offen offset:256 nt
    v_mfma_f32_16x16x32_bf16 v[24:27], v[176:179], v[8:11], 0
    v_mfma_f32_16x16x32_bf16 v[24:27], v[180:183], v[12:15], v[24:27]
    s_call_b64 s[60:61], SM1
    v_mfma_f32_16x16x32_bf16 v[16:19], v[24:27], v[184:187], v[16:19]
    v_mfma_f32_16x16x32_bf16 v[20:23], v[24:27], v[188:191], v[20:23]
    s_add_u32 s94, s92, 0x4000
    buffer_load_dwordx4 v[8:11], v60, s[12:15], s94 offen offset:0 sc1
    buffer_load_dwordx4 v[12:15], v60, s[12:15], s94 offen offset:256 sc1
    s_mov_b32 s69, 1
    s_mov_b32 s95, 160516
    s_call_b64 s[60:61], WDN
    s_mov_b32 s96, 147456
    s_call_b64 s[60:61], REC
    s_call_b64 s[60:61], ARR
    s_cmp_eq_u32 s94, 3
    s_cbranch_scc1 Lal_15
    s_mov_b32 s56, 0x40000000
    s_mov_b32 s57, 0x40000000
    s_call_b64 s[60:61], MST
    s_branch Lad_17
Lal_15:
    s_mov_b32 s96, 147456
    s_add_u32 s56, s90, 0x40000
    s_add_u32 s57, s91, 0x10000
    s_call_b64 s[60:61], MRG
    v_mov_b32 v32, 160516
    v_mov_b32 v33, 2
    ds_write_b32 v32, v33
Lad_17:
    s_waitcnt vmcnt(14)
    s_waitcnt vmcnt(12)
    s_add_u32 s100, s92, 0x10000
    s_branch Lchk_21
Lretry_20:
    buffer_load_dwordx4 v[52:55], v60, s[12:15], s100 offen offset:0 sc1
    buffer_load_dwordx4 v[56:59], v60, s[12:15], s100 offen offset:256 sc1
    s_waitcnt vmcnt(0)
Lchk_21:
    v_max_u32 v61, v52, v53
    v_max3_u32 v61, v61, v54, v55
    v_max3_u32 v61, v61, v56, v57
    v_max3_u32 v61, v61, v58, v59
    v_cmp_eq_u32 vcc, -1, v61
    s_cbranch_vccz Lok_19
    s_sub_u32 s93, s93, 1
    s_cbranch_scc1 L_end
    s_branch Lretry_20
Lok_19:
Lqok_18:
    v_mfma_f32_16x16x32_bf16 v[24:27], a[80:83], v[52:55], 0
    v_mfma_f32_16x16x32_bf16 v[28:31], a[96:99], v[52:55], 0
    v_mfma_f32_16x16x32_bf16 v[32:35], a[112:115], v[52:55], 0
    v_mfma_f32_16x16x32_bf16 v[36:39], a[128:131], v[52:55], 0
    v_mfma_f32_16x16x32_bf16 v[24:27], a[84:87], v[56:59], v[24:27]
    v_mfma_f32_16x16x32_bf16 v[28:31], a[100:103], v[56:59], v[28:31]
    v_mfma_f32_16x16x32_bf16 v[32:35], a[116:119], v[56:59], v[32:35]
    v_mfma_f32_16x16x32_bf16 v[36:39], a[132:135], v[56:59], v[36:39]
    s_call_b64 s[60:61], SM4
    v_mfma_f32_16x16x32_bf16 v[16:19], v[24:27], a[88:91], v[16:19]
    v_mfma_f32_16x16x32_bf16 v[20:23], v[24:27], a[92:95], v[20:23]
    v_mfma_f32_16x16x32_bf16 v[16:19], v[28:31], a[104:107], v[16:19]
    v_mfma_f32_16x16x32_bf16 v[20:23], v[28:31], a[108:111], v[20:23]
    v_mfma_f32_16x16x32_bf16 v[16:19], v[32:35], a[120:123], v[16:19]
    v_mfma_f32_16x16x32_bf16 v[20:23], v[32:35], a[124:127], v[20:23]
    v_mfma_f32_16x16x32_bf16 v[16:19], v[36:39], a[136:139], v[16:19]
    v_mfma_f32_16x16x32_bf16 v[20:23], v[36:39], a[140:143], v[20:23]
    s_sub_u32 s67, s54, 64
    s_lshl_b32 s94, s67, 11
    s_add_u32 s94, s94, s68
    s_add_u32 s94, s94, 0x0
    s_cmp_lt_u32 s67, 8
    s_cselect_b32 s94, s94, 0x40000000
    buffer_load_dwordx4 a[80:83], v2, s[4:7], s94 offen offset:0 nt
    buffer_load_dwordx4 a[84:87], v2, s[4:7], s94 offen offset:256 nt
    buffer_load_dwordx4 a[88:91], v3, s[8:11], s94 offen offset:0 nt
    buffer_load_dwordx4 a[92:95], v3, s[8:11], s94 offen offset:256 nt
    s_sub_u32 s66, s54, 16
    s_lshl_b32 s94, s66, 11
    s_add_u32 s94, s94, s68
    s_add_u32 s94, s94, 0x4000000
    s_cmp_lt_u32 s66, 8
    s_cselect_b32 s94, s94, 0x40000000
    buffer_load_dwordx4 a[96:99], v2, s[4:7], s94 offen offset:0 nt
    buffer_load_dwordx4 a[100:103], v2, s[4:7], s94 offen offset:256 nt
    buffer_load_dwordx4 a[104:107], v3, s[8:11], s94 offen offset:0 nt
    buffer_load_dwordx4 a[108:111], v3, s[8:11], s94 offen offset:256 nt
    s_add_u32 s56, s84, 0x4000000
    s_xor_b32 s57, s56, 6144
    buffer_load_dwordx4 a[112:115], v2, s[4:7], s57 offen offset:0 nt
    buffer_load_dwordx4 a[116:119], v2, s[4:7], s57 offen offset:256 nt
    buffer_load_dwordx4 a[120:123], v3, s[8:11], s57 offen offset:0 nt
    buffer_load_dwordx4 a[124:127], v3, s[8:11], s57 offen offset:256 nt
    v_mfma_f32_16x16x32_bf16 v[24:27], a[144:147], v[52:55], 0
    v_mfma_f32_16x16x32_bf16 v[28:31], a[160:163], v[52:55], 0
    v_mfma_f32_16x16x32_bf16 v[32:35], a[176:179], v[52:55], 0
    v_mfma_f32_16x16x32_bf16 v[36:39], a[192:195], v[52:55], 0
    v_mfma_f32_16x16x32_bf16 v[24:27], a[148:151], v[56:59], v[24:27]
    v_mfma_f32_16x16x32_bf16 v[28:31], a[164:167], v[56:59], v[28:31]
    v_mfma_f32_16x16x32_bf16 v[32:35], a[180:183], v[56:59], v[32:35]
    v_mfma_f32_16x16x32_bf16 v[36:39], a[196:199], v[56:59], v[36:39]
    s_call_b64 s[60:61], SM4
    v_mfma_f32_16x16x32_bf16 v[16:19], v[24:27], a[152:155], v[16:19]
    v_mfma_f32_16x16x32_bf16 v[20:23], v[24:27], a[156:159], v[20:23]
    v_mfma_f32_16x16x32_bf16 v[16:19], v[28:31], a[168:171], v[16:19]
    v_mfma_f32_16x16x32_bf16 v[20:23], v[28:31], a[172:175], v[20:23]
    v_mfma_f32_16x16x32_bf16 v[16:19], v[32:35], a[184:187], v[16:19]
    v_mfma_f32_16x16x32_bf16 v[20:23], v[32:35], a[188:191], v[20:23]
    v_mfma_f32_16x16x32_bf16 v[16:19], v[36:39], a[200:203], v[16:19]
    v_mfma_f32_16x16x32_bf16 v[20:23], v[36:39], a[204:207], v[20:23]
    s_add_u32 s56, s85, 0x4000000
    buffer_load_dwordx4 a[128:131], v2, s[4:7], s56 offen offset:0 nt
    buffer_load_dwordx4 a[132:135], v2, s[4:7], s56 offen offset:256 nt
    buffer_load_dwordx4 a[136:139], v3, s[8:11], s56 offen offset:0 nt
    buffer_load_dwordx4 a[140:143], v3, s[8:11], s56 offen offset:256 nt
    v_mfma_f32_16x16x32_bf16 v[24:27], a[224:227], v[52:55], 0
    v_mfma_f32_16x16x32_bf16 v[28:31], a[240:243], v[52:55], 0
    v_mfma_f32_16x16x32_bf16 v[32:35], v[112:115], v[52:55], 0
    v_mfma_f32_16x16x32_bf16 v[36:39], v[144:147], v[52:55], 0
    v_mfma_f32_16x16x32_bf16 v[24:27], a[228:231], v[56:59], v[24:27]
    v_mfma_f32_16x16x32_bf16 v[28:31], a[244:247], v[56:59], v[28:31]
    v_mfma_f32_16x16x32_bf16 v[32:35], v[116:119], v[56:59], v[32:35]
    v_mfma_f32_16x16x32_bf16 v[36:39], v[148:151], v[56:59], v[36:39]
    s_call_b64 s[60:61], SM4
    v_mfma_f32_16x16x32_bf16 v[16:19], v[24:27], a[232:235], v[16:19]
    v_mfma_f32_16x16x32_bf16 v[20:23], v[24:27], a[236:239], v[20:23]
    v_mfma_f32_16x16x32_bf16 v[16:19], v[28:31], a[248:251], v[16:19]
    v_mfma_f32_16x16x32_bf16 v[20:23], v[28:31], a[252:255], v[20:23]
    v_mfma_f32_16x16x32_bf16 v[16:19], v[32:35], v[120:123], v[16:19]
    v_mfma_f32_16x16x32_bf16 v[20:23], v[32:35], v[124:127], v[20:23]
    v_mfma_f32_16x16x32_bf16 v[16:19], v[36:39], v[152:155], v[16:19]
    v_mfma_f32_16x16x32_bf16 v[20:23], v[36:39], v[156:159], v[20:23]
    s_nop 3
    ds_read_b128 a[224:227], v62 offset:0
    ds_read_b128 a[228:231], v62 offset:1024
    ds_read_b128 a[232:235], v62 offset:2048
    ds_read_b128 a[236:239], v62 offset:3072
    ds_read_b128 a[240:243], v62 offset:16384
    ds_read_b128 a[244:247], v62 offset:17408
    ds_read_b128 a[248:251], v62 offset:18432
    ds_read_b128 a[252:255], v62 offset:19456
    ds_read_b128 v[112:115], v62 offset:32768
    ds_read_b128 v[116:119], v62 offset:33792
    ds_read_b128 v[120:123], v62 offset:34816
    ds_read_b128 v[124:127], v62 offset:35840
    ds_read_b128 v[144:147], v62 offset:49152
    ds_read_b128 v[148:151], v62 offset:50176
    ds_read_b128 v[152:155], v62 offset:51200
    ds_read_b128 v[156:159], v62 offset:52224
    s_waitcnt lgkmcnt(0)
    v_mfma_f32_16x16x32_bf16 v[24:27], a[224:227], v[52:55], 0
    v_mfma_f32_16x16x32_bf16 v[28:31], a[240:243], v[52:55], 0
    v_mfma_f32_16x16x32_bf16 v[32:35], v[112:115], v[52:55], 0
    v_mfma_f32_16x16x32_bf16 v[36:39], v[144:147], v[52:55], 0
    v_mfma_f32_16x16x32_bf16 v[24:27], a[228:231], v[56:59], v[24:27]
    v_mfma_f32_16x16x32_bf16 v[28:31], a[244:247], v[56:59], v[28:31]
    v_mfma_f32_16x16x32_bf16 v[32:35], v[116:119], v[56:59], v[32:35]
    v_mfma_f32_16x16x32_bf16 v[36:39], v[148:151], v[56:59], v[36:39]
    s_call_b64 s[60:61], SM4
    v_mfma_f32_16x16x32_bf16 v[16:19], v[24:27], a[232:235], v[16:19]
    v_mfma_f32_16x16x32_bf16 v[20:23], v[24:27], a[236:239], v[20:23]
    v_mfma_f32_16x16x32_bf16 v[16:19], v[28:31], a[248:251], v[16:19]
    v_mfma_f32_16x16x32_bf16 v[20:23], v[28:31], a[252:255], v[20:23]
    v_mfma_f32_16x16x32_bf16 v[16:19], v[32:35], v[120:123], v[16:19]
    v_mfma_f32_16x16x32_bf16 v[20:23], v[32:35], v[124:127], v[20:23]
    v_mfma_f32_16x16x32_bf16 v[16:19], v[36:39], v[152:155], v[16:19]
    v_mfma_f32_16x16x32_bf16 v[20:23], v[36:39], v[156:159], v[20:23]
    s_nop 3
    v_add_u32 v49, 65536, v62
    ds_read_b128 a[224:227], v49 offset:0
    ds_read_b128 a[228:231], v49 offset:1024
    ds_read_b128 a[232:235], v49 offset:2048
    ds_read_b128 a[236:239], v49 offset:3072
    s_xor_b32 s57, s56, 2048
    buffer_load_dwordx4 a[144:147], v2, s[4:7], s57 offen offset:0 nt
    buffer_load_dwordx4 a[148:151], v2, s[4:7], s57 offen offset:256 nt
    buffer_load_dwordx4 a[152:155], v3, s[8:11], s57 offen offset:0 nt
    buffer_load_dwordx4 a[156:159], v3, s[8:11], s57 offen offset:256 nt
    s_waitcnt lgkmcnt(0)
    v_mfma_f32_16x16x32_bf16 v[24:27], a[224:227], v[52:55], 0
    v_mfma_f32_16x16x32_bf16 v[24:27], a[228:231], v[56:59], v[24:27]
    s_call_b64 s[60:61], SM1
    v_mfma_f32_16x16x32_bf16 v[16:19], v[24:27], a[232:235], v[16:19]
    v_mfma_f32_16x16x32_bf16 v[20:23], v[24:27], a[236:239], v[20:23]
    s_cmp_ge_u32 s67, 8
    s_cbranch_scc1 Lnx_22
    s_waitcnt vmcnt(16)
    v_mfma_f32_16x16x32_bf16 v[24:27], a[80:83], v[52:55], 0
    v_mfma_f32_16x16x32_bf16 v[24:27], a[84:87], v[56:59], v[24:27]
    s_call_b64 s[60:61], SM1
    v_mfma_f32_16x16x32_bf16 v[16:19], v[24:27], a[88:91], v[16:19]
    v_mfma_f32_16x16x32_bf16 v[20:23], v[24:27], a[92:95], v[20:23]
Lnx_22:
    s_mov_b32 s96, 151808
    s_call_b64 s[60:61], REC
    s_waitcnt vmcnt(28)
    s_waitcnt vmcnt(24)
    s_waitcnt vmcnt(22)
    s_add_u32 s100, s92, 0x4000
    s_branch Lchk_25
Lretry_24:
    buffer_load_dwordx4 v[8:11], v60, s[12:15], s100 offen offset:0 sc1
    buffer_load_dwordx4 v[12:15], v60, s[12:15], s100 offen offset:256 sc1
    s_waitcnt vmcnt(0)
Lchk_25:
    v_max_u32 v61, v8, v9
    v_max3_u32 v61, v61, v10, v11
    v_max3_u32 v61, v61, v12, v13
    v_max3_u32 v61, v61, v14, v15
    v_cmp_eq_u32 vcc, -1, v61
    s_cbranch_vccz Lok_23
    s_sub_u32 s93, s93, 1
    s_cbranch_scc1 L_end
    s_branch Lretry_24
Lok_23:
    s_waitcnt vmcnt(8)
    s_xor_b32 s57, s56, 4096
    buffer_load_dwordx4 a[160:163], v2, s[4:7], s57 offen offset:0 nt
    buffer_load_dwordx4 a[164:167], v2, s[4:7], s57 offen offset:256 nt
    buffer_load_dwordx4 a[168:171], v3, s[8:11], s57 offen offset:0 nt
    buffer_load_dwordx4 a[172:175], v3, s[8:11], s57 offen offset:256 nt
    v_mfma_f32_16x16x32_bf16 v[24:27], v[192:195], v[8:11], 0
    v_mfma_f32_16x16x32_bf16 v[28:31], v[208:211], v[8:11], 0
    v_mfma_f32_16x16x32_bf16 v[32:35], v[128:131], v[8:11], 0
    v_mfma_f32_16x16x32_bf16 v[36:39], a[112:115], v[8:11], 0
    v_mfma_f32_16x16x32_bf16 v[24:27], v[196:199], v[12:15], v[24:27]
    v_mfma_f32_16x16x32_bf16 v[28:31], v[212:215], v[12:15], v[28:31]
    v_mfma_f32_16x16x32_bf16 v[32:35], v[132:135], v[12:15], v[32:35]
    v_mfma_f32_16x16x32_bf16 v[36:39], a[116:119], v[12:15], v[36:39]
    s_call_b64 s[60:61], SM4
    v_mfma_f32_16x16x32_bf16 v[16:19], v[24:27], v[200:203], v[16:19]
    v_mfma_f32_16x16x32_bf16 v[20:23], v[24:27], v[204:207], v[20:23]
    v_mfma_f32_16x16x32_bf16 v[16:19], v[28:31], v[216:219], v[16:19]
    v_mfma_f32_16x16x32_bf16 v[20:23], v[28:31], v[220:223], v[20:23]
    v_mfma_f32_16x16x32_bf16 v[16:19], v[32:35], v[136:139], v[16:19]
    v_mfma_f32_16x16x32_bf16 v[20:23], v[32:35], v[140:143], v[20:23]
    v_mfma_f32_16x16x32_bf16 v[16:19], v[36:39], a[120:123], v[16:19]
    v_mfma_f32_16x16x32_bf16 v[20:23], v[36:39], a[124:127], v[20:23]
    ds_write_b128 v62, v[192:195] offset:0
    ds_write_b128 v62, v[196:199] offset:1024
    ds_write_b128 v62, v[200:203] offset:2048
    ds_write_b128 v62, v[204:207] offset:3072
    ds_write_b128 v62, v[208:211] offset:16384
    ds_write_b128 v62, v[212:215] offset:17408
    ds_write_b128 v62, v[216:219] offset:18432
    ds_write_b128 v62, v[220:223] offset:19456
    ds_write_b128 v62, v[128:131] offset:32768
    ds_write_b128 v62, v[132:135] offset:33792
    ds_write_b128 v62, v[136:139] offset:34816
    ds_write_b128 v62, v[140:143] offset:35840
    ds_write_b128 v62, a[112:115] offset:49152
    ds_write_b128 v62, a[116:119] offset:50176
    ds_write_b128 v62, a[120:123] offset:51200
    ds_write_b128 v62, a[124:127] offset:52224
    s_waitcnt lgkmcnt(0)
    s_cmp_ge_u32 s66, 8
    s_cbranch_scc1 Lnx_26
    v_mfma_f32_16x16x32_bf16 v[24:27], a[96:99], v[8:11], 0
    v_mfma_f32_16x16x32_bf16 v[24:27], a[100:103], v[12:15], v[24:27]
    s_call_b64 s[60:61], SM1
    v_mfma_f32_16x16x32_bf16 v[16:19], v[24:27], a[104:107], v[16:19]
    v_mfma_f32_16x16x32_bf16 v[20:23], v[24:27], a[108:111], v[20:23]
Lnx_26:
    s_waitcnt vmcnt(8)
    s_xor_b32 s57, s56, 6144
    buffer_load_dwordx4 a[176:179], v2, s[4:7], s57 offen offset:0 nt
    buffer_load_dwordx4 a[180:183], v2, s[4:7], s57 offen offset:256 nt
    buffer_load_dwordx4 a[184:187], v3, s[8:11], s57 offen offset:0 nt
    buffer_load_dwordx4 a[188:191], v3, s[8:11], s57 offen offset:256 nt
    s_waitcnt vmcnt(8)
    s_add_u32 s56, s86, 0x4000000
    buffer_load_dwordx4 a[192:195], v2, s[4:7], s56 offen offset:0 nt
    buffer_load_dwordx4 a[196:199], v2, s[4:7], s56 offen offset:256 nt
    buffer_load_dwordx4 a[200:203], v3, s[8:11], s56 offen offset:0 nt
    buffer_load_dwordx4 a[204:207], v3, s[8:11], s56 offen offset:256 nt
    s_waitcnt vmcnt(8)
    s_xor_b32 s57, s56, 2048
    buffer_load_dwordx4 a[240:243], v2, s[4:7], s57 offen offset:0 nt
    buffer_load_dwordx4 a[244:247], v2, s[4:7], s57 offen offset:256 nt
    buffer_load_dwordx4 a[248:251], v3, s[8:11], s57 offen offset:0 nt
    buffer_load_dwordx4 a[252:255], v3, s[8:11], s57 offen offset:256 nt
    s_waitcnt vmcnt(8)
    s_xor_b32 s57, s56, 4096
    buffer_load_dwordx4 v[112:115], v2, s[4:7], s57 offen offset:0 nt
    buffer_load_dwordx4 v[116:119], v2, s[4:7], s57 offen offset:256 nt
    buffer_load_dwordx4 v[120:123], v3, s[8:11], s57 offen offset:0 nt
    buffer_load_dwordx4 v[124:127], v3, s[8:11], s57 offen offset:256 nt
    v_mfma_f32_16x16x32_bf16 v[24:27], a[128:131], v[8:11], 0
    v_mfma_f32_16x16x32_bf16 v[28:31], a[144:147], v[8:11], 0
    v_mfma_f32_16x16x32_bf16 v[32:35], a[160:163], v[8:11], 0
    v_mfma_f32_16x16x32_bf16 v[36:39], a[176:179], v[8:11], 0
    v_mfma_f32_16x16x32_bf16 v[24:27], a[132:135], v[12:15], v[24:27]
    v_mfma_f32_16x16x32_bf16 v[28:31], a[148:151], v[12:15], v[28:31]
    v_mfma_f32_16x16x32_bf16 v[32:35], a[164:167], v[12:15], v[32:35]
    v_mfma_f32_16x16x32_bf16 v[36:39], a[180:183], v[12:15], v[36:39]
    s_call_b64 s[60:61], SM4
    v_mfma_f32_16x16x32_bf16 v[16:19], v[24:27], a[136:139], v[16:19]
    v_mfma_f32_16x16x32_bf16 v[20:23], v[24:27], a[140:143], v[20:23]
    v_mfma_f32_16x16x32_bf16 v[16:19], v[28:31], a[152:155], v[16:19]
    v_mfma_f32_16x16x32_bf16 v[20:23], v[28:31], a[156:159], v[20:23]
    v_mfma_f32_16x16x32_bf16 v[16:19], v[32:35], a[168:171], v[16:19]
    v_mfma_f32_16x16x32_bf16 v[20:23], v[32:35], a[172:175], v[20:23]
    v_mfma_f32_16x16x32_bf16 v[16:19], v[36:39], a[184:187], v[16:19]
    v_mfma_f32_16x16x32_bf16 v[20:23], v[36:39], a[188:191], v[20:23]
    v_add_u32 v49, 65536, v62
    ds_write_b128 v49, a[128:131] offset:0
    ds_write_b128 v49, a[132:135] offset:1024
    ds_write_b128 v49, a[136:139] offset:2048
    ds_write_b128 v49, a[140:143] offset:3072
    s_waitcnt lgkmcnt(0)
    s_waitcnt vmcnt(8)
    s_xor_b32 s57, s56, 6144
    buffer_load_dwordx4 v[144:147], v2, s[4:7], s57 offen offset:0 nt
    buffer_load_dwordx4 v[148:151], v2, s[4:7], s57 offen offset:256 nt
    buffer_load_dwordx4 v[152:155], v3, s[8:11], s57 offen offset:0 nt
    buffer_load_dwordx4 v[156:159], v3, s[8:11], s57 offen offset:256 nt
    s_waitcnt vmcnt(8)
    s_add_u32 s56, s87, 0x4000000
    buffer_load_dwordx4 a[224:227], v2, s[4:7], s56 offen offset:0 nt
    buffer_load_dwordx4 a[228:231], v2, s[4:7], s56 offen offset:256 nt
    buffer_load_dwordx4 a[232:235], v3, s[8:11], s56 offen offset:0 nt
    buffer_load_dwordx4 a[236:239], v3, s[8:11], s56 offen offset:256 nt
    s_waitcnt vmcnt(8)
    s_xor_b32 s57, s56, 2048
    buffer_load_dwordx4 a[80:83], v2, s[4:7], s57 offen offset:0 nt
    buffer_load_dwordx4 a[84:87], v2, s[4:7], s57 offen offset:256 nt
    buffer_load_dwordx4 a[88:91], v3, s[8:11], s57 offen offset:0 nt
    buffer_load_dwordx4 a[92:95], v3, s[8:11], s57 offen offset:256 nt
    s_waitcnt vmcnt(8)
    s_xor_b32 s57, s56, 4096
    buffer_load_dwordx4 v[192:195], v2, s[4:7], s57 offen offset:0 nt
    buffer_load_dwordx4 v[196:199], v2, s[4:7], s57 offen offset:256 nt
    buffer_load_dwordx4 v[200:203], v3, s[8:11], s57 offen offset:0 nt
    buffer_load_dwordx4 v[204:207], v3, s[8:11], s57 offen offset:256 nt
    v_mfma_f32_16x16x32_bf16 v[24:27], a[192:195], v[8:11], 0
    v_mfma_f32_16x16x32_bf16 v[28:31], a[240:243], v[8:11], 0
    v_mfma_f32_16x16x32_bf16 v[32:35], v[112:115], v[8:11], 0
    v_mfma_f32_16x16x32_bf16 v[36:39], v[144:147], v[8:11], 0
    v_mfma_f32_16x16x32_bf16 v[24:27], a[196:199], v[12:15], v[24:27]
    v_mfma_f32_16x16x32_bf16 v[28:31], a[244:247], v[12:15], v[28:31]
    v_mfma_f32_16x16x32_bf16 v[32:35], v[116:119], v[12:15], v[32:35]
    v_mfma_f32_16x16x32_bf16 v[36:39], v[148:151], v[12:15], v[36:39]
    s_call_b64 s[60:61], SM4
    v_mfma_f32_16x16x32_bf16 v[16:19], v[24:27], a[200:203], v[16:19]
    v_mfma_f32_16x16x32_bf16 v[20:23], v[24:27], a[204:207], v[20:23]
    v_mfma_f32_16x16x32_bf16 v[16:19], v[28:31], a[248:251], v[16:19]
    v_mfma_f32_16x16x32_bf16 v[20:23], v[28:31], a[252:255], v[20:23]
    v_mfma_f32_16x16x32_bf16 v[16:19], v[32:35], v[120:123], v[16:19]
    v_mfma_f32_16x16x32_bf16 v[20:23], v[32:35], v[124:127], v[20:23]
    v_mfma_f32_16x16x32_bf16 v[16:19], v[36:39], v[152:155], v[16:19]
    v_mfma_f32_16x16x32_bf16 v[20:23], v[36:39], v[156:159], v[20:23]
    s_waitcnt vmcnt(8)
    s_xor_b32 s57, s56, 6144
    buffer_load_dwordx4 v[208:211], v2, s[4:7], s57 offen offset:0 nt
    buffer_load_dwordx4 v[212:215], v2, s[4:7], s57 offen offset:256 nt
    buffer_load_dwordx4 v[216:219], v3, s[8:11], s57 offen offset:0 nt
    buffer_load_dwordx4 v[220:223], v3, s[8:11], s57 offen offset:256 nt
    s_waitcnt vmcnt(8)
    s_add_u32 s56, s59, 0x4000000
    buffer_load_dwordx4 v[128:131], v2, s[4:7], s56 offen offset:0 nt
    buffer_load_dwordx4 v[132:135], v2, s[4:7], s56 offen offset:256 nt
    buffer_load_dwordx4 v[136:139], v3, s[8:11], s56 offen offset:0 nt
    buffer_load_dwordx4 v[140:143], v3, s[8:11], s56 offen offset:256 nt
    s_waitcnt vmcnt(8)
    s_add_u32 s56, s84, 0x6000000
    buffer_load_dwordx4 a[112:115], v2, s[4:7], s56 offen offset:0 nt
    buffer_load_dwordx4 a[116:119], v2, s[4:7], s56 offen offset:256 nt
    buffer_load_dwordx4 a[120:123], v3, s[8:11], s56 offen offset:0 nt
    buffer_load_dwordx4 a[124:127], v3, s[8:11], s56 offen offset:256 nt
    s_waitcnt vmcnt(8)
    s_add_u32 s94, s92, 0x12000
    buffer_load_dwordx4 v[52:55], v60, s[12:15], s94 offen offset:0 sc1
    buffer_load_dwordx4 v[56:59], v60, s[12:15], s94 offen offset:256 sc1
    s_xor_b32 s57, s56, 2048
    buffer_load_dwordx4 a[96:99], v2, s[4:7], s57 offen offset:0 nt
    buffer_load_dwordx4 a[100:103], v2, s[4:7], s57 offen offset:256 nt
    buffer_load_dwordx4 a[104:107], v3, s[8:11], s57 offen offset:0 nt
    buffer_load_dwordx4 a[108:111], v3, s[8:11], s57 offen offset:256 nt
    v_mfma_f32_16x16x32_bf16 v[24:27], a[224:227], v[8:11], 0
    v_mfma_f32_16x16x32_bf16 v[28:31], a[80:83], v[8:11], 0
    v_mfma_f32_16x16x32_bf16 v[32:35], v[192:195], v[8:11], 0
    v_mfma_f32_16x16x32_bf16 v[36:39], v[208:211], v[8:11], 0
    v_mfma_f32_16x16x32_bf16 v[24:27], a[228:231], v[12:15], v[24:27]
    v_mfma_f32_16x16x32_bf16 v[28:31], a[84:87], v[12:15], v[28:31]
    v_mfma_f32_16x16x32_bf16 v[32:35], v[196:199], v[12:15], v[32:35]
    v_mfma_f32_16x16x32_bf16 v[36:39], v[212:215], v[12:15], v[36:39]
    s_call_b64 s[60:61], SM4
    v_mfma_f32_16x16x32_bf16 v[16:19], v[24:27], a[232:235], v[16:19]
    v_mfma_f32_16x16x32_bf16 v[20:23], v[24:27], a[236:239], v[20:23]
    v_mfma_f32_16x16x32_bf16 v[16:19], v[28:31], a[88:91], v[16:19]
    v_mfma_f32_16x16x32_bf16 v[20:23], v[28:31], a[92:95], v[20:23]
    v_mfma_f32_16x16x32_bf16 v[16:19], v[32:35], v[200:203], v[16:19]
    v_mfma_f32_16x16x32_bf16 v[20:23], v[32:35], v[204:207], v[20:23]
    v_mfma_f32_16x16x32_bf16 v[16:19], v[36:39], v[216:219], v[16:19]
    v_mfma_f32_16x16x32_bf16 v[20:23], v[36:39], v[220:223], v[20:23]
    s_waitcnt vmcnt(10)
    s_xor_b32 s57, s56, 4096
    buffer_load_dwordx4 a[128:131], v2, s[4:7], s57 offen offset:0 nt
    buffer_load_dwordx4 a[132:135], v2, s[4:7], s57 offen offset:256 nt
    buffer_load_dwordx4 a[136:139], v3, s[8:11], s57 offen offset:0 nt
    buffer_load_dwordx4 a[140:143], v3, s[8:11], s57 offen offset:256 nt
    v_mfma_f32_16x16x32_bf16 v[24:27], v[128:131], v[8:11], 0
    v_mfma_f32_16x16x32_bf16 v[24:27], v[132:135], v[12:15], v[24:27]
    s_call_b64 s[60:61], SM1
    v_mfma_f32_16x16x32_bf16 v[16:19], v[24:27], v[136:139], v[16:19]
    v_mfma_f32_16x16x32_bf16 v[20:23], v[24:27], v[140:143], v[20:23]
    s_add_u32 s94, s92, 0x6000
    buffer_load_dwordx4 v[8:11], v60, s[12:15], s94 offen offset:0 sc1
    buffer_load_dwordx4 v[12:15], v60, s[12:15], s94 offen offset:256 sc1
    s_mov_b32 s69, 2
    s_mov_b32 s95, 160516
    s_call_b64 s[60:61], WDN
    s_mov_b32 s96, 147456
    s_call_b64 s[60:61], REC
    s_call_b64 s[60:61], ARR
    s_cmp_eq_u32 s94, 3
    s_cbranch_scc1 Lal_27
    s_mov_b32 s56, 0x40000000
    s_mov_b32 s57, 0x40000000
    s_call_b64 s[60:61], MST
    s_branch Lad_29
Lal_27:
    s_mov_b32 s96, 147456
    s_add_u32 s56, s90, 0x80000
    s_add_u32 s57, s91, 0x20000
    s_call_b64 s[60:61], MRG
    v_mov_b32 v32, 160516
    v_mov_b32 v33, 3
    ds_write_b32 v32, v33
Lad_29:
    s_waitcnt vmcnt(14)
    s_waitcnt vmcnt(12)
    s_add_u32 s100, s92, 0x12000
    s_branch Lchk_33
Lretry_32:
    buffer_load_dwordx4 v[52:55], v60, s[12:15], s100 offen offset:0 sc1
    buffer_load_dwordx4 v[56:59], v60, s[12:15], s100 offen offset:256 sc1
    s_waitcnt vmcnt(0)
Lchk_33:
    v_max_u32 v61, v52, v53
    v_max3_u32 v61, v61, v54, v55
    v_max3_u32 v61, v61, v56, v57
    v_max3_u32 v61, v61, v58, v59
    v_cmp_eq_u32 vcc, -1, v61
    s_cbranch_vccz Lok_31
    s_sub_u32 s93, s93, 1
    s_cbranch_scc1 L_end
    s_branch Lretry_32
Lok_31:
Lqok_30:
    v_mfma_f32_16x16x32_bf16 v[24:27], v[224:227], v[52:55], 0
    v_mfma_f32_16x16x32_bf16 v[28:31], v[240:243], v[52:55], 0
    v_mfma_f32_16x16x32_bf16 v[32:35], a[0:3], v[52:55], 0
    v_mfma_f32_16x16x32_bf16 v[36:39], a[16:19], v[52:55], 0
    v_mfma_f32_16x16x32_bf16 v[24:27], v[228:231], v[56:59], v[24:27]
    v_mfma_f32_16x16x32_bf16 v[28:31], v[244:247], v[56:59], v[28:31]
    v_mfma_f32_16x16x32_bf16 v[32:35], a[4:7], v[56:59], v[32:35]
    v_mfma_f32_16x16x32_bf16 v[36:39], a[20:23], v[56:59], v[36:39]
    s_call_b64 s[60:61], SM4
    v_mfma_f32_16x16x32_bf16 v[16:19], v[24:27], v[232:235], v[16:19]
    v_mfma_f32_16x16x32_bf16 v[20:23], v[24:27], v[236:239], v[20:23]
    v_mfma_f32_16x16x32_bf16 v[16:19], v[28:31], v[248:251], v[16:19]
    v_mfma_f32_16x16x32_bf16 v[20:23], v[28:31], v[252:255], v[20:23]
    v_mfma_f32_16x16x32_bf16 v[16:19], v[32:35], a[8:11], v[16:19]
    v_mfma_f32_16x16x32_bf16 v[20:23], v[32:35], a[12:15], v[20:23]
    v_mfma_f32_16x16x32_bf16 v[16:19], v[36:39], a[24:27], v[16:19]
    v_mfma_f32_16x16x32_bf16 v[20:23], v[36:39], a[28:31], v[20:23]
    s_sub_u32 s67, s54, 72
    s_lshl_b32 s94, s67, 11
    s_add_u32 s94, s94, s68
    s_add_u32 s94, s94, 0x2000000
    s_cmp_lt_u32 s67, 8
    s_cselect_b32 s94, s94, 0x40000000
    buffer_load_dwordx4 v[224:227], v2, s[4:7], s94 offen offset:0 nt
    buffer_load_dwordx4 v[228:231], v2, s[4:7], s94 offen offset:256 nt
    buffer_load_dwordx4 v[232:235], v3, s[8:11], s94 offen offset:0 nt
    buffer_load_dwordx4 v[236:239], v3, s[8:11], s94 offen offset:256 nt
    s_sub_u32 s66, s54, 24
    s_lshl_b32 s94, s66, 11
    s_add_u32 s94, s94, s68
    s_add_u32 s94, s94, 0x6000000
    s_cmp_lt_u32 s66, 8
    s_cselect_b32 s94, s94, 0x40000000
    buffer_load_dwordx4 v[240:243], v2, s[4:7], s94 offen offset:0 nt
    buffer_load_dwordx4 v[244:247], v2, s[4:7], s94 offen offset:256 nt
    buffer_load_dwordx4 v[248:251], v3, s[8:11], s94 offen offset:0 nt
    buffer_load_dwordx4 v[252:255], v3, s[8:11], s94 offen offset:256 nt
    s_add_u32 s56, s84, 0x6000000
    s_xor_b32 s57, s56, 6144
    buffer_load_dwordx4 a[0:3], v2, s[4:7], s57 offen offset:0 nt
    buffer_load_dwordx4 a[4:7], v2, s[4:7], s57 offen offset:256 nt
    buffer_load_dwordx4 a[8:11], v3, s[8:11], s57 offen offset:0 nt
    buffer_load_dwordx4 a[12:15], v3, s[8:11], s57 offen offset:256 nt
    v_mfma_f32_16x16x32_bf16 v[24:27], a[32:35], v[52:55], 0
    v_mfma_f32_16x16x32_bf16 v[28:31], a[48:51], v[52:55], 0
    v_mfma_f32_16x16x32_bf16 v[32:35], a[208:211], v[52:55], 0
    v_mfma_f32_16x16x32_bf16 v[36:39], a[64:67], v[52:55], 0
    v_mfma_f32_16x16x32_bf16 v[24:27], a[36:39], v[56:59], v[24:27]
    v_mfma_f32_16x16x32_bf16 v[28:31], a[52:55], v[56:59], v[28:31]
    v_mfma_f32_16x16x32_bf16 v[32:35], a[212:215], v[56:59], v[32:35]
    v_mfma_f32_16x16x32_bf16 v[36:39], a[68:71], v[56:59], v[36:39]
    s_call_b64 s[60:61], SM4
    v_mfma_f32_16x16x32_bf16 v[16:19], v[24:27], a[40:43], v[16:19]
    v_mfma_f32_16x16x32_bf16 v[20:23], v[24:27], a[44:47], v[20:23]
    v_mfma_f32_16x16x32_bf16 v[16:19], v[28:31], a[56:59], v[16:19]
    v_mfma_f32_16x16x32_bf16 v[20:23], v[28:31], a[60:63], v[20:23]
    v_mfma_f32_16x16x32_bf16 v[16:19], v[32:35], a[216:219], v[16:19]
    v_mfma_f32_16x16x32_bf16 v[20:23], v[32:35], a[220:223], v[20:23]
    v_mfma_f32_16x16x32_bf16 v[16:19], v[36:39], a[72:75], v[16:19]
    v_mfma_f32_16x16x32_bf16 v[20:23], v[36:39], a[76:79], v[20:23]
    s_add_u32 s56, s85, 0x6000000
    buffer_load_dwordx4 a[16:19], v2, s[4:7], s56 offen offset:0 nt
    buffer_load_dwordx4 a[20:23], v2, s[4:7], s56 offen offset:256 nt
    buffer_load_dwordx4 a[24:27], v3, s[8:11], s56 offen offset:0 nt
    buffer_load_dwordx4 a[28:31], v3, s[8:11], s56 offen offset:256 nt
    v_mfma_f32_16x16x32_bf16 v[24:27], v[64:67], v[52:55], 0
    v_mfma_f32_16x16x32_bf16 v[28:31], v[80:83], v[52:55], 0
    v_mfma_f32_16x16x32_bf16 v[32:35], v[96:99], v[52:55], 0
    v_mfma_f32_16x16x32_bf16 v[36:39], v[160:163], v[52:55], 0
    v_mfma_f32_16x16x32_bf16 v[24:27], v[68:71], v[56:59], v[24:27]
    v_mfma_f32_16x16x32_bf16 v[28:31], v[84:87], v[56:59], v[28:31]
    v_mfma_f32_16x16x32_bf16 v[32:35], v[100:103], v[56:59], v[32:35]
    v_mfma_f32_16x16x32_bf16 v[36:39], v[164:167], v[56:59], v[36:39]
    s_call_b64 s[60:61], SM4
    v_mfma_f32_16x16x32_bf16 v[16:19], v[24:27], v[72:75], v[16:19]
    v_mfma_f32_16x16x32_bf16 v[20:23], v[24:27], v[76:79], v[20:23]
    v_mfma_f32_16x16x32_bf16 v[16:19], v[28:31], v[88:91], v[16:19]
    v_mfma_f32_16x16x32_bf16 v[20:23], v[28:31], v[92:95], v[20:23]
    v_mfma_f32_16x16x32_bf16 v[16:19], v[32:35], v[104:107], v[16:19]
    v_mfma_f32_16x16x32_bf16 v[20:23], v[32:35], v[108:111], v[20:23]
    v_mfma_f32_16x16x32_bf16 v[16:19], v[36:39], v[168:171], v[16:19]
    v_mfma_f32_16x16x32_bf16 v[20:23], v[36:39], v[172:175], v[20:23]
    s_nop 3
    v_add_u32 v49, 65536, v62
    ds_read_b128 v[64:67], v49 offset:16384
    ds_read_b128 v[68:71], v49 offset:17408
    ds_read_b128 v[72:75], v49 offset:18432
    ds_read_b128 v[76:79], v49 offset:19456
    v_add_u32 v49, 65536, v62
    ds_read_b128 v[80:83], v49 offset:32768
    ds_read_b128 v[84:87], v49 offset:33792
    ds_read_b128 v[88:91], v49 offset:34816
    ds_read_b128 v[92:95], v49 offset:35840
    v_add_u32 v49, 65536, v62
    ds_read_b128 v[96:99], v49 offset:49152
    ds_read_b128 v[100:103], v49 offset:50176
    ds_read_b128 v[104:107], v49 offset:51200
    ds_read_b128 v[108:111], v49 offset:52224
    v_add_u32 v49, 131072, v62
    ds_read_b128 v[160:163], v49 offset:0
    ds_read_b128 v[164:167], v49 offset:1024
    ds_read_b128 v[168:171], v49 offset:2048
    ds_read_b128 v[172:175], v49 offset:3072
    v_mfma_f32_16x16x32_bf16 v[24:27], v[176:179], v[52:55], 0
    v_mfma_f32_16x16x32_bf16 v[24:27], v[180:183], v[56:59], v[24:27]
    s_call_b64 s[60:61], SM1
    v_mfma_f32_16x16x32_bf16 v[16:19], v[24:27], v[184:187], v[16:19]
    v_mfma_f32_16x16x32_bf16 v[20:23], v[24:27], v[188:191], v[20:23]
    s_waitcnt lgkmcnt(0)
    v_mfma_f32_16x16x32_bf16 v[24:27], v[64:67], v[52:55], 0
    v_mfma_f32_16x16x32_bf16 v[28:31], v[80:83], v[52:55], 0
    v_mfma_f32_16x16x32_bf16 v[32:35], v[96:99], v[52:55], 0
    v_mfma_f32_16x16x32_bf16 v[36:39], v[160:163], v[52:55], 0
    v_mfma_f32_16x16x32_bf16 v[24:27], v[68:71], v[56:59], v[24:27]
    v_mfma_f32_16x16x32_bf16 v[28:31], v[84:87], v[56:59], v[28:31]
    v_mfma_f32_16x16x32_bf16 v[32:35], v[100:103], v[56:59], v[32:35]
    v_mfma_f32_16x16x32_bf16 v[36:39], v[164:167], v[56:59], v[36:39]
    s_call_b64 s[60:61], SM4
    v_mfma_f32_16x16x32_bf16 v[16:19], v[24:27], v[72:75], v[16:19]
    v_mfma_f32_16x16x32_bf16 v[20:23], v[24:27], v[76:79], v[20:23]
    v_mfma_f32_16x16x32_bf16 v[16:19], v[28:31], v[88:91], v[16:19]
    v_mfma_f32_16x16x32_bf16 v[20:23], v[28:31], v[92:95], v[20:23]
    v_mfma_f32_16x16x32_bf16 v[16:19], v[32:35], v[104:107], v[16:19]
    v_mfma_f32_16x16x32_bf16 v[20:23], v[32:35], v[108:111], v[20:23]
    v_mfma_f32_16x16x32_bf16 v[16:19], v[36:39], v[168:171], v[16:19]
    v_mfma_f32_16x16x32_bf16 v[20:23], v[36:39], v[172:175], v[20:23]
    s_xor_b32 s57, s56, 2048
    buffer_load_dwordx4 a[32:35], v2, s[4:7], s57 offen offset:0 nt
    buffer_load_dwordx4 a[36:39], v2, s[4:7], s57 offen offset:256 nt
    buffer_load_dwordx4 a[40:43], v3, s[8:11], s57 offen offset:0 nt
    buffer_load_dwordx4 a[44:47], v3, s[8:11], s57 offen offset:256 nt
    s_cmp_ge_u32 s67, 8
    s_cbranch_scc1 Lnx_34
    s_waitcnt vmcnt(16)
    v_mfma_f32_16x16x32_bf16 v[24:27], v[224:227], v[52:55], 0
    v_mfma_f32_16x16x32_bf16 v[24:27], v[228:231], v[56:59], v[24:27]
    s_call_b64 s[60:61], SM1
    v_mfma_f32_16x16x32_bf16 v[16:19], v[24:27], v[232:235], v[16:19]
    v_mfma_f32_16x16x32_bf16 v[20:23], v[24:27], v[236:239], v[20:23]
Lnx_34:
    s_mov_b32 s96, 156160
    s_call_b64 s[60:61], REC
    s_waitcnt vmcnt(28)
    s_waitcnt vmcnt(24)
    s_waitcnt vmcnt(22)
    s_add_u32 s100, s92, 0x6000
    s_branch Lchk_37
Lretry_36:
    buffer_load_dwordx4 v[8:11], v60, s[12:15], s100 offen offset:0 sc1
    buffer_load_dwordx4 v[12:15], v60, s[12:15], s100 offen offset:256 sc1
    s_waitcnt vmcnt(0)
Lchk_37:
    v_max_u32 v61, v8, v9
    v_max3_u32 v61, v61, v10, v11
    v_max3_u32 v61, v61, v12, v13
    v_max3_u32 v61, v61, v14, v15
    v_cmp_eq_u32 vcc, -1, v61
    s_cbranch_vccz Lok_35
    s_sub_u32 s93, s93, 1
    s_cbranch_scc1 L_end
    s_branch Lretry_36
Lok_35:
    s_waitcnt vmcnt(8)
    s_xor_b32 s57, s56, 4096
    buffer_load_dwordx4 a[48:51], v2, s[4:7], s57 offen offset:0 nt
    buffer_load_dwordx4 a[52:55], v2, s[4:7], s57 offen offset:256 nt
    buffer_load_dwordx4 a[56:59], v3, s[8:11], s57 offen offset:0 nt
    buffer_load_dwordx4 a[60:63], v3, s[8:11], s57 offen offset:256 nt
    v_mfma_f32_16x16x32_bf16 v[24:27], a[112:115], v[8:11], 0
    v_mfma_f32_16x16x32_bf16 v[28:31], a[96:99], v[8:11], 0
    v_mfma_f32_16x16x32_bf16 v[32:35], a[128:131], v[8:11], 0
    v_mfma_f32_16x16x32_bf16 v[36:39], a[0:3], v[8:11], 0
    v_mfma_f32_16x16x32_bf16 v[24:27], a[116:119], v[12:15], v[24:27]
    v_mfma_f32_16x16x32_bf16 v[28:31], a[100:103], v[12:15], v[28:31]
    v_mfma_f32_16x16x32_bf16 v[32:35], a[132:135], v[12:15], v[32:35]
    v_mfma_f32_16x16x32_bf16 v[36:39], a[4:7], v[12:15], v[36:39]
    s_call_b64 s[60:61], SM4
    v_mfma_f32_16x16x32_bf16 v[16:19], v[24:27], a[120:123], v[16:19]
    v_mfma_f32_16x16x32_bf16 v[20:23], v[24:27], a[124:127], v[20:23]
    v_mfma_f32_16x16x32_bf16 v[16:19], v[28:31], a[104:107], v[16:19]
    v_mfma_f32_16x16x32_bf16 v[20:23], v[28:31], a[108:111], v[20:23]
    v_mfma_f32_16x16x32_bf16 v[16:19], v[32:35], a[136:139], v[16:19]
    v_mfma_f32_16x16x32_bf16 v[20:23], v[32:35], a[140:143], v[20:23]
    v_mfma_f32_16x16x32_bf16 v[16:19], v[36:39], a[8:11], v[16:19]
    v_mfma_f32_16x16x32_bf16 v[20:23], v[36:39], a[12:15], v[20:23]
    v_add_u32 v49, 65536, v62
    ds_write_b128 v49, a[112:115] offset:16384
    ds_write_b128 v49, a[116:119] offset:17408
    ds_write_b128 v49, a[120:123] offset:18432
    ds_write_b128 v49, a[124:127] offset:19456
    v_add_u32 v49, 65536, v62
    ds_write_b128 v49, a[96:99] offset:32768
    ds_write_b128 v49, a[100:103] offset:33792
    ds_write_b128 v49, a[104:107] offset:34816
    ds_write_b128 v49, a[108:111] offset:35840
    v_add_u32 v49, 65536, v62
    ds_write_b128 v49, a[128:131] offset:49152
    ds_write_b128 v49, a[132:135] offset:50176
    ds_write_b128 v49, a[136:139] offset:51200
    ds_write_b128 v49, a[140:143] offset:52224
    v_add_u32 v49, 131072, v62
    ds_write_b128 v49, a[0:3] offset:0
    ds_write_b128 v49, a[4:7] offset:1024
    ds_write_b128 v49, a[8:11] offset:2048
    ds_write_b128 v49, a[12:15] offset:3072
    s_waitcnt lgkmcnt(0)
    s_cmp_ge_u32 s66, 8
    s_cbranch_scc1 Lnx_38
    v_mfma_f32_16x16x32_bf16 v[24:27], v[240:243], v[8:11], 0
    v_mfma_f32_16x16x32_bf16 v[24:27], v[244:247], v[12:15], v[24:27]
    s_call_b64 s[60:61], SM1
    v_mfma_f32_16x16x32_bf16 v[16:19], v[24:27], v[248:251], v[16:19]
    v_mfma_f32_16x16x32_bf16 v[20:23], v[24:27], v[252:255], v[20:23]
Lnx_38:
    s_waitcnt vmcnt(8)
    s_xor_b32 s57, s56, 6144
    buffer_load_dwordx4 a[208:211], v2, s[4:7], s57 offen offset:0 nt
    buffer_load_dwordx4 a[212:215], v2, s[4:7], s57 offen offset:256 nt
    buffer_load_dwordx4 a[216:219], v3, s[8:11], s57 offen offset:0 nt
    buffer_load_dwordx4 a[220:223], v3, s[8:11], s57 offen offset:256 nt
    s_waitcnt vmcnt(8)
    s_add_u32 s56, s86, 0x6000000
    buffer_load_dwordx4 a[64:67], v2, s[4:7], s56 offen offset:0 nt
    buffer_load_dwordx4 a[68:71], v2, s[4:7], s56 offen offset:256 nt
    buffer_load_dwordx4 a[72:75], v3, s[8:11], s56 offen offset:0 nt
    buffer_load_dwordx4 a[76:79], v3, s[8:11], s56 offen offset:256 nt
    s_waitcnt vmcnt(8)
    s_xor_b32 s57, s56, 2048
    buffer_load_dwordx4 v[176:179], v2, s[4:7], s57 offen offset:0 nt
    buffer_load_dwordx4 v[180:183], v2, s[4:7], s57 offen offset:256 nt
    buffer_load_dwordx4 v[184:187], v3, s[8:11], s57 offen offset:0 nt
    buffer_load_dwordx4 v[188:191], v3, s[8:11], s57 offen offset:256 nt
    s_waitcnt vmcnt(8)
    s_xor_b32 s57, s56, 4096
    buffer_load_dwordx4 v[64:67], v2, s[4:7], s57 offen offset:0 nt
    buffer_load_dwordx4 v[68:71], v2, s[4:7], s57 offen offset:256 nt
    buffer_load_dwordx4 v[72:75], v3, s[8:11], s57 offen offset:0 nt
    buffer_load_dwordx4 v[76:79], v3, s[8:11], s57 offen offset:256 nt
    v_mfma_f32_16x16x32_bf16 v[24:27], a[16:19], v[8:11], 0
    v_mfma_f32_16x16x32_bf16 v[28:31], a[32:35], v[8:11], 0
    v_mfma_f32_16x16x32_bf16 v[32:35], a[48:51], v[8:11], 0
    v_mfma_f32_16x16x32_bf16 v[36:39], a[208:211], v[8:11], 0
    v_mfma_f32_16x16x32_bf16 v[24:27], a[20:23], v[12:15], v[24:27]
    v_mfma_f32_16x16x32_bf16 v[28:31], a[36:39], v[12:15], v[28:31]
    v_mfma_f32_16x16x32_bf16 v[32:35], a[52:55], v[12:15], v[32:35]
    v_mfma_f32_16x16x32_bf16 v[36:39], a[212:215], v[12:15], v[36:39]
    s_call_b64 s[60:61], SM4
    v_mfma_f32_16x16x32_bf16 v[16:19], v[24:27], a[24:27], v[16:19]
    v_mfma_f32_16x16x32_bf16 v[20:23], v[24:27], a[28:31], v[20:23]
    v_mfma_f32_16x16x32_bf16 v[16:19], v[28:31], a[40:43], v[16:19]
    v_mfma_f32_16x16x32_bf16 v[20:23], v[28:31], a[44:47], v[20:23]
    v_mfma_f32_16x16x32_bf16 v[16:19], v[32:35], a[56:59], v[16:19]
    v_mfma_f32_16x16x32_bf16 v[20:23], v[32:35], a[60:63], v[20:23]
    v_mfma_f32_16x16x32_bf16 v[16:19], v[36:39], a[216:219], v[16:19]
    v_mfma_f32_16x16x32_bf16 v[20:23], v[36:39], a[220:223], v[20:23]
    s_waitcnt vmcnt(8)
    s_xor_b32 s57, s56, 6144
    buffer_load_dwordx4 v[80:83], v2, s[4:7], s57 offen offset:0 nt
    buffer_load_dwordx4 v[84:87], v2, s[4:7], s57 offen offset:256 nt
    buffer_load_dwordx4 v[88:91], v3, s[8:11], s57 offen offset:0 nt
    buffer_load_dwordx4 v[92:95], v3, s[8:11], s57 offen offset:256 nt
    s_waitcnt vmcnt(8)
    s_add_u32 s56, s87, 0x6000000
    buffer_load_dwordx4 v[96:99], v2, s[4:7], s56 offen offset:0 nt
    buffer_load_dwordx4 v[100:103], v2, s[4:7], s56 offen offset:256 nt
    buffer_load_dwordx4 v[104:107], v3, s[8:11], s56 offen offset:0 nt
    buffer_load_dwordx4 v[108:111], v3, s[8:11], s56 offen offset:256 nt
    s_waitcnt vmcnt(8)
    s_xor_b32 s57, s56, 2048
    buffer_load_dwordx4 v[160:163], v2, s[4:7], s57 offen offset:0 nt
    buffer_load_dwordx4 v[164:167], v2, s[4:7], s57 offen offset:256 nt
    buffer_load_dwordx4 v[168:171], v3, s[8:11], s57 offen offset:0 nt
    buffer_load_dwordx4 v[172:175], v3, s[8:11], s57 offen offset:256 nt
    s_waitcnt vmcnt(8)
    s_xor_b32 s57, s56, 4096
    buffer_load_dwordx4 v[224:227], v2, s[4:7], s57 offen offset:0 nt
    buffer_load_dwordx4 v[228:231], v2, s[4:7], s57 offen offset:256 nt
    buffer_load_dwordx4 v[232:235], v3, s[8:11], s57 offen offset:0 nt
    buffer_load_dwordx4 v[236:239], v3, s[8:11], s57 offen offset:256 nt
    v_mfma_f32_16x16x32_bf16 v[24:27], a[64:67], v[8:11], 0
    v_mfma_f32_16x16x32_bf16 v[28:31], v[176:179], v[8:11], 0
    v_mfma_f32_16x16x32_bf16 v[32:35], v[64:67], v[8:11], 0
    v_mfma_f32_16x16x32_bf16 v[36:39], v[80:83], v[8:11], 0
    v_mfma_f32_16x16x32_bf16 v[24:27], a[68:71], v[12:15], v[24:27]
    v_mfma_f32_16x16x32_bf16 v[28:31], v[180:183], v[12:15], v[28:31]
    v_mfma_f32_16x16x32_bf16 v[32:35], v[68:71], v[12:15], v[32:35]
    v_mfma_f32_16x16x32_bf16 v[36:39], v[84:87], v[12:15], v[36:39]
    s_call_b64 s[60:61], SM4
    v_mfma_f32_16x16x32_bf16 v[16:19], v[24:27], a[72:75], v[16:19]
    v_mfma_f32_16x16x32_bf16 v[20:23], v[24:27], a[76:79], v[20:23]
    v_mfma_f32_16x16x32_bf16 v[16:19], v[28:31], v[184:187], v[16:19]
    v_mfma_f32_16x16x32_bf16 v[20:23], v[28:31], v[188:191], v[20:23]
    v_mfma_f32_16x16x32_bf16 v[16:19], v[32:35], v[72:75], v[16:19]
    v_mfma_f32_16x16x32_bf16 v[20:23], v[32:35], v[76:79], v[20:23]
    v_mfma_f32_16x16x32_bf16 v[16:19], v[36:39], v[88:91], v[16:19]
    v_mfma_f32_16x16x32_bf16 v[20:23], v[36:39], v[92:95], v[20:23]
    s_waitcnt vmcnt(8)
    s_xor_b32 s57, s56, 6144
    buffer_load_dwordx4 a[112:115], v2, s[4:7], s57 offen offset:0 nt
    buffer_load_dwordx4 a[116:119], v2, s[4:7], s57 offen offset:256 nt
    buffer_load_dwordx4 a[120:123], v3, s[8:11], s57 offen offset:0 nt
    buffer_load_dwordx4 a[124:127], v3, s[8:11], s57 offen offset:256 nt
    s_waitcnt vmcnt(8)
    s_add_u32 s56, s59, 0x6000000
    buffer_load_dwordx4 a[96:99], v2, s[4:7], s56 offen offset:0 nt
    buffer_load_dwordx4 a[100:103], v2, s[4:7], s56 offen offset:256 nt
    buffer_load_dwordx4 a[104:107], v3, s[8:11], s56 offen offset:0 nt
    buffer_load_dwordx4 a[108:111], v3, s[8:11], s56 offen offset:256 nt
    s_waitcnt vmcnt(8)
    s_add_u32 s56, s84, 0x8000000
    buffer_load_dwordx4 a[128:131], v2, s[4:7], s56 offen offset:0 nt
    buffer_load_dwordx4 a[132:135], v2, s[4:7], s56 offen offset:256 nt
    buffer_load_dwordx4 a[136:139], v3, s[8:11], s56 offen offset:0 nt
    buffer_load_dwordx4 a[140:143], v3, s[8:11], s56 offen offset:256 nt
    s_waitcnt vmcnt(8)
    s_add_u32 s94, s92, 0x14000
    buffer_load_dwordx4 v[52:55], v60, s[12:15], s94 offen offset:0 sc1
    buffer_load_dwordx4 v[56:59], v60, s[12:15], s94 offen offset:256 sc1
    s_xor_b32 s57, s56, 2048
    buffer_load_dwordx4 a[0:3], v2, s[4:7], s57 offen offset:0 nt
    buffer_load_dwordx4 a[4:7], v2, s[4:7], s57 offen offset:256 nt
    buffer_load_dwordx4 a[8:11], v3, s[8:11], s57 offen offset:0 nt
    buffer_load_dwordx4 a[12:15], v3, s[8:11], s57 offen offset:256 nt
    v_mfma_f32_16x16x32_bf16 v[24:27], v[96:99], v[8:11], 0
    v_mfma_f32_16x16x32_bf16 v[28:31], v[160:163], v[8:11], 0
    v_mfma_f32_16x16x32_bf16 v[32:35], v[224:227], v[8:11], 0
    v_mfma_f32_16x16x32_bf16 v[36:39], a[112:115], v[8:11], 0
    v_mfma_f32_16x16x32_bf16 v[24:27], v[100:103], v[12:15], v[24:27]
    v_mfma_f32_16x16x32_bf16 v[28:31], v[164:167], v[12:15], v[28:31]
    v_mfma_f32_16x16x32_bf16 v[32:35], v[228:231], v[12:15], v[32:35]
    v_mfma_f32_16x16x32_bf16 v[36:39], a[116:119], v[12:15], v[36:39]
    s_call_b64 s[60:61], SM4
    v_mfma_f32_16x16x32_bf16 v[16:19], v[24:27], v[104:107], v[16:19]
    v_mfma_f32_16x16x32_bf16 v[20:23], v[24:27], v[108:111], v[20:23]
    v_mfma_f32_16x16x32_bf16 v[16:19], v[28:31], v[168:171], v[16:19]
    v_mfma_f32_16x16x32_bf16 v[20:23], v[28:31], v[172:175], v[20:23]
    v_mfma_f32_16x16x32_bf16 v[16:19], v[32:35], v[232:235], v[16:19]
    v_mfma_f32_16x16x32_bf16 v[20:23], v[32:35], v[236:239], v[20:23]
    v_mfma_f32_16x16x32_bf16 v[16:19], v[36:39], a[120:123], v[16:19]
    v_mfma_f32_16x16x32_bf16 v[20:23], v[36:39], a[124:127], v[20:23]
    s_waitcnt vmcnt(10)
    s_xor_b32 s57, s56, 4096
    buffer_load_dwordx4 v[240:243], v2, s[4:7], s57 offen offset:0 nt
    buffer_load_dwordx4 v[244:247], v2, s[4:7], s57 offen offset:256 nt
    buffer_load_dwordx4 v[248:251], v3, s[8:11], s57 offen offset:0 nt
    buffer_load_dwordx4 v[252:255], v3, s[8:11], s57 offen offset:256 nt
    v_mfma_f32_16x16x32_bf16 v[24:27], a[96:99], v[8:11], 0
    v_mfma_f32_16x16x32_bf16 v[24:27], a[100:103], v[12:15], v[24:27]
    s_call_b64 s[60:61], SM1
    v_mfma_f32_16x16x32_bf16 v[16:19], v[24:27], a[104:107], v[16:19]
    v_mfma_f32_16x16x32_bf16 v[20:23], v[24:27], a[108:111], v[20:23]
    s_add_u32 s94, s92, 0x8000
    buffer_load_dwordx4 v[8:11], v60, s[12:15], s94 offen offset:0 sc1
    buffer_load_dwordx4 v[12:15], v60, s[12:15], s94 offen offset:256 sc1
    s_mov_b32 s69, 3
    s_mov_b32 s95, 160516
    s_call_b64 s[60:61], WDN
    s_mov_b32 s96, 147456
    s_call_b64 s[60:61], REC
    s_call_b64 s[60:61], ARR
    s_cmp_eq_u32 s94, 3
    s_cbranch_scc1 Lal_39
    s_cmp_eq_u32 s94, 0
    s_cbranch_scc1 Laf_40
    s_mov_b32 s56, 0x40000000
    s_mov_b32 s57, 0x40000000
    s_call_b64 s[60:61], MST
    s_branch Lad_41
Laf_40:
    s_mov_b32 s96, 151808
    s_add_u32 s56, s90, 0x200000
    s_add_u32 s57, s91, 0x80000
    s_call_b64 s[60:61], MRG
    v_mov_b32 v32, 160520
    v_mov_b32 v33, 4
    ds_write_b32 v32, v33
    s_branch Lad_41
Lal_39:
    s_mov_b32 s96, 147456
    s_add_u32 s56, s90, 0xc0000
    s_add_u32 s57, s91, 0x30000
    s_call_b64 s[60:61], MRG
    v_mov_b32 v32, 160516
    v_mov_b32 v33, 4
    ds_write_b32 v32, v33
Lad_41:
    s_waitcnt vmcnt(14)
    s_waitcnt vmcnt(12)
    s_add_u32 s100, s92, 0x14000
    s_branch Lchk_45
Lretry_44:
    buffer_load_dwordx4 v[52:55], v60, s[12:15], s100 offen offset:0 sc1
    buffer_load_dwordx4 v[56:59], v60, s[12:15], s100 offen offset:256 sc1
    s_waitcnt vmcnt(0)
Lchk_45:
    v_max_u32 v61, v52, v53
    v_max3_u32 v61, v61, v54, v55
    v_max3_u32 v61, v61, v56, v57
    v_max3_u32 v61, v61, v58, v59
    v_cmp_eq_u32 vcc, -1, v61
    s_cbranch_vccz Lok_43
    s_sub_u32 s93, s93, 1
    s_cbranch_scc1 L_end
    s_branch Lretry_44
Lok_43:
Lqok_42:
    v_mfma_f32_16x16x32_bf16 v[24:27], a[144:147], v[52:55], 0
    v_mfma_f32_16x16x32_bf16 v[28:31], a[160:163], v[52:55], 0
    v_mfma_f32_16x16x32_bf16 v[32:35], a[176:179], v[52:55], 0
    v_mfma_f32_16x16x32_bf16 v[36:39], a[192:195], v[52:55], 0
    v_mfma_f32_16x16x32_bf16 v[24:27], a[148:151], v[56:59], v[24:27]
    v_mfma_f32_16x16x32_bf16 v[28:31], a[164:167], v[56:59], v[28:31]
    v_mfma_f32_16x16x32_bf16 v[32:35], a[180:183], v[56:59], v[32:35]
    v_mfma_f32_16x16x32_bf16 v[36:39], a[196:199], v[56:59], v[36:39]
    s_call_b64 s[60:61], SM4
    v_mfma_f32_16x16x32_bf16 v[16:19], v[24:27], a[152:155], v[16:19]
    v_mfma_f32_16x16x32_bf16 v[20:23], v[24:27], a[156:159], v[20:23]
    v_mfma_f32_16x16x32_bf16 v[16:19], v[28:31], a[168:171], v[16:19]
    v_mfma_f32_16x16x32_bf16 v[20:23], v[28:31], a[172:175], v[20:23]
    v_mfma_f32_16x16x32_bf16 v[16:19], v[32:35], a[184:187], v[16:19]
    v_mfma_f32_16x16x32_bf16 v[20:23], v[32:35], a[188:191], v[20:23]
    v_mfma_f32_16x16x32_bf16 v[16:19], v[36:39], a[200:203], v[16:19]
    v_mfma_f32_16x16x32_bf16 v[20:23], v[36:39], a[204:207], v[20:23]
    s_sub_u32 s67, s54, 80
    s_lshl_b32 s94, s67, 11
    s_add_u32 s94, s94, s68
    s_add_u32 s94, s94, 0x4000000
    s_cmp_lt_u32 s67, 8
    s_cselect_b32 s94, s94, 0x40000000
    buffer_load_dwordx4 a[144:147], v2, s[4:7], s94 offen offset:0 nt
    buffer_load_dwordx4 a[148:151], v2, s[4:7], s94 offen offset:256 nt
    buffer_load_dwordx4 a[152:155], v3, s[8:11], s94 offen offset:0 nt
    buffer_load_dwordx4 a[156:159], v3, s[8:11], s94 offen offset:256 nt
    s_sub_u32 s66, s54, 32
    s_lshl_b32 s94, s66, 11
    s_add_u32 s94, s94, s68
    s_add_u32 s94, s94, 0x8000000
    s_cmp_lt_u32 s66, 8
    s_cselect_b32 s94, s94, 0x40000000
    buffer_load_dwordx4 a[160:163], v2, s[4:7], s94 offen offset:0 nt
    buffer_load_dwordx4 a[164:167], v2, s[4:7], s94 offen offset:256 nt
    buffer_load_dwordx4 a[168:171], v3, s[8:11], s94 offen offset:0 nt
    buffer_load_dwordx4 a[172:175], v3, s[8:11], s94 offen offset:256 nt
    s_add_u32 s56, s84, 0x8000000
    s_xor_b32 s57, s56, 6144
    buffer_load_dwordx4 a[176:179], v2, s[4:7], s57 offen offset:0 nt
    buffer_load_dwordx4 a[180:183], v2, s[4:7], s57 offen offset:256 nt
    buffer_load_dwordx4 a[184:187], v3, s[8:11], s57 offen offset:0 nt
    buffer_load_dwordx4 a[188:191], v3, s[8:11], s57 offen offset:256 nt
    v_mfma_f32_16x16x32_bf16 v[24:27], a[240:243], v[52:55], 0
    v_mfma_f32_16x16x32_bf16 v[28:31], v[112:115], v[52:55], 0
    v_mfma_f32_16x16x32_bf16 v[32:35], v[144:147], v[52:55], 0
    v_mfma_f32_16x16x32_bf16 v[36:39], a[224:227], v[52:55], 0
    v_mfma_f32_16x16x32_bf16 v[24:27], a[244:247], v[56:59], v[24:27]
    v_mfma_f32_16x16x32_bf16 v[28:31], v[116:119], v[56:59], v[28:31]
    v_mfma_f32_16x16x32_bf16 v[32:35], v[148:151], v[56:59], v[32:35]
    v_mfma_f32_16x16x32_bf16 v[36:39], a[228:231], v[56:59], v[36:39]
    s_call_b64 s[60:61], SM4
    v_mfma_f32_16x16x32_bf16 v[16:19], v[24:27], a[248:251], v[16:19]
    v_mfma_f32_16x16x32_bf16 v[20:23], v[24:27], a[252:255], v[20:23]
    v_mfma_f32_16x16x32_bf16 v[16:19], v[28:31], v[120:123], v[16:19]
    v_mfma_f32_16x16x32_bf16 v[20:23], v[28:31], v[124:127], v[20:23]
    v_mfma_f32_16x16x32_bf16 v[16:19], v[32:35], v[152:155], v[16:19]
    v_mfma_f32_16x16x32_bf16 v[20:23], v[32:35], v[156:159], v[20:23]
    v_mfma_f32_16x16x32_bf16 v[16:19], v[36:39], a[232:235], v[16:19]
    v_mfma_f32_16x16x32_bf16 v[20:23], v[36:39], a[236:239], v[20:23]
    s_add_u32 s56, s85, 0x8000000
    buffer_load_dwordx4 a[192:195], v2, s[4:7], s56 offen offset:0 nt
    buffer_load_dwordx4 a[196:199], v2, s[4:7], s56 offen offset:256 nt
    buffer_load_dwordx4 a[200:203], v3, s[8:11], s56 offen offset:0 nt
    buffer_load_dwordx4 a[204:207], v3, s[8:11], s56 offen offset:256 nt
    v_mfma_f32_16x16x32_bf16 v[24:27], a[80:83], v[52:55], 0
    v_mfma_f32_16x16x32_bf16 v[28:31], v[192:195], v[52:55], 0
    v_mfma_f32_16x16x32_bf16 v[32:35], v[208:211], v[52:55], 0
    v_mfma_f32_16x16x32_bf16 v[36:39], v[128:131], v[52:55], 0
    v_mfma_f32_16x16x32_bf16 v[24:27], a[84:87], v[56:59], v[24:27]
    v_mfma_f32_16x16x32_bf16 v[28:31], v[196:199], v[56:59], v[28:31]
    v_mfma_f32_16x16x32_bf16 v[32:35], v[212:215], v[56:59], v[32:35]
    v_mfma_f32_16x16x32_bf16 v[36:39], v[132:135], v[56:59], v[36:39]
    s_call_b64 s[60:61], SM4
    v_mfma_f32_16x16x32_bf16 v[16:19], v[24:27], a[88:91], v[16:19]
    v_mfma_f32_16x16x32_bf16 v[20:23], v[24:27], a[92:95], v[20:23]
    v_mfma_f32_16x16x32_bf16 v[16:19], v[28:31], v[200:203], v[16:19]
    v_mfma_f32_16x16x32_bf16 v[20:23], v[28:31], v[204:207], v[20:23]
    v_mfma_f32_16x16x32_bf16 v[16:19], v[32:35], v[216:219], v[16:19]
    v_mfma_f32_16x16x32_bf16 v[20:23], v[32:35], v[220:223], v[20:23]
    v_mfma_f32_16x16x32_bf16 v[16:19], v[36:39], v[136:139], v[16:19]
    v_mfma_f32_16x16x32_bf16 v[20:23], v[36:39], v[140:143], v[20:23]
    s_nop 3
    ds_read_b128 a[80:83], v62 offset:0
    ds_read_b128 a[84:87], v62 offset:1024
    ds_read_b128 a[88:91], v62 offset:2048
    ds_read_b128 a[92:95], v62 offset:3072
    ds_read_b128 v[192:195], v62 offset:16384
    ds_read_b128 v[196:199], v62 offset:17408
    ds_read_b128 v[200:203], v62 offset:18432
    ds_read_b128 v[204:207], v62 offset:19456
    ds_read_b128 v[208:211], v62 offset:32768
    ds_read_b128 v[212:215], v62 offset:33792
    ds_read_b128 v[216:219], v62 offset:34816
    ds_read_b128 v[220:223], v62 offset:35840
    ds_read_b128 v[128:131], v62 offset:49152
    ds_read_b128 v[132:135], v62 offset:50176
    ds_read_b128 v[136:139], v62 offset:51200
    ds_read_b128 v[140:143], v62 offset:52224
    s_waitcnt lgkmcnt(0)
    v_mfma_f32_16x16x32_bf16 v[24:27], a[80:83], v[52:55], 0
    v_mfma_f32_16x16x32_bf16 v[28:31], v[192:195], v[52:55], 0
    v_mfma_f32_16x16x32_bf16 v[32:35], v[208:211], v[52:55], 0
    v_mfma_f32_16x16x32_bf16 v[36:39], v[128:131], v[52:55], 0
    v_mfma_f32_16x16x32_bf16 v[24:27], a[84:87], v[56:59], v[24:27]
    v_mfma_f32_16x16x32_bf16 v[28:31], v[196:199], v[56:59], v[28:31]
    v_mfma_f32_16x16x32_bf16 v[32:35], v[212:215], v[56:59], v[32:35]
    v_mfma_f32_16x16x32_bf16 v[36:39], v[132:135], v[56:59], v[36:39]
    s_call_b64 s[60:61], SM4
    v_mfma_f32_16x16x32_bf16 v[16:19], v[24:27], a[88:91], v[16:19]
    v_mfma_f32_16x16x32_bf16 v[20:23], v[24:27], a[92:95], v[20:23]
    v_mfma_f32_16x16x32_bf16 v[16:19], v[28:31], v[200:203], v[16:19]
    v_mfma_f32_16x16x32_bf16 v[20:23], v[28:31], v[204:207], v[20:23]
    v_mfma_f32_16x16x32_bf16 v[16:19], v[32:35], v[216:219], v[16:19]
    v_mfma_f32_16x16x32_bf16 v[20:23], v[32:35], v[220:223], v[20:23]
    v_mfma_f32_16x16x32_bf16 v[16:19], v[36:39], v[136:139], v[16:19]
    v_mfma_f32_16x16x32_bf16 v[20:23], v[36:39], v[140:143], v[20:23]
    s_nop 3
    v_add_u32 v49, 65536, v62
    ds_read_b128 a[80:83], v49 offset:0
    ds_read_b128 a[84:87], v49 offset:1024
    ds_read_b128 a[88:91], v49 offset:2048
    ds_read_b128 a[92:95], v49 offset:3072
    s_xor_b32 s57, s56, 2048
    buffer_load_dwordx4 a[240:243], v2, s[4:7], s57 offen offset:0 nt
    buffer_load_dwordx4 a[244:247], v2, s[4:7], s57 offen offset:256 nt
    buffer_load_dwordx4 a[248:251], v3, s[8:11], s57 offen offset:0 nt
    buffer_load_dwordx4 a[252:255], v3, s[8:11], s57 offen offset:256 nt
    s_waitcnt lgkmcnt(0)
    v_mfma_f32_16x16x32_bf16 v[24:27], a[80:83], v[52:55], 0
    v_mfma_f32_16x16x32_bf16 v[24:27], a[84:87], v[56:59], v[24:27]
    s_call_b64 s[60:61], SM1
    v_mfma_f32_16x16x32_bf16 v[16:19], v[24:27], a[88:91], v[16:19]
    v_mfma_f32_16x16x32_bf16 v[20:23], v[24:27], a[92:95], v[20:23]
    s_cmp_ge_u32 s67, 8
    s_cbranch_scc1 Lnx_46
    s_waitcnt vmcnt(16)
    v_mfma_f32_16x16x32_bf16 v[24:27], a[144:147], v[52:55], 0
    v_mfma_f32_16x16x32_bf16 v[24:27], a[148:151], v[56:59], v[24:27]
    s_call_b64 s[60:61], SM1
    v_mfma_f32_16x16x32_bf16 v[16:19], v[24:27], a[152:155], v[16:19]
    v_mfma_f32_16x16x32_bf16 v[20:23], v[24:27], a[156:159], v[20:23]
Lnx_46:
    s_mov_b32 s69, 4
    s_mov_b32 s95, 160520
    s_call_b64 s[60:61], WDN
    s_mov_b32 s96, 151808
    s_call_b64 s[60:61], REC
    s_waitcnt vmcnt(28)
    s_waitcnt vmcnt(24)
    s_waitcnt vmcnt(22)
    s_add_u32 s100, s92, 0x8000
    s_branch Lchk_49
Lretry_48:
    buffer_load_dwordx4 v[8:11], v60, s[12:15], s100 offen offset:0 sc1
    buffer_load_dwordx4 v[12:15], v60, s[12:15], s100 offen offset:256 sc1
    s_waitcnt vmcnt(0)
Lchk_49:
    v_max_u32 v61, v8, v9
    v_max3_u32 v61, v61, v10, v11
    v_max3_u32 v61, v61, v12, v13
    v_max3_u32 v61, v61, v14, v15
    v_cmp_eq_u32 vcc, -1, v61
    s_cbranch_vccz Lok_47
    s_sub_u32 s93, s93, 1
    s_cbranch_scc1 L_end
    s_branch Lretry_48
Lok_47:
    s_waitcnt vmcnt(8)
    s_xor_b32 s57, s56, 4096
    buffer_load_dwordx4 v[112:115], v2, s[4:7], s57 offen offset:0 nt
    buffer_load_dwordx4 v[116:119], v2, s[4:7], s57 offen offset:256 nt
    buffer_load_dwordx4 v[120:123], v3, s[8:11], s57 offen offset:0 nt
    buffer_load_dwordx4 v[124:127], v3, s[8:11], s57 offen offset:256 nt
    v_mfma_f32_16x16x32_bf16 v[24:27], a[128:131], v[8:11], 0
    v_mfma_f32_16x16x32_bf16 v[28:31], a[0:3], v[8:11], 0
    v_mfma_f32_16x16x32_bf16 v[32:35], v[240:243], v[8:11], 0
    v_mfma_f32_16x16x32_bf16 v[36:39], a[176:179], v[8:11], 0
    v_mfma_f32_16x16x32_bf16 v[24:27], a[132:135], v[12:15], v[24:27]
    v_mfma_f32_16x16x32_bf16 v[28:31], a[4:7], v[12:15], v[28:31]
    v_mfma_f32_16x16x32_bf16 v[32:35], v[244:247], v[12:15], v[32:35]
    v_mfma_f32_16x16x32_bf16 v[36:39], a[180:183], v[12:15], v[36:39]
    s_call_b64 s[60:61], SM4
    v_mfma_f32_16x16x32_bf16 v[16:19], v[24:27], a[136:139], v[16:19]
    v_mfma_f32_16x16x32_bf16 v[20:23], v[24:27], a[140:143], v[20:23]
    v_mfma_f32_16x16x32_bf16 v[16:19], v[28:31], a[8:11], v[16:19]
    v_mfma_f32_16x16x32_bf16 v[20:23], v[28:31], a[12:15], v[20:23]
    v_mfma_f32_16x16x32_bf16 v[16:19], v[32:35], v[248:251], v[16:19]
    v_mfma_f32_16x16x32_bf16 v[20:23], v[32:35], v[252:255], v[20:23]
    v_mfma_f32_16x16x32_bf16 v[16:19], v[36:39], a[184:187], v[16:19]
    v_mfma_f32_16x16x32_bf16 v[20:23], v[36:39], a[188:191], v[20:23]
    ds_write_b128 v62, a[128:131] offset:0
    ds_write_b128 v62, a[132:135] offset:1024
    ds_write_b128 v62, a[136:139] offset:2048
    ds_write_b128 v62, a[140:143] offset:3072
    ds_write_b128 v62, a[0:3] offset:16384
    ds_write_b128 v62, a[4:7] offset:17408
    ds_write_b128 v62, a[8:11] offset:18432
    ds_write_b128 v62, a[12:15] offset:19456
    ds_write_b128 v62, v[240:243] offset:32768
    ds_write_b128 v62, v[244:247] offset:33792
    ds_write_b128 v62, v[248:251] offset:34816
    ds_write_b128 v62, v[252:255] offset:35840
    ds_write_b128 v62, a[176:179] offset:49152
    ds_write_b128 v62, a[180:183] offset:50176
    ds_write_b128 v62, a[184:187] offset:51200
    ds_write_b128 v62, a[188:191] offset:52224
    s_waitcnt lgkmcnt(0)
    s_cmp_ge_u32 s66, 8
    s_cbranch_scc1 Lnx_50
    v_mfma_f32_16x16x32_bf16 v[24:27], a[160:163], v[8:11], 0
    v_mfma_f32_16x16x32_bf16 v[24:27], a[164:167], v[12:15], v[24:27]
    s_call_b64 s[60:61], SM1
    v_mfma_f32_16x16x32_bf16 v[16:19], v[24:27], a[168:171], v[16:19]
    v_mfma_f32_16x16x32_bf16 v[20:23], v[24:27], a[172:175], v[20:23]
Lnx_50:
    s_waitcnt vmcnt(8)
    s_xor_b32 s57, s56, 6144
    buffer_load_dwordx4 v[144:147], v2, s[4:7], s57 offen offset:0 nt
    buffer_load_dwordx4 v[148:151], v2, s[4:7], s57 offen offset:256 nt
    buffer_load_dwordx4 v[152:155], v3, s[8:11], s57 offen offset:0 nt
    buffer_load_dwordx4 v[156:159], v3, s[8:11], s57 offen offset:256 nt
    s_waitcnt vmcnt(8)
    s_add_u32 s56, s86, 0x8000000
    buffer_load_dwordx4 a[224:227], v2, s[4:7], s56 offen offset:0 nt
    buffer_load_dwordx4 a[228:231], v2, s[4:7], s56 offen offset:256 nt
    buffer_load_dwordx4 a[232:235], v3, s[8:11], s56 offen offset:0 nt
    buffer_load_dwordx4 a[236:239], v3, s[8:11], s56 offen offset:256 nt
    s_waitcnt vmcnt(8)
    s_xor_b32 s57, s56, 2048
    buffer_load_dwordx4 v[192:195], v2, s[4:7], s57 offen offset:0 nt
    buffer_load_dwordx4 v[196:199], v2, s[4:7], s57 offen offset:256 nt
    buffer_load_dwordx4 v[200:203], v3, s[8:11], s57 offen offset:0 nt
    buffer_load_dwordx4 v[204:207], v3, s[8:11], s57 offen offset:256 nt
    s_waitcnt vmcnt(8)
    s_xor_b32 s57, s56, 4096
    buffer_load_dwordx4 v[208:211], v2, s[4:7], s57 offen offset:0 nt
    buffer_load_dwordx4 v[212:215], v2, s[4:7], s57 offen offset:256 nt
    buffer_load_dwordx4 v[216:219], v3, s[8:11], s57 offen offset:0 nt
    buffer_load_dwordx4 v[220:223], v3, s[8:11], s57 offen offset:256 nt
    v_mfma_f32_16x16x32_bf16 v[24:27], a[192:195], v[8:11], 0
    v_mfma_f32_16x16x32_bf16 v[28:31], a[240:243], v[8:11], 0
    v_mfma_f32_16x16x32_bf16 v[32:35], v[112:115], v[8:11], 0
    v_mfma_f32_16x16x32_bf16 v[36:39], v[144:147], v[8:11], 0
    v_mfma_f32_16x16x32_bf16 v[24:27], a[196:199], v[12:15], v[24:27]
    v_mfma_f32_16x16x32_bf16 v[28:31], a[244:247], v[12:15], v[28:31]
    v_mfma_f32_16x16x32_bf16 v[32:35], v[116:119], v[12:15], v[32:35]
    v_mfma_f32_16x16x32_bf16 v[36:39], v[148:151], v[12:15], v[36:39]
    s_call_b64 s[60:61], SM4
    v_mfma_f32_16x16x32_bf16 v[16:19], v[24:27], a[200:203], v[16:19]
    v_mfma_f32_16x16x32_bf16 v[20:23], v[24:27], a[204:207], v[20:23]
    v_mfma_f32_16x16x32_bf16 v[16:19], v[28:31], a[248:251], v[16:19]
    v_mfma_f32_16x16x32_bf16 v[20:23], v[28:31], a[252:255], v[20:23]
    v_mfma_f32_16x16x32_bf16 v[16:19], v[32:35], v[120:123], v[16:19]
    v_mfma_f32_16x16x32_bf16 v[20:23], v[32:35], v[124:127], v[20:23]
    v_mfma_f32_16x16x32_bf16 v[16:19], v[36:39], v[152:155], v[16:19]
    v_mfma_f32_16x16x32_bf16 v[20:23], v[36:39], v[156:159], v[20:23]
    v_add_u32 v49, 65536, v62
    ds_write_b128 v49, a[192:195] offset:0
    ds_write_b128 v49, a[196:199] offset:1024
    ds_write_b128 v49, a[200:203] offset:2048
    ds_write_b128 v49, a[204:207] offset:3072
    s_waitcnt lgkmcnt(0)
    s_waitcnt vmcnt(8)
    s_xor_b32 s57, s56, 6144
    buffer_load_dwordx4 v[128:131], v2, s[4:7], s57 offen offset:0 nt
    buffer_load_dwordx4 v[132:135], v2, s[4:7], s57 offen offset:256 nt
    buffer_load_dwordx4 v[136:139], v3, s[8:11], s57 offen offset:0 nt
    buffer_load_dwordx4 v[140:143], v3, s[8:11], s57 offen offset:256 nt
    s_waitcnt vmcnt(8)
    s_add_u32 s56, s87, 0x8000000
    buffer_load_dwordx4 a[80:83], v2, s[4:7], s56 offen offset:0 nt
    buffer_load_dwordx4 a[84:87], v2, s[4:7], s56 offen offset:256 nt
    buffer_load_dwordx4 a[88:91], v3, s[8:11], s56 offen offset:0 nt
    buffer_load_dwordx4 a[92:95], v3, s[8:11], s56 offen offset:256 nt
    s_waitcnt vmcnt(8)
    s_xor_b32 s57, s56, 2048
    buffer_load_dwordx4 a[144:147], v2, s[4:7], s57 offen offset:0 nt
    buffer_load_dwordx4 a[148:151], v2, s[4:7], s57 offen offset:256 nt
    buffer_load_dwordx4 a[152:155], v3, s[8:11], s57 offen offset:0 nt
    buffer_load_dwordx4 a[156:159], v3, s[8:11], s57 offen offset:256 nt
    s_waitcnt vmcnt(8)
    s_xor_b32 s57, s56, 4096
    buffer_load_dwordx4 a[128:131], v2, s[4:7], s57 offen offset:0 nt
    buffer_load_dwordx4 a[132:135], v2, s[4:7], s57 offen offset:256 nt
    buffer_load_dwordx4 a[136:139], v3, s[8:11], s57 offen offset:0 nt
    buffer_load_dwordx4 a[140:143], v3, s[8:11], s57 offen offset:256 nt
    v_mfma_f32_16x16x32_bf16 v[24:27], a[224:227], v[8:11], 0
    v_mfma_f32_16x16x32_bf16 v[28:31], v[192:195], v[8:11], 0
    v_mfma_f32_16x16x32_bf16 v[32:35], v[208:211], v[8:11], 0
    v_mfma_f32_16x16x32_bf16 v[36:39], v[128:131], v[8:11], 0
    v_mfma_f32_16x16x32_bf16 v[24:27], a[228:231], v[12:15], v[24:27]
    v_mfma_f32_16x16x32_bf16 v[28:31], v[196:199], v[12:15], v[28:31]
    v_mfma_f32_16x16x32_bf16 v[32:35], v[212:215], v[12:15], v[32:35]
    v_mfma_f32_16x16x32_bf16 v[36:39], v[132:135], v[12:15], v[36:39]
    s_call_b64 s[60:61], SM4
    v_mfma_f32_16x16x32_bf16 v[16:19], v[24:27], a[232:235], v[16:19]
    v_mfma_f32_16x16x32_bf16 v[20:23], v[24:27], a[236:239], v[20:23]
    v_mfma_f32_16x16x32_bf16 v[16:19], v[28:31], v[200:203], v[16:19]
    v_mfma_f32_16x16x32_bf16 v[20:23], v[28:31], v[204:207], v[20:23]
    v_mfma_f32_16x16x32_bf16 v[16:19], v[32:35], v[216:219], v[16:19]
    v_mfma_f32_16x16x32_bf16 v[20:23], v[32:35], v[220:223], v[20:23]
    v_mfma_f32_16x16x32_bf16 v[16:19], v[36:39], v[136:139], v[16:19]
    v_mfma_f32_16x16x32_bf16 v[20:23], v[36:39], v[140:143], v[20:23]
    s_waitcnt vmcnt(8)
    s_xor_b32 s57, s56, 6144
    buffer_load_dwordx4 a[0:3], v2, s[4:7], s57 offen offset:0 nt
    buffer_load_dwordx4 a[4:7], v2, s[4:7], s57 offen offset:256 nt
    buffer_load_dwordx4 a[8:11], v3, s[8:11], s57 offen offset:0 nt
    buffer_load_dwordx4 a[12:15], v3, s[8:11], s57 offen offset:256 nt
    s_waitcnt vmcnt(8)
    s_add_u32 s56, s59, 0x8000000
    buffer_load_dwordx4 v[240:243], v2, s[4:7], s56 offen offset:0 nt
    buffer_load_dwordx4 v[244:247], v2, s[4:7], s56 offen offset:256 nt
    buffer_load_dwordx4 v[248:251], v3, s[8:11], s56 offen offset:0 nt
    buffer_load_dwordx4 v[252:255], v3, s[8:11], s56 offen offset:256 nt
    s_waitcnt vmcnt(8)
    s_add_u32 s56, s84, 0xa000000
    buffer_load_dwordx4 a[176:179], v2, s[4:7], s56 offen offset:0 nt
    buffer_load_dwordx4 a[180:183], v2, s[4:7], s56 offen offset:256 nt
    buffer_load_dwordx4 a[184:187], v3, s[8:11], s56 offen offset:0 nt
    buffer_load_dwordx4 a[188:191], v3, s[8:11], s56 offen offset:256 nt
    s_waitcnt vmcnt(8)
    s_add_u32 s94, s92, 0x16000
    buffer_load_dwordx4 v[52:55], v60, s[12:15], s94 offen offset:0 sc1
    buffer_load_dwordx4 v[56:59], v60, s[12:15], s94 offen offset:256 sc1
    s_xor_b32 s57, s56, 2048
    buffer_load_dwordx4 a[160:163], v2, s[4:7], s57 offen offset:0 nt
    buffer_load_dwordx4 a[164:167], v2, s[4:7], s57 offen offset:256 nt
    buffer_load_dwordx4 a[168:171], v3, s[8:11], s57 offen offset:0 nt
    buffer_load_dwordx4 a[172:175], v3, s[8:11], s57 offen offset:256 nt
    v_mfma_f32_16x16x32_bf16 v[24:27], a[80:83], v[8:11], 0
    v_mfma_f32_16x16x32_bf16 v[28:31], a[144:147], v[8:11], 0
    v_mfma_f32_16x16x32_bf16 v[32:35], a[128:131], v[8:11], 0
    v_mfma_f32_16x16x32_bf16 v[36:39], a[0:3], v[8:11], 0
    v_mfma_f32_16x16x32_bf16 v[24:27], a[84:87], v[12:15], v[24:27]
    v_mfma_f32_16x16x32_bf16 v[28:31], a[148:151], v[12:15], v[28:31]
    v_mfma_f32_16x16x32_bf16 v[32:35], a[132:135], v[12:15], v[32:35]
    v_mfma_f32_16x16x32_bf16 v[36:39], a[4:7], v[12:15], v[36:39]
    s_call_b64 s[60:61], SM4
    v_mfma_f32_16x16x32_bf16 v[16:19], v[24:27], a[88:91], v[16:19]
    v_mfma_f32_16x16x32_bf16 v[20:23], v[24:27], a[92:95], v[20:23]
    v_mfma_f32_16x16x32_bf16 v[16:19], v[28:31], a[152:155], v[16:19]
    v_mfma_f32_16x16x32_bf16 v[20:23], v[28:31], a[156:159], v[20:23]
    v_mfma_f32_16x16x32_bf16 v[16:19], v[32:35], a[136:139], v[16:19]
    v_mfma_f32_16x16x32_bf16 v[20:23], v[32:35], a[140:143], v[20:23]
    v_mfma_f32_16x16x32_bf16 v[16:19], v[36:39], a[8:11], v[16:19]
    v_mfma_f32_16x16x32_bf16 v[20:23], v[36:39], a[12:15], v[20:23]
    s_waitcnt vmcnt(10)
    s_xor_b32 s57, s56, 4096
    buffer_load_dwordx4 a[192:195], v2, s[4:7], s57 offen offset:0 nt
    buffer_load_dwordx4 a[196:199], v2, s[4:7], s57 offen offset:256 nt
    buffer_load_dwordx4 a[200:203], v3, s[8:11], s57 offen offset:0 nt
    buffer_load_dwordx4 a[204:207], v3, s[8:11], s57 offen offset:256 nt
    v_mfma_f32_16x16x32_bf16 v[24:27], v[240:243], v[8:11], 0
    v_mfma_f32_16x16x32_bf16 v[24:27], v[244:247], v[12:15], v[24:27]
    s_call_b64 s[60:61], SM1
    v_mfma_f32_16x16x32_bf16 v[16:19], v[24:27], v[248:251], v[16:19]
    v_mfma_f32_16x16x32_bf16 v[20:23], v[24:27], v[252:255], v[20:23]
    s_add_u32 s94, s92, 0xa000
    buffer_load_dwordx4 v[8:11], v60, s[12:15], s94 offen offset:0 sc1
    buffer_load_dwordx4 v[12:15], v60, s[12:15], s94 offen offset:256 sc1
    s_mov_b32 s69, 4
    s_mov_b32 s95, 160516
    s_call_b64 s[60:61], WDN
    s_mov_b32 s96, 147456
    s_call_b64 s[60:61], REC
    s_call_b64 s[60:61], ARR
    s_cmp_eq_u32 s94, 3
    s_cbranch_scc1 Lal_51
    s_cmp_eq_u32 s94, 0
    s_cbranch_scc1 Laf_52
    s_mov_b32 s56, 0x40000000
    s_mov_b32 s57, 0x40000000
    s_call_b64 s[60:61], MST
    s_branch Lad_53
Laf_52:
    s_mov_b32 s96, 156160
    s_add_u32 s56, s90, 0x240000
    s_add_u32 s57, s91, 0x90000
    s_call_b64 s[60:61], MRG
    v_mov_b32 v32, 160520
    v_mov_b32 v33, 5
    ds_write_b32 v32, v33
    s_branch Lad_53
Lal_51:
    s_mov_b32 s96, 147456
    s_add_u32 s56, s90, 0x100000
    s_add_u32 s57, s91, 0x40000
    s_call_b64 s[60:61], MRG
    v_mov_b32 v32, 160516
    v_mov_b32 v33, 5
    ds_write_b32 v32, v33
Lad_53:
    s_waitcnt vmcnt(14)
    s_waitcnt vmcnt(12)
    s_add_u32 s100, s92, 0x16000
    s_branch Lchk_57
Lretry_56:
    buffer_load_dwordx4 v[52:55], v60, s[12:15], s100 offen offset:0 sc1
    buffer_load_dwordx4 v[56:59], v60, s[12:15], s100 offen offset:256 sc1
    s_waitcnt vmcnt(0)
Lchk_57:
    v_max_u32 v61, v52, v53
    v_max3_u32 v61, v61, v54, v55
    v_max3_u32 v61, v61, v56, v57
    v_max3_u32 v61, v61, v58, v59
    v_cmp_eq_u32 vcc, -1, v61
    s_cbranch_vccz Lok_55
    s_sub_u32 s93, s93, 1
    s_cbranch_scc1 L_end
    s_branch Lretry_56
Lok_55:
Lqok_54:
    v_mfma_f32_16x16x32_bf16 v[24:27], a[16:19], v[52:55], 0
    v_mfma_f32_16x16x32_bf16 v[28:31], a[32:35], v[52:55], 0
    v_mfma_f32_16x16x32_bf16 v[32:35], a[48:51], v[52:55], 0
    v_mfma_f32_16x16x32_bf16 v[36:39], a[208:211], v[52:55], 0
    v_mfma_f32_16x16x32_bf16 v[24:27], a[20:23], v[56:59], v[24:27]
    v_mfma_f32_16x16x32_bf16 v[28:31], a[36:39], v[56:59], v[28:31]
    v_mfma_f32_16x16x32_bf16 v[32:35], a[52:55], v[56:59], v[32:35]
    v_mfma_f32_16x16x32_bf16 v[36:39], a[212:215], v[56:59], v[36:39]
    s_call_b64 s[60:61], SM4
    v_mfma_f32_16x16x32_bf16 v[16:19], v[24:27], a[24:27], v[16:19]
    v_mfma_f32_16x16x32_bf16 v[20:23], v[24:27], a[28:31], v[20:23]
    v_mfma_f32_16x16x32_bf16 v[16:19], v[28:31], a[40:43], v[16:19]
    v_mfma_f32_16x16x32_bf16 v[20:23], v[28:31], a[44:47], v[20:23]
    v_mfma_f32_16x16x32_bf16 v[16:19], v[32:35], a[56:59], v[16:19]
    v_mfma_f32_16x16x32_bf16 v[20:23], v[32:35], a[60:63], v[20:23]
    v_mfma_f32_16x16x32_bf16 v[16:19], v[36:39], a[216:219], v[16:19]
    v_mfma_f32_16x16x32_bf16 v[20:23], v[36:39], a[220:223], v[20:23]
    s_sub_u32 s67, s54, 88
    s_lshl_b32 s94, s67, 11
    s_add_u32 s94, s94, s68
    s_add_u32 s94, s94, 0x6000000
    s_cmp_lt_u32 s67, 8
    s_cselect_b32 s94, s94, 0x40000000
    buffer_load_dwordx4 a[16:19], v2, s[4:7], s94 offen offset:0 nt
    buffer_load_dwordx4 a[20:23], v2, s[4:7], s94 offen offset:256 nt
    buffer_load_dwordx4 a[24:27], v3, s[8:11], s94 offen offset:0 nt
    buffer_load_dwordx4 a[28:31], v3, s[8:11], s94 offen offset:256 nt
    s_sub_u32 s66, s54, 40
    s_lshl_b32 s94, s66, 11
    s_add_u32 s94, s94, s68
    s_add_u32 s94, s94, 0xa000000
    s_cmp_lt_u32 s66, 8
    s_cselect_b32 s94, s94, 0x40000000
    buffer_load_dwordx4 a[32:35], v2, s[4:7], s94 offen offset:0 nt
    buffer_load_dwordx4 a[36:39], v2, s[4:7], s94 offen offset:256 nt
    buffer_load_dwordx4 a[40:43], v3, s[8:11], s94 offen offset:0 nt
    buffer_load_dwordx4 a[44:47], v3, s[8:11], s94 offen offset:256 nt
    s_add_u32 s56, s84, 0xa000000
    s_xor_b32 s57, s56, 6144
    buffer_load_dwordx4 a[48:51], v2, s[4:7], s57 offen offset:0 nt
    buffer_load_dwordx4 a[52:55], v2, s[4:7], s57 offen offset:256 nt
    buffer_load_dwordx4 a[56:59], v3, s[8:11], s57 offen offset:0 nt
    buffer_load_dwordx4 a[60:63], v3, s[8:11], s57 offen offset:256 nt
    v_mfma_f32_16x16x32_bf16 v[24:27], a[64:67], v[52:55], 0
    v_mfma_f32_16x16x32_bf16 v[28:31], v[176:179], v[52:55], 0
    v_mfma_f32_16x16x32_bf16 v[32:35], v[64:67], v[52:55], 0
    v_mfma_f32_16x16x32_bf16 v[36:39], v[80:83], v[52:55], 0
    v_mfma_f32_16x16x32_bf16 v[24:27], a[68:71], v[56:59], v[24:27]
    v_mfma_f32_16x16x32_bf16 v[28:31], v[180:183], v[56:59], v[28:31]
    v_mfma_f32_16x16x32_bf16 v[32:35], v[68:71], v[56:59], v[32:35]
    v_mfma_f32_16x16x32_bf16 v[36:39], v[84:87], v[56:59], v[36:39]
    s_call_b64 s[60:61], SM4
    v_mfma_f32_16x16x32_bf16 v[16:19], v[24:27], a[72:75], v[16:19]
    v_mfma_f32_16x16x32_bf16 v[20:23], v[24:27], a[76:79], v[20:23]
    v_mfma_f32_16x16x32_bf16 v[16:19], v[28:31], v[184:187], v[16:19]
    v_mfma_f32_16x16x32_bf16 v[20:23], v[28:31], v[188:191], v[20:23]
    v_mfma_f32_16x16x32_bf16 v[16:19], v[32:35], v[72:75], v[16:19]
    v_mfma_f32_16x16x32_bf16 v[20:23], v[32:35], v[76:79], v[20:23]
    v_mfma_f32_16x16x32_bf16 v[16:19], v[36:39], v[88:91], v[16:19]
    v_mfma_f32_16x16x32_bf16 v[20:23], v[36:39], v[92:95], v[20:23]
    s_add_u32 s56, s85, 0xa000000
    buffer_load_dwordx4 a[208:211], v2, s[4:7], s56 offen offset:0 nt
    buffer_load_dwordx4 a[212:215], v2, s[4:7], s56 offen offset:256 nt
    buffer_load_dwordx4 a[216:219], v3, s[8:11], s56 offen offset:0 nt
    buffer_load_dwordx4 a[220:223], v3, s[8:11], s56 offen offset:256 nt
    v_mfma_f32_16x16x32_bf16 v[24:27], v[96:99], v[52:55], 0
    v_mfma_f32_16x16x32_bf16 v[28:31], v[160:163], v[52:55], 0
    v_mfma_f32_16x16x32_bf16 v[32:35], v[224:227], v[52:55], 0
    v_mfma_f32_16x16x32_bf16 v[36:39], a[112:115], v[52:55], 0
    v_mfma_f32_16x16x32_bf16 v[24:27], v[100:103], v[56:59], v[24:27]
    v_mfma_f32_16x16x32_bf16 v[28:31], v[164:167], v[56:59], v[28:31]
    v_mfma_f32_16x16x32_bf16 v[32:35], v[228:231], v[56:59], v[32:35]
    v_mfma_f32_16x16x32_bf16 v[36:39], a[116:119], v[56:59], v[36:39]
    s_call_b64 s[60:61], SM4
    v_mfma_f32_16x16x32_bf16 v[16:19], v[24:27], v[104:107], v[16:19]
    v_mfma_f32_16x16x32_bf16 v[20:23], v[24:27], v[108:111], v[20:23]
    v_mfma_f32_16x16x32_bf16 v[16:19], v[28:31], v[168:171], v[16:19]
    v_mfma_f32_16x16x32_bf16 v[20:23], v[28:31], v[172:175], v[20:23]
    v_mfma_f32_16x16x32_bf16 v[16:19], v[32:35], v[232:235], v[16:19]
    v_mfma_f32_16x16x32_bf16 v[20:23], v[32:35], v[236:239], v[20:23]
    v_mfma_f32_16x16x32_bf16 v[16:19], v[36:39], a[120:123], v[16:19]
    v_mfma_f32_16x16x32_bf16 v[20:23], v[36:39], a[124:127], v[20:23]
    s_nop 3
    v_add_u32 v49, 65536, v62
    ds_read_b128 v[96:99], v49 offset:16384
    ds_read_b128 v[100:103], v49 offset:17408
    ds_read_b128 v[104:107], v49 offset:18432
    ds_read_b128 v[108:111], v49 offset:19456
    v_add_u32 v49, 65536, v62
    ds_read_b128 v[160:163], v49 offset:32768
    ds_read_b128 v[164:167], v49 offset:33792
    ds_read_b128 v[168:171], v49 offset:34816
    ds_read_b128 v[172:175], v49 offset:35840
    v_add_u32 v49, 65536, v62
    ds_read_b128 v[224:227], v49 offset:49152
    ds_read_b128 v[228:231], v49 offset:50176
    ds_read_b128 v[232:235], v49 offset:51200
    ds_read_b128 v[236:239], v49 offset:52224
    v_add_u32 v49, 131072, v62
    ds_read_b128 a[112:115], v49 offset:0
    ds_read_b128 a[116:119], v49 offset:1024
    ds_read_b128 a[120:123], v49 offset:2048
    ds_read_b128 a[124:127], v49 offset:3072
    v_mfma_f32_16x16x32_bf16 v[24:27], a[96:99], v[52:55], 0
    v_mfma_f32_16x16x32_bf16 v[24:27], a[100:103], v[56:59], v[24:27]
    s_call_b64 s[60:61], SM1
    v_mfma_f32_16x16x32_bf16 v[16:19], v[24:27], a[104:107], v[16:19]
    v_mfma_f32_16x16x32_bf16 v[20:23], v[24:27], a[108:111], v[20:23]
    s_waitcnt lgkmcnt(0)
    v_mfma_f32_16x16x32_bf16 v[24:27], v[96:99], v[52:55], 0
    v_mfma_f32_16x16x32_bf16 v[28:31], v[160:163], v[52:55], 0
    v_mfma_f32_16x16x32_bf16 v[32:35], v[224:227], v[52:55], 0
    v_mfma_f32_16x16x32_bf16 v[36:39], a[112:115], v[52:55], 0
    v_mfma_f32_16x16x32_bf16 v[24:27], v[100:103], v[56:59], v[24:27]
    v_mfma_f32_16x16x32_bf16 v[28:31], v[164:167], v[56:59], v[28:31]
    v_mfma_f32_16x16x32_bf16 v[32:35], v[228:231], v[56:59], v[32:35]
    v_mfma_f32_16x16x32_bf16 v[36:39], a[116:119], v[56:59], v[36:39]
    s_call_b64 s[60:61], SM4
    v_mfma_f32_16x16x32_bf16 v[16:19], v[24:27], v[104:107], v[16:19]
    v_mfma_f32_16x16x32_bf16 v[20:23], v[24:27], v[108:111], v[20:23]
    v_mfma_f32_16x16x32_bf16 v[16:19], v[28:31], v[168:171], v[16:19]
    v_mfma_f32_16x16x32_bf16 v[20:23], v[28:31], v[172:175], v[20:23]
    v_mfma_f32_16x16x32_bf16 v[16:19], v[32:35], v[232:235], v[16:19]
    v_mfma_f32_16x16x32_bf16 v[20:23], v[32:35], v[236:239], v[20:23]
    v_mfma_f32_16x16x32_bf16 v[16:19], v[36:39], a[120:123], v[16:19]
    v_mfma_f32_16x16x32_bf16 v[20:23], v[36:39], a[124:127], v[20:23]
    s_xor_b32 s57, s56, 2048
    buffer_load_dwordx4 a[64:67], v2, s[4:7], s57 offen offset:0 nt
    buffer_load_dwordx4 a[68:71], v2, s[4:7], s57 offen offset:256 nt
    buffer_load_dwordx4 a[72:75], v3, s[8:11], s57 offen offset:0 nt
    buffer_load_dwordx4 a[76:79], v3, s[8:11], s57 offen offset:256 nt
    s_cmp_ge_u32 s67, 8
    s_cbranch_scc1 Lnx_58
    s_waitcnt vmcnt(16)
    v_mfma_f32_16x16x32_bf16 v[24:27], a[16:19], v[52:55], 0
    v_mfma_f32_16x16x32_bf16 v[24:27], a[20:23], v[56:59], v[24:27]
    s_call_b64 s[60:61], SM1
    v_mfma_f32_16x16x32_bf16 v[16:19], v[24:27], a[24:27], v[16:19]
    v_mfma_f32_16x16x32_bf16 v[20:23], v[24:27], a[28:31], v[20:23]
Lnx_58:
    s_mov_b32 s69, 5
    s_mov_b32 s95, 160520
    s_call_b64 s[60:61], WDN
    s_mov_b32 s96, 156160
    s_call_b64 s[60:61], REC
    s_waitcnt vmcnt(28)
    s_waitcnt vmcnt(24)
    s_waitcnt vmcnt(22)
    s_add_u32 s100, s92, 0xa000
    s_branch Lchk_61
Lretry_60:
    buffer_load_dwordx4 v[8:11], v60, s[12:15], s100 offen offset:0 sc1
    buffer_load_dwordx4 v[12:15], v60, s[12:15], s100 offen offset:256 sc1
    s_waitcnt vmcnt(0)
Lchk_61:
    v_max_u32 v61, v8, v9
    v_max3_u32 v61, v61, v10, v11
    v_max3_u32 v61, v61, v12, v13
    v_max3_u32 v61, v61, v14, v15
    v_cmp_eq_u32 vcc, -1, v61
    s_cbranch_vccz Lok_59
    s_sub_u32 s93, s93, 1
    s_cbranch_scc1 L_end
    s_branch Lretry_60
Lok_59:
    s_waitcnt vmcnt(8)
    s_xor_b32 s57, s56, 4096
    buffer_load_dwordx4 v[176:179], v2, s[4:7], s57 offen offset:0 nt
    buffer_load_dwordx4 v[180:183], v2, s[4:7], s57 offen offset:256 nt
    buffer_load_dwordx4 v[184:187], v3, s[8:11], s57 offen offset:0 nt
    buffer_load_dwordx4 v[188:191], v3, s[8:11], s57 offen offset:256 nt
    v_mfma_f32_16x16x32_bf16 v[24:27], a[176:179], v[8:11], 0
    v_mfma_f32_16x16x32_bf16 v[28:31], a[160:163], v[8:11], 0
    v_mfma_f32_16x16x32_bf16 v[32:35], a[192:195], v[8:11], 0
    v_mfma_f32_16x16x32_bf16 v[36:39], a[48:51], v[8:11], 0
    v_mfma_f32_16x16x32_bf16 v[24:27], a[180:183], v[12:15], v[24:27]
    v_mfma_f32_16x16x32_bf16 v[28:31], a[164:167], v[12:15], v[28:31]
    v_mfma_f32_16x16x32_bf16 v[32:35], a[196:199], v[12:15], v[32:35]
    v_mfma_f32_16x16x32_bf16 v[36:39], a[52:55], v[12:15], v[36:39]
    s_call_b64 s[60:61], SM4
    v_mfma_f32_16x16x32_bf16 v[16:19], v[24:27], a[184:187], v[16:19]
    v_mfma_f32_16x16x32_bf16 v[20:23], v[24:27], a[188:191], v[20:23]
    v_mfma_f32_16x16x32_bf16 v[16:19], v[28:31], a[168:171], v[16:19]
    v_mfma_f32_16x16x32_bf16 v[20:23], v[28:31], a[172:175], v[20:23]
    v_mfma_f32_16x16x32_bf16 v[16:19], v[32:35], a[200:203], v[16:19]
    v_mfma_f32_16x16x32_bf16 v[20:23], v[32:35], a[204:207], v[20:23]
    v_mfma_f32_16x16x32_bf16 v[16:19], v[36:39], a[56:59], v[16:19]
    v_mfma_f32_16x16x32_bf16 v[20:23], v[36:39], a[60:63], v[20:23]
    v_add_u32 v49, 65536, v62
    ds_write_b128 v49, a[176:179] offset:16384
    ds_write_b128 v49, a[180:183] offset:17408
    ds_write_b128 v49, a[184:187] offset:18432
    ds_write_b128 v49, a[188:191] offset:19456
    v_add_u32 v49, 65536, v62
    ds_write_b128 v49, a[160:163] offset:32768
    ds_write_b128 v49, a[164:167] offset:33792
    ds_write_b128 v49, a[168:171] offset:34816
    ds_write_b128 v49, a[172:175] offset:35840
    v_add_u32 v49, 65536, v62
    ds_write_b128 v49, a[192:195] offset:49152
    ds_write_b128 v49, a[196:199] offset:50176
    ds_write_b128 v49, a[200:203] offset:51200
    ds_write_b128 v49, a[204:207] offset:52224
    v_add_u32 v49, 131072, v62
    ds_write_b128 v49, a[48:51] offset:0
    ds_write_b128 v49, a[52:55] offset:1024
    ds_write_b128 v49, a[56:59] offset:2048
    ds_write_b128 v49, a[60:63] offset:3072
    s_waitcnt lgkmcnt(0)
    s_cmp_ge_u32 s66, 8
    s_cbranch_scc1 Lnx_62
    v_mfma_f32_16x16x32_bf16 v[24:27], a[32:35], v[8:11], 0
    v_mfma_f32_16x16x32_bf16 v[24:27], a[36:39], v[12:15], v[24:27]
    s_call_b64 s[60:61], SM1
    v_mfma_f32_16x16x32_bf16 v[16:19], v[24:27], a[40:43], v[16:19]
    v_mfma_f32_16x16x32_bf16 v[20:23], v[24:27], a[44:47], v[20:23]
Lnx_62:
    s_waitcnt vmcnt(8)
    s_xor_b32 s57, s56, 6144
    buffer_load_dwordx4 v[64:67], v2, s[4:7], s57 offen offset:0 nt
    buffer_load_dwordx4 v[68:71], v2, s[4:7], s57 offen offset:256 nt
    buffer_load_dwordx4 v[72:75], v3, s[8:11], s57 offen offset:0 nt
    buffer_load_dwordx4 v[76:79], v3, s[8:11], s57 offen offset:256 nt
    s_waitcnt vmcnt(8)
    s_add_u32 s56, s86, 0xa000000
    buffer_load_dwordx4 v[80:83], v2, s[4:7], s56 offen offset:0 nt
    buffer_load_dwordx4 v[84:87], v2, s[4:7], s56 offen offset:256 nt
    buffer_load_dwordx4 v[88:91], v3, s[8:11], s56 offen offset:0 nt
    buffer_load_dwordx4 v[92:95], v3, s[8:11], s56 offen offset:256 nt
    s_waitcnt vmcnt(8)
    s_xor_b32 s57, s56, 2048
    buffer_load_dwordx4 a[96:99], v2, s[4:7], s57 offen offset:0 nt
    buffer_load_dwordx4 a[100:103], v2, s[4:7], s57 offen offset:256 nt
    buffer_load_dwordx4 a[104:107], v3, s[8:11], s57 offen offset:0 nt
    buffer_load_dwordx4 a[108:111], v3, s[8:11], s57 offen offset:256 nt
    s_waitcnt vmcnt(8)
    s_xor_b32 s57, s56, 4096
    buffer_load_dwordx4 v[96:99], v2, s[4:7], s57 offen offset:0 nt
    buffer_load_dwordx4 v[100:103], v2, s[4:7], s57 offen offset:256 nt
    buffer_load_dwordx4 v[104:107], v3, s[8:11], s57 offen offset:0 nt
    buffer_load_dwordx4 v[108:111], v3, s[8:11], s57 offen offset:256 nt
    v_mfma_f32_16x16x32_bf16 v[24:27], a[208:211], v[8:11], 0
    v_mfma_f32_16x16x32_bf16 v[28:31], a[64:67], v[8:11], 0
    v_mfma_f32_16x16x32_bf16 v[32:35], v[176:179], v[8:11], 0
    v_mfma_f32_16x16x32_bf16 v[36:39], v[64:67], v[8:11], 0
    v_mfma_f32_16x16x32_bf16 v[24:27], a[212:215], v[12:15], v[24:27]
    v_mfma_f32_16x16x32_bf16 v[28:31], a[68:71], v[12:15], v[28:31]
    v_mfma_f32_16x16x32_bf16 v[32:35], v[180:183], v[12:15], v[32:35]
    v_mfma_f32_16x16x32_bf16 v[36:39], v[68:71], v[12:15], v[36:39]
    s_call_b64 s[60:61], SM4
    v_mfma_f32_16x16x32_bf16 v[16:19], v[24:27], a[216:219], v[16:19]
    v_mfma_f32_16x16x32_bf16 v[20:23], v[24:27], a[220:223], v[20:23]
    v_mfma_f32_16x16x32_bf16 v[16:19], v[28:31], a[72:75], v[16:19]
    v_mfma_f32_16x16x32_bf16 v[20:23], v[28:31], a[76:79], v[20:23]
    v_mfma_f32_16x16x32_bf16 v[16:19], v[32:35], v[184:187], v[16:19]
    v_mfma_f32_16x16x32_bf16 v[20:23], v[32:35], v[188:191], v[20:23]
    v_mfma_f32_16x16x32_bf16 v[16:19], v[36:39], v[72:75], v[16:19]
    v_mfma_f32_16x16x32_bf16 v[20:23], v[36:39], v[76:79], v[20:23]
    s_waitcnt vmcnt(8)
    s_xor_b32 s57, s56, 6144
    buffer_load_dwordx4 v[160:163], v2, s[4:7], s57 offen offset:0 nt
    buffer_load_dwordx4 v[164:167], v2, s[4:7], s57 offen offset:256 nt
    buffer_load_dwordx4 v[168:171], v3, s[8:11], s57 offen offset:0 nt
    buffer_load_dwordx4 v[172:175], v3, s[8:11], s57 offen offset:256 nt
    s_waitcnt vmcnt(8)
    s_add_u32 s56, s87, 0xa000000
    buffer_load_dwordx4 v[224:227], v2, s[4:7], s56 offen offset:0 nt
    buffer_load_dwordx4 v[228:231], v2, s[4:7], s56 offen offset:256 nt
    buffer_load_dwordx4 v[232:235], v3, s[8:11], s56 offen offset:0 nt
    buffer_load_dwordx4 v[236:239], v3, s[8:11], s56 offen offset:256 nt
    s_waitcnt vmcnt(8)
    s_xor_b32 s57, s56, 2048
    buffer_load_dwordx4 a[112:115], v2, s[4:7], s57 offen offset:0 nt
    buffer_load_dwordx4 a[116:119], v2, s[4:7], s57 offen offset:256 nt
    buffer_load_dwordx4 a[120:123], v3, s[8:11], s57 offen offset:0 nt
    buffer_load_dwordx4 a[124:127], v3, s[8:11], s57 offen offset:256 nt
    s_waitcnt vmcnt(8)
    s_xor_b32 s57, s56, 4096
    buffer_load_dwordx4 a[16:19], v2, s[4:7], s57 offen offset:0 nt
    buffer_load_dwordx4 a[20:23], v2, s[4:7], s57 offen offset:256 nt
    buffer_load_dwordx4 a[24:27], v3, s[8:11], s57 offen offset:0 nt
    buffer_load_dwordx4 a[28:31], v3, s[8:11], s57 offen offset:256 nt
    v_mfma_f32_16x16x32_bf16 v[24:27], v[80:83], v[8:11], 0
    v_mfma_f32_16x16x32_bf16 v[28:31], a[96:99], v[8:11], 0
    v_mfma_f32_16x16x32_bf16 v[32:35], v[96:99], v[8:11], 0
    v_mfma_f32_16x16x32_bf16 v[36:39], v[160:163], v[8:11], 0
    v_mfma_f32_16x16x32_bf16 v[24:27], v[84:87], v[12:15], v[24:27]
    v_mfma_f32_16x16x32_bf16 v[28:31], a[100:103], v[12:15], v[28:31]
    v_mfma_f32_16x16x32_bf16 v[32:35], v[100:103], v[12:15], v[32:35]
    v_mfma_f32_16x16x32_bf16 v[36:39], v[164:167], v[12:15], v[36:39]
    s_call_b64 s[60:61], SM4
    v_mfma_f32_16x16x32_bf16 v[16:19], v[24:27], v[88:91], v[16:19]
    v_mfma_f32_16x16x32_bf16 v[20:23], v[24:27], v[92:95], v[20:23]
    v_mfma_f32_16x16x32_bf16 v[16:19], v[28:31], a[104:107], v[16:19]
    v_mfma_f32_16x16x32_bf16 v[20:23], v[28:31], a[108:111], v[20:23]
    v_mfma_f32_16x16x32_bf16 v[16:19], v[32:35], v[104:107], v[16:19]
    v_mfma_f32_16x16x32_bf16 v[20:23], v[32:35], v[108:111], v[20:23]
    v_mfma_f32_16x16x32_bf16 v[16:19], v[36:39], v[168:171], v[16:19]
    v_mfma_f32_16x16x32_bf16 v[20:23], v[36:39], v[172:175], v[20:23]
    s_waitcnt vmcnt(8)
    s_xor_b32 s57, s56, 6144
    buffer_load_dwordx4 a[176:179], v2, s[4:7], s57 offen offset:0 nt
    buffer_load_dwordx4 a[180:183], v2, s[4:7], s57 offen offset:256 nt
    buffer_load_dwordx4 a[184:187], v3, s[8:11], s57 offen offset:0 nt
    buffer_load_dwordx4 a[188:191], v3, s[8:11], s57 offen offset:256 nt
    s_waitcnt vmcnt(8)
    s_add_u32 s56, s59, 0xa000000
    buffer_load_dwordx4 a[160:163], v2, s[4:7], s56 offen offset:0 nt
    buffer_load_dwordx4 a[164:167], v2, s[4:7], s56 offen offset:256 nt
    buffer_load_dwordx4 a[168:171], v3, s[8:11], s56 offen offset:0 nt
    buffer_load_dwordx4 a[172:175], v3, s[8:11], s56 offen offset:256 nt
    s_waitcnt vmcnt(8)
    s_add_u32 s56, s84, 0xc000000
    buffer_load_dwordx4 a[192:195], v2, s[4:7], s56 offen offset:0 nt
    buffer_load_dwordx4 a[196:199], v2, s[4:7], s56 offen offset:256 nt
    buffer_load_dwordx4 a[200:203], v3, s[8:11], s56 offen offset:0 nt
    buffer_load_dwordx4 a[204:207], v3, s[8:11], s56 offen offset:256 nt
    s_waitcnt vmcnt(8)
    s_add_u32 s94, s92, 0x18000
    buffer_load_dwordx4 v[52:55], v60, s[12:15], s94 offen offset:0 sc1
    buffer_load_dwordx4 v[56:59], v60, s[12:15], s94 offen offset:256 sc1
    s_xor_b32 s57, s56, 2048
    buffer_load_dwordx4 a[48:51], v2, s[4:7], s57 offen offset:0 nt
    buffer_load_dwordx4 a[52:55], v2, s[4:7], s57 offen offset:256 nt
    buffer_load_dwordx4 a[56:59], v3, s[8:11], s57 offen offset:0 nt
    buffer_load_dwordx4 a[60:63], v3, s[8:11], s57 offen offset:256 nt
    v_mfma_f32_16x16x32_bf16 v[24:27], v[224:227], v[8:11], 0
    v_mfma_f32_16x16x32_bf16 v[28:31], a[112:115], v[8:11], 0
    v_mfma_f32_16x16x32_bf16 v[32:35], a[16:19], v[8:11], 0
    v_mfma_f32_16x16x32_bf16 v[36:39], a[176:179], v[8:11], 0
    v_mfma_f32_16x16x32_bf16 v[24:27], v[228:231], v[12:15], v[24:27]
    v_mfma_f32_16x16x32_bf16 v[28:31], a[116:119], v[12:15], v[28:31]
    v_mfma_f32_16x16x32_bf16 v[32:35], a[20:23], v[12:15], v[32:35]
    v_mfma_f32_16x16x32_bf16 v[36:39], a[180:183], v[12:15], v[36:39]
    s_call_b64 s[60:61], SM4
    v_mfma_f32_16x16x32_bf16 v[16:19], v[24:27], v[232:235], v[16:19]
    v_mfma_f32_16x16x32_bf16 v[20:23], v[24:27], v[236:239], v[20:23]
    v_mfma_f32_16x16x32_bf16 v[16:19], v[28:31], a[120:123], v[16:19]
    v_mfma_f32_16x16x32_bf16 v[20:23], v[28:31], a[124:127], v[20:23]
    v_mfma_f32_16x16x32_bf16 v[16:19], v[32:35], a[24:27], v[16:19]
    v_mfma_f32_16x16x32_bf16 v[20:23], v[32:35], a[28:31], v[20:23]
    v_mfma_f32_16x16x32_bf16 v[16:19], v[36:39], a[184:187], v[16:19]
    v_mfma_f32_16x16x32_bf16 v[20:23], v[36:39], a[188:191], v[20:23]
    s_waitcnt vmcnt(10)
    s_xor_b32 s57, s56, 4096
    buffer_load_dwordx4 a[32:35], v2, s[4:7], s57 offen offset:0 nt
    buffer_load_dwordx4 a[36:39], v2, s[4:7], s57 offen offset:256 nt
    buffer_load_dwordx4 a[40:43], v3, s[8:11], s57 offen offset:0 nt
    buffer_load_dwordx4 a[44:47], v3, s[8:11], s57 offen offset:256 nt
    v_mfma_f32_16x16x32_bf16 v[24:27], a[160:163], v[8:11], 0
    v_mfma_f32_16x16x32_bf16 v[24:27], a[164:167], v[12:15], v[24:27]
    s_call_b64 s[60:61], SM1
    v_mfma_f32_16x16x32_bf16 v[16:19], v[24:27], a[168:171], v[16:19]
    v_mfma_f32_16x16x32_bf16 v[20:23], v[24:27], a[172:175], v[20:23]
    s_add_u32 s94, s92, 0xc000
    buffer_load_dwordx4 v[8:11], v60, s[12:15], s94 offen offset:0 sc1
    buffer_load_dwordx4 v[12:15], v60, s[12:15], s94 offen offset:256 sc1
    s_mov_b32 s69, 5
    s_mov_b32 s95, 160516
    s_call_b64 s[60:61], WDN
    s_mov_b32 s96, 147456
    s_call_b64 s[60:61], REC
    s_call_b64 s[60:61], ARR
    s_cmp_eq_u32 s94, 3
    s_cbranch_scc1 Lal_63
    s_cmp_eq_u32 s94, 0
    s_cbranch_scc1 Laf_64
    s_mov_b32 s56, 0x40000000
    s_mov_b32 s57, 0x40000000
    s_call_b64 s[60:61], MST
    s_branch Lad_65
Laf_64:
    s_mov_b32 s96, 151808
    s_add_u32 s56, s90, 0x280000
    s_add_u32 s57, s91, 0xa0000
    s_call_b64 s[60:61], MRG
    v_mov_b32 v32, 160520
    v_mov_b32 v33, 6
    ds_write_b32 v32, v33
    s_branch Lad_65
Lal_63:
    s_mov_b32 s96, 147456
    s_add_u32 s56, s90, 0x140000
    s_add_u32 s57, s91, 0x50000
    s_call_b64 s[60:61], MRG
    v_mov_b32 v32, 160516
    v_mov_b32 v33, 6
    ds_write_b32 v32, v33
Lad_65:
    s_waitcnt vmcnt(14)
    s_waitcnt vmcnt(12)
    s_add_u32 s100, s92, 0x18000
    s_branch Lchk_69
Lretry_68:
    buffer_load_dwordx4 v[52:55], v60, s[12:15], s100 offen offset:0 sc1
    buffer_load_dwordx4 v[56:59], v60, s[12:15], s100 offen offset:256 sc1
    s_waitcnt vmcnt(0)
Lchk_69:
    v_max_u32 v61, v52, v53
    v_max3_u32 v61, v61, v54, v55
    v_max3_u32 v61, v61, v56, v57
    v_max3_u32 v61, v61, v58, v59
    v_cmp_eq_u32 vcc, -1, v61
    s_cbranch_vccz Lok_67
    s_sub_u32 s93, s93, 1
    s_cbranch_scc1 L_end
    s_branch Lretry_68
Lok_67:
Lqok_66:
    v_mfma_f32_16x16x32_bf16 v[24:27], a[240:243], v[52:55], 0
    v_mfma_f32_16x16x32_bf16 v[28:31], v[112:115], v[52:55], 0
    v_mfma_f32_16x16x32_bf16 v[32:35], v[144:147], v[52:55], 0
    v_mfma_f32_16x16x32_bf16 v[36:39], a[224:227], v[52:55], 0
    v_mfma_f32_16x16x32_bf16 v[24:27], a[244:247], v[56:59], v[24:27]
    v_mfma_f32_16x16x32_bf16 v[28:31], v[116:119], v[56:59], v[28:31]
    v_mfma_f32_16x16x32_bf16 v[32:35], v[148:151], v[56:59], v[32:35]
    v_mfma_f32_16x16x32_bf16 v[36:39], a[228:231], v[56:59], v[36:39]
    s_call_b64 s[60:61], SM4
    v_mfma_f32_16x16x32_bf16 v[16:19], v[24:27], a[248:251], v[16:19]
    v_mfma_f32_16x16x32_bf16 v[20:23], v[24:27], a[252:255], v[20:23]
    v_mfma_f32_16x16x32_bf16 v[16:19], v[28:31], v[120:123], v[16:19]
    v_mfma_f32_16x16x32_bf16 v[20:23], v[28:31], v[124:127], v[20:23]
    v_mfma_f32_16x16x32_bf16 v[16:19], v[32:35], v[152:155], v[16:19]
    v_mfma_f32_16x16x32_bf16 v[20:23], v[32:35], v[156:159], v[20:23]
    v_mfma_f32_16x16x32_bf16 v[16:19], v[36:39], a[232:235], v[16:19]
    v_mfma_f32_16x16x32_bf16 v[20:23], v[36:39], a[236:239], v[20:23]
    s_sub_u32 s67, s54, 96
    s_lshl_b32 s94, s67, 11
    s_add_u32 s94, s94, s68
    s_add_u32 s94, s94, 0x8000000
    s_cmp_lt_u32 s67, 8
    s_cselect_b32 s94, s94, 0x40000000
    buffer_load_dwordx4 a[240:243], v2, s[4:7], s94 offen offset:0 nt
    buffer_load_dwordx4 a[244:247], v2, s[4:7], s94 offen offset:256 nt
    buffer_load_dwordx4 a[248:251], v3, s[8:11], s94 offen offset:0 nt
    buffer_load_dwordx4 a[252:255], v3, s[8:11], s94 offen offset:256 nt
    s_sub_u32 s66, s54, 48
    s_lshl_b32 s94, s66, 11
    s_add_u32 s94, s94, s68
    s_add_u32 s94, s94, 0xc000000
    s_cmp_lt_u32 s66, 8
    s_cselect_b32 s94, s94, 0x40000000
    buffer_load_dwordx4 v[112:115], v2, s[4:7], s94 offen offset:0 nt
    buffer_load_dwordx4 v[116:119], v2, s[4:7], s94 offen offset:256 nt
    buffer_load_dwordx4 v[120:123], v3, s[8:11], s94 offen offset:0 nt
    buffer_load_dwordx4 v[124:127], v3, s[8:11], s94 offen offset:256 nt
    s_add_u32 s56, s84, 0xc000000
    s_xor_b32 s57, s56, 6144
    buffer_load_dwordx4 v[144:147], v2, s[4:7], s57 offen offset:0 nt
    buffer_load_dwordx4 v[148:151], v2, s[4:7], s57 offen offset:256 nt
    buffer_load_dwordx4 v[152:155], v3, s[8:11], s57 offen offset:0 nt
    buffer_load_dwordx4 v[156:159], v3, s[8:11], s57 offen offset:256 nt
    v_mfma_f32_16x16x32_bf16 v[24:27], v[192:195], v[52:55], 0
    v_mfma_f32_16x16x32_bf16 v[28:31], v[208:211], v[52:55], 0
    v_mfma_f32_16x16x32_bf16 v[32:35], v[128:131], v[52:55], 0
    v_mfma_f32_16x16x32_bf16 v[36:39], a[80:83], v[52:55], 0
    v_mfma_f32_16x16x32_bf16 v[24:27], v[196:199], v[56:59], v[24:27]
    v_mfma_f32_16x16x32_bf16 v[28:31], v[212:215], v[56:59], v[28:31]
    v_mfma_f32_16x16x32_bf16 v[32:35], v[132:135], v[56:59], v[32:35]
    v_mfma_f32_16x16x32_bf16 v[36:39], a[84:87], v[56:59], v[36:39]
    s_call_b64 s[60:61], SM4
    v_mfma_f32_16x16x32_bf16 v[16:19], v[24:27], v[200:203], v[16:19]
    v_mfma_f32_16x16x32_bf16 v[20:23], v[24:27], v[204:207], v[20:23]
    v_mfma_f32_16x16x32_bf16 v[16:19], v[28:31], v[216:219], v[16:19]
    v_mfma_f32_16x16x32_bf16 v[20:23], v[28:31], v[220:223], v[20:23]
    v_mfma_f32_16x16x32_bf16 v[16:19], v[32:35], v[136:139], v[16:19]
    v_mfma_f32_16x16x32_bf16 v[20:23], v[32:35], v[140:143], v[20:23]
    v_mfma_f32_16x16x32_bf16 v[16:19], v[36:39], a[88:91], v[16:19]
    v_mfma_f32_16x16x32_bf16 v[20:23], v[36:39], a[92:95], v[20:23]
    s_add_u32 s56, s85, 0xc000000
    buffer_load_dwordx4 a[224:227], v2, s[4:7], s56 offen offset:0 nt
    buffer_load_dwordx4 a[228:231], v2, s[4:7], s56 offen offset:256 nt
    buffer_load_dwordx4 a[232:235], v3, s[8:11], s56 offen offset:0 nt
    buffer_load_dwordx4 a[236:239], v3, s[8:11], s56 offen offset:256 nt
    v_mfma_f32_16x16x32_bf16 v[24:27], a[144:147], v[52:55], 0
    v_mfma_f32_16x16x32_bf16 v[28:31], a[128:131], v[52:55], 0
    v_mfma_f32_16x16x32_bf16 v[32:35], a[0:3], v[52:55], 0
    v_mfma_f32_16x16x32_bf16 v[36:39], v[240:243], v[52:55], 0
    v_mfma_f32_16x16x32_bf16 v[24:27], a[148:151], v[56:59], v[24:27]
    v_mfma_f32_16x16x32_bf16 v[28:31], a[132:135], v[56:59], v[28:31]
    v_mfma_f32_16x16x32_bf16 v[32:35], a[4:7], v[56:59], v[32:35]
    v_mfma_f32_16x16x32_bf16 v[36:39], v[244:247], v[56:59], v[36:39]
    s_call_b64 s[60:61], SM4
    v_mfma_f32_16x16x32_bf16 v[16:19], v[24:27], a[152:155], v[16:19]
    v_mfma_f32_16x16x32_bf16 v[20:23], v[24:27], a[156:159], v[20:23]
    v_mfma_f32_16x16x32_bf16 v[16:19], v[28:31], a[136:139], v[16:19]
    v_mfma_f32_16x16x32_bf16 v[20:23], v[28:31], a[140:143], v[20:23]
    v_mfma_f32_16x16x32_bf16 v[16:19], v[32:35], a[8:11], v[16:19]
    v_mfma_f32_16x16x32_bf16 v[20:23], v[32:35], a[12:15], v[20:23]
    v_mfma_f32_16x16x32_bf16 v[16:19], v[36:39], v[248:251], v[16:19]
    v_mfma_f32_16x16x32_bf16 v[20:23], v[36:39], v[252:255], v[20:23]
    s_nop 3
    ds_read_b128 a[144:147], v62 offset:0
    ds_read_b128 a[148:151], v62 offset:1024
    ds_read_b128 a[152:155], v62 offset:2048
    ds_read_b128 a[156:159], v62 offset:3072
    ds_read_b128 a[128:131], v62 offset:16384
    ds_read_b128 a[132:135], v62 offset:17408
    ds_read_b128 a[136:139], v62 offset:18432
    ds_read_b128 a[140:143], v62 offset:19456
    ds_read_b128 a[0:3], v62 offset:32768
    ds_read_b128 a[4:7], v62 offset:33792
    ds_read_b128 a[8:11], v62 offset:34816
    ds_read_b128 a[12:15], v62 offset:35840
    ds_read_b128 v[240:243], v62 offset:49152
    ds_read_b128 v[244:247], v62 offset:50176
    ds_read_b128 v[248:251], v62 offset:51200
    ds_read_b128 v[252:255], v62 offset:52224
    s_waitcnt lgkmcnt(0)
    v_mfma_f32_16x16x32_bf16 v[24:27], a[144:147], v[52:55], 0
    v_mfma_f32_16x16x32_bf16 v[28:31], a[128:131], v[52:55], 0
    v_mfma_f32_16x16x32_bf16 v[32:35], a[0:3], v[52:55], 0
    v_mfma_f32_16x16x32_bf16 v[36:39], v[240:243], v[52:55], 0
    v_mfma_f32_16x16x32_bf16 v[24:27], a[148:151], v[56:59], v[24:27]
    v_mfma_f32_16x16x32_bf16 v[28:31], a[132:135], v[56:59], v[28:31]
    v_mfma_f32_16x16x32_bf16 v[32:35], a[4:7], v[56:59], v[32:35]
    v_mfma_f32_16x16x32_bf16 v[36:39], v[244:247], v[56:59], v[36:39]
    s_call_b64 s[60:61], SM4
    v_mfma_f32_16x16x32_bf16 v[16:19], v[24:27], a[152:155], v[16:19]
    v_mfma_f32_16x16x32_bf16 v[20:23], v[24:27], a[156:159], v[20:23]
    v_mfma_f32_16x16x32_bf16 v[16:19], v[28:31], a[136:139], v[16:19]
    v_mfma_f32_16x16x32_bf16 v[20:23], v[28:31], a[140:143], v[20:23]
    v_mfma_f32_16x16x32_bf16 v[16:19], v[32:35], a[8:11], v[16:19]
    v_mfma_f32_16x16x32_bf16 v[20:23], v[32:35], a[12:15], v[20:23]
    v_mfma_f32_16x16x32_bf16 v[16:19], v[36:39], v[248:251], v[16:19]
    v_mfma_f32_16x16x32_bf16 v[20:23], v[36:39], v[252:255], v[20:23]
    s_nop 3
    v_add_u32 v49, 65536, v62
    ds_read_b128 a[144:147], v49 offset:0
    ds_read_b128 a[148:151], v49 offset:1024
    ds_read_b128 a[152:155], v49 offset:2048
    ds_read_b128 a[156:159], v49 offset:3072
    s_xor_b32 s57, s56, 2048
    buffer_load_dwordx4 v[192:195], v2, s[4:7], s57 offen offset:0 nt
    buffer_load_dwordx4 v[196:199], v2, s[4:7], s57 offen offset:256 nt
    buffer_load_dwordx4 v[200:203], v3, s[8:11], s57 offen offset:0 nt
    buffer_load_dwordx4 v[204:207], v3, s[8:11], s57 offen offset:256 nt
    s_waitcnt lgkmcnt(0)
    v_mfma_f32_16x16x32_bf16 v[24:27], a[144:147], v[52:55], 0
    v_mfma_f32_16x16x32_bf16 v[24:27], a[148:151], v[56:59], v[24:27]
    s_call_b64 s[60:61], SM1
    v_mfma_f32_16x16x32_bf16 v[16:19], v[24:27], a[152:155], v[16:19]
    v_mfma_f32_16x16x32_bf16 v[20:23], v[24:27], a[156:159], v[20:23]
    s_cmp_ge_u32 s67, 8
    s_cbranch_scc1 Lnx_70
    s_waitcnt vmcnt(16)
    v_mfma_f32_16x16x32_bf16 v[24:27], a[240:243], v[52:55], 0
    v_mfma_f32_16x16x32_bf16 v[24:27], a[244:247], v[56:59], v[24:27]
    s_call_b64 s[60:61], SM1
    v_mfma_f32_16x16x32_bf16 v[16:19], v[24:27], a[248:251], v[16:19]
    v_mfma_f32_16x16x32_bf16 v[20:23], v[24:27], a[252:255], v[20:23]
Lnx_70:
    s_mov_b32 s69, 6
    s_mov_b32 s95, 160520
    s_call_b64 s[60:61], WDN
    s_mov_b32 s96, 151808
    s_call_b64 s[60:61], REC
    s_waitcnt vmcnt(28)
    s_waitcnt vmcnt(24)
    s_waitcnt vmcnt(22)
    s_add_u32 s100, s92, 0xc000
    s_branch Lchk_73
Lretry_72:
    buffer_load_dwordx4 v[8:11], v60, s[12:15], s100 offen offset:0 sc1
    buffer_load_dwordx4 v[12:15], v60, s[12:15], s100 offen offset:256 sc1
    s_waitcnt vmcnt(0)
Lchk_73:
    v_max_u32 v61, v8, v9
    v_max3_u32 v61, v61, v10, v11
    v_max3_u32 v61, v61, v12, v13
    v_max3_u32 v61, v61, v14, v15
    v_cmp_eq_u32 vcc, -1, v61
    s_cbranch_vccz Lok_71
    s_sub_u32 s93, s93, 1
    s_cbranch_scc1 L_end
    s_branch Lretry_72
Lok_71:
    s_waitcnt vmcnt(8)
    s_xor_b32 s57, s56, 4096
    buffer_load_dwordx4 v[208:211], v2, s[4:7], s57 offen offset:0 nt
    buffer_load_dwordx4 v[212:215], v2, s[4:7], s57 offen offset:256 nt
    buffer_load_dwordx4 v[216:219], v3, s[8:11], s57 offen offset:0 nt
    buffer_load_dwordx4 v[220:223], v3, s[8:11], s57 offen offset:256 nt
    v_mfma_f32_16x16x32_bf16 v[24:27], a[192:195], v[8:11], 0
    v_mfma_f32_16x16x32_bf16 v[28:31], a[48:51], v[8:11], 0
    v_mfma_f32_16x16x32_bf16 v[32:35], a[32:35], v[8:11], 0
    v_mfma_f32_16x16x32_bf16 v[36:39], v[144:147], v[8:11], 0
    v_mfma_f32_16x16x32_bf16 v[24:27], a[196:199], v[12:15], v[24:27]
    v_mfma_f32_16x16x32_bf16 v[28:31], a[52:55], v[12:15], v[28:31]
    v_mfma_f32_16x16x32_bf16 v[32:35], a[36:39], v[12:15], v[32:35]
    v_mfma_f32_16x16x32_bf16 v[36:39], v[148:151], v[12:15], v[36:39]
    s_call_b64 s[60:61], SM4
    v_mfma_f32_16x16x32_bf16 v[16:19], v[24:27], a[200:203], v[16:19]
    v_mfma_f32_16x16x32_bf16 v[20:23], v[24:27], a[204:207], v[20:23]
    v_mfma_f32_16x16x32_bf16 v[16:19], v[28:31], a[56:59], v[16:19]
    v_mfma_f32_16x16x32_bf16 v[20:23], v[28:31], a[60:63], v[20:23]
    v_mfma_f32_16x16x32_bf16 v[16:19], v[32:35], a[40:43], v[16:19]
    v_mfma_f32_16x16x32_bf16 v[20:23], v[32:35], a[44:47], v[20:23]
    v_mfma_f32_16x16x32_bf16 v[16:19], v[36:39], v[152:155], v[16:19]
    v_mfma_f32_16x16x32_bf16 v[20:23], v[36:39], v[156:159], v[20:23]
    ds_write_b128 v62, a[192:195] offset:0
    ds_write_b128 v62, a[196:199] offset:1024
    ds_write_b128 v62, a[200:203] offset:2048
    ds_write_b128 v62, a[204:207] offset:3072
    ds_write_b128 v62, a[48:51] offset:16384
    ds_write_b128 v62, a[52:55] offset:17408
    ds_write_b128 v62, a[56:59] offset:18432
    ds_write_b128 v62, a[60:63] offset:19456
    ds_write_b128 v62, a[32:35] offset:32768
    ds_write_b128 v62, a[36:39] offset:33792
    ds_write_b128 v62, a[40:43] offset:34816
    ds_write_b128 v62, a[44:47] offset:35840
    ds_write_b128 v62, v[144:147] offset:49152
    ds_write_b128 v62, v[148:151] offset:50176
    ds_write_b128 v62, v[152:155] offset:51200
    ds_write_b128 v62, v[156:159] offset:52224
    s_waitcnt lgkmcnt(0)
    s_cmp_ge_u32 s66, 8
    s_cbranch_scc1 Lnx_74
    v_mfma_f32_16x16x32_bf16 v[24:27], v[112:115], v[8:11], 0
    v_mfma_f32_16x16x32_bf16 v[24:27], v[116:119], v[12:15], v[24:27]
    s_call_b64 s[60:61], SM1
    v_mfma_f32_16x16x32_bf16 v[16:19], v[24:27], v[120:123], v[16:19]
    v_mfma_f32_16x16x32_bf16 v[20:23], v[24:27], v[124:127], v[20:23]
Lnx_74:
    s_waitcnt vmcnt(8)
    s_xor_b32 s57, s56, 6144
    buffer_load_dwordx4 v[128:131], v2, s[4:7], s57 offen offset:0 nt
    buffer_load_dwordx4 v[132:135], v2, s[4:7], s57 offen offset:256 nt
    buffer_load_dwordx4 v[136:139], v3, s[8:11], s57 offen offset:0 nt
    buffer_load_dwordx4 v[140:143], v3, s[8:11], s57 offen offset:256 nt
    s_waitcnt vmcnt(8)
    s_add_u32 s56, s86, 0xc000000
    buffer_load_dwordx4 a[80:83], v2, s[4:7], s56 offen offset:0 nt
    buffer_load_dwordx4 a[84:87], v2, s[4:7], s56 offen offset:256 nt
    buffer_load_dwordx4 a[88:91], v3, s[8:11], s56 offen offset:0 nt
    buffer_load_dwordx4 a[92:95], v3, s[8:11], s56 offen offset:256 nt
    s_waitcnt vmcnt(8)
    s_xor_b32 s57, s56, 2048
    buffer_load_dwordx4 a[128:131], v2, s[4:7], s57 offen offset:0 nt
    buffer_load_dwordx4 a[132:135], v2, s[4:7], s57 offen offset:256 nt
    buffer_load_dwordx4 a[136:139], v3, s[8:11], s57 offen offset:0 nt
    buffer_load_dwordx4 a[140:143], v3, s[8:11], s57 offen offset:256 nt
    s_waitcnt vmcnt(8)
    s_xor_b32 s57, s56, 4096
    buffer_load_dwordx4 a[0:3], v2, s[4:7], s57 offen offset:0 nt
    buffer_load_dwordx4 a[4:7], v2, s[4:7], s57 offen offset:256 nt
    buffer_load_dwordx4 a[8:11], v3, s[8:11], s57 offen offset:0 nt
    buffer_load_dwordx4 a[12:15], v3, s[8:11], s57 offen offset:256 nt
    v_mfma_f32_16x16x32_bf16 v[24:27], a[224:227], v[8:11], 0
    v_mfma_f32_16x16x32_bf16 v[28:31], v[192:195], v[8:11], 0
    v_mfma_f32_16x16x32_bf16 v[32:35], v[208:211], v[8:11], 0
    v_mfma_f32_16x16x32_bf16 v[36:39], v[128:131], v[8:11], 0
    v_mfma_f32_16x16x32_bf16 v[24:27], a[228:231], v[12:15], v[24:27]
    v_mfma_f32_16x16x32_bf16 v[28:31], v[196:199], v[12:15], v[28:31]
    v_mfma_f32_16x16x32_bf16 v[32:35], v[212:215], v[12:15], v[32:35]
    v_mfma_f32_16x16x32_bf16 v[36:39], v[132:135], v[12:15], v[36:39]
    s_call_b64 s[60:61], SM4
    v_mfma_f32_16x16x32_bf16 v[16:19], v[24:27], a[232:235], v[16:19]
    v_mfma_f32_16x16x32_bf16 v[20:23], v[24:27], a[236:239], v[20:23]
    v_mfma_f32_16x16x32_bf16 v[16:19], v[28:31], v[200:203], v[16:19]
    v_mfma_f32_16x16x32_bf16 v[20:23], v[28:31], v[204:207], v[20:23]
    v_mfma_f32_16x16x32_bf16 v[16:19], v[32:35], v[216:219], v[16:19]
    v_mfma_f32_16x16x32_bf16 v[20:23], v[32:35], v[220:223], v[20:23]
    v_mfma_f32_16x16x32_bf16 v[16:19], v[36:39], v[136:139], v[16:19]
    v_mfma_f32_16x16x32_bf16 v[20:23], v[36:39], v[140:143], v[20:23]
    v_add_u32 v49, 65536, v62
    ds_write_b128 v49, a[224:227] offset:0
    ds_write_b128 v49, a[228:231] offset:1024
    ds_write_b128 v49, a[232:235] offset:2048
    ds_write_b128 v49, a[236:239] offset:3072
    s_waitcnt lgkmcnt(0)
    s_waitcnt vmcnt(8)
    s_xor_b32 s57, s56, 6144
    buffer_load_dwordx4 v[240:243], v2, s[4:7], s57 offen offset:0 nt
    buffer_load_dwordx4 v[244:247], v2, s[4:7], s57 offen offset:256 nt
    buffer_load_dwordx4 v[248:251], v3, s[8:11], s57 offen offset:0 nt
    buffer_load_dwordx4 v[252:255], v3, s[8:11], s57 offen offset:256 nt
    s_waitcnt vmcnt(8)
    s_add_u32 s56, s87, 0xc000000
    buffer_load_dwordx4 a[144:147], v2, s[4:7], s56 offen offset:0 nt
    buffer_load_dwordx4 a[148:151], v2, s[4:7], s56 offen offset:256 nt
    buffer_load_dwordx4 a[152:155], v3, s[8:11], s56 offen offset:0 nt
    buffer_load_dwordx4 a[156:159], v3, s[8:11], s56 offen offset:256 nt
    s_waitcnt vmcnt(8)
    s_xor_b32 s57, s56, 2048
    buffer_load_dwordx4 a[240:243], v2, s[4:7], s57 offen offset:0 nt
    buffer_load_dwordx4 a[244:247], v2, s[4:7], s57 offen offset:256 nt
    buffer_load_dwordx4 a[248:251], v3, s[8:11], s57 offen offset:0 nt
    buffer_load_dwordx4 a[252:255], v3, s[8:11], s57 offen offset:256 nt
    s_waitcnt vmcnt(8)
    s_xor_b32 s57, s56, 4096
    buffer_load_dwordx4 a[192:195], v2, s[4:7], s57 offen offset:0 nt
    buffer_load_dwordx4 a[196:199], v2, s[4:7], s57 offen offset:256 nt
    buffer_load_dwordx4 a[200:203], v3, s[8:11], s57 offen offset:0 nt
    buffer_load_dwordx4 a[204:207], v3, s[8:11], s57 offen offset:256 nt
    v_mfma_f32_16x16x32_bf16 v[24:27], a[80:83], v[8:11], 0
    v_mfma_f32_16x16x32_bf16 v[28:31], a[128:131], v[8:11], 0
    v_mfma_f32_16x16x32_bf16 v[32:35], a[0:3], v[8:11], 0
    v_mfma_f32_16x16x32_bf16 v[36:39], v[240:243], v[8:11], 0
    v_mfma_f32_16x16x32_bf16 v[24:27], a[84:87], v[12:15], v[24:27]
    v_mfma_f32_16x16x32_bf16 v[28:31], a[132:135], v[12:15], v[28:31]
    v_mfma_f32_16x16x32_bf16 v[32:35], a[4:7], v[12:15], v[32:35]
    v_mfma_f32_16x16x32_bf16 v[36:39], v[244:247], v[12:15], v[36:39]
    s_call_b64 s[60:61], SM4
    v_mfma_f32_16x16x32_bf16 v[16:19], v[24:27], a[88:91], v[16:19]
    v_mfma_f32_16x16x32_bf16 v[20:23], v[24:27], a[92:95], v[20:23]
    v_mfma_f32_16x16x32_bf16 v[16:19], v[28:31], a[136:139], v[16:19]
    v_mfma_f32_16x16x32_bf16 v[20:23], v[28:31], a[140:143], v[20:23]
    v_mfma_f32_16x16x32_bf16 v[16:19], v[32:35], a[8:11], v[16:19]
    v_mfma_f32_16x16x32_bf16 v[20:23], v[32:35], a[12:15], v[20:23]
    v_mfma_f32_16x16x32_bf16 v[16:19], v[36:39], v[248:251], v[16:19]
    v_mfma_f32_16x16x32_bf16 v[20:23], v[36:39], v[252:255], v[20:23]
    s_waitcnt vmcnt(8)
    s_xor_b32 s57, s56, 6144
    buffer_load_dwordx4 a[48:51], v2, s[4:7], s57 offen offset:0 nt
    buffer_load_dwordx4 a[52:55], v2, s[4:7], s57 offen offset:256 nt
    buffer_load_dwordx4 a[56:59], v3, s[8:11], s57 offen offset:0 nt
    buffer_load_dwordx4 a[60:63], v3, s[8:11], s57 offen offset:256 nt
    s_waitcnt vmcnt(8)
    s_add_u32 s56, s59, 0xc000000
    buffer_load_dwordx4 a[32:35], v2, s[4:7], s56 offen offset:0 nt
    buffer_load_dwordx4 a[36:39], v2, s[4:7], s56 offen offset:256 nt
    buffer_load_dwordx4 a[40:43], v3, s[8:11], s56 offen offset:0 nt
    buffer_load_dwordx4 a[44:47], v3, s[8:11], s56 offen offset:256 nt
    s_waitcnt vmcnt(8)
    s_add_u32 s56, s84, 0xe000000
    buffer_load_dwordx4 v[144:147], v2, s[4:7], s56 offen offset:0 nt
    buffer_load_dwordx4 v[148:151], v2, s[4:7], s56 offen offset:256 nt
    buffer_load_dwordx4 v[152:155], v3, s[8:11], s56 offen offset:0 nt
    buffer_load_dwordx4 v[156:159], v3, s[8:11], s56 offen offset:256 nt
    s_waitcnt vmcnt(8)
    s_add_u32 s94, s92, 0x1a000
    buffer_load_dwordx4 v[52:55], v60, s[12:15], s94 offen offset:0 sc1
    buffer_load_dwordx4 v[56:59], v60, s[12:15], s94 offen offset:256 sc1
    s_xor_b32 s57, s56, 2048
    buffer_load_dwordx4 v[112:115], v2, s[4:7], s57 offen offset:0 nt
    buffer_load_dwordx4 v[116:119], v2, s[4:7], s57 offen offset:256 nt
    buffer_load_dwordx4 v[120:123], v3, s[8:11], s57 offen offset:0 nt
    buffer_load_dwordx4 v[124:127], v3, s[8:11], s57 offen offset:256 nt
    v_mfma_f32_16x16x32_bf16 v[24:27], a[144:147], v[8:11], 0
    v_mfma_f32_16x16x32_bf16 v[28:31], a[240:243], v[8:11], 0
    v_mfma_f32_16x16x32_bf16 v[32:35], a[192:195], v[8:11], 0
    v_mfma_f32_16x16x32_bf16 v[36:39], a[48:51], v[8:11], 0
    v_mfma_f32_16x16x32_bf16 v[24:27], a[148:151], v[12:15], v[24:27]
    v_mfma_f32_16x16x32_bf16 v[28:31], a[244:247], v[12:15], v[28:31]
    v_mfma_f32_16x16x32_bf16 v[32:35], a[196:199], v[12:15], v[32:35]
    v_mfma_f32_16x16x32_bf16 v[36:39], a[52:55], v[12:15], v[36:39]
    s_call_b64 s[60:61], SM4
    v_mfma_f32_16x16x32_bf16 v[16:19], v[24:27], a[152:155], v[16:19]
    v_mfma_f32_16x16x32_bf16 v[20:23], v[24:27], a[156:159], v[20:23]
    v_mfma_f32_16x16x32_bf16 v[16:19], v[28:31], a[248:251], v[16:19]
    v_mfma_f32_16x16x32_bf16 v[20:23], v[28:31], a[252:255], v[20:23]
    v_mfma_f32_16x16x32_bf16 v[16:19], v[32:35], a[200:203], v[16:19]
    v_mfma_f32_16x16x32_bf16 v[20:23], v[32:35], a[204:207], v[20:23]
    v_mfma_f32_16x16x32_bf16 v[16:19], v[36:39], a[56:59], v[16:19]
    v_mfma_f32_16x16x32_bf16 v[20:23], v[36:39], a[60:63], v[20:23]
    s_waitcnt vmcnt(10)
    s_xor_b32 s57, s56, 4096
    buffer_load_dwordx4 a[224:227], v2, s[4:7], s57 offen offset:0 nt
    buffer_load_dwordx4 a[228:231], v2, s[4:7], s57 offen offset:256 nt
    buffer_load_dwordx4 a[232:235], v3, s[8:11], s57 offen offset:0 nt
    buffer_load_dwordx4 a[236:239], v3, s[8:11], s57 offen offset:256 nt
    v_mfma_f32_16x16x32_bf16 v[24:27], a[32:35], v[8:11], 0
    v_mfma_f32_16x16x32_bf16 v[24:27], a[36:39], v[12:15], v[24:27]
    s_call_b64 s[60:61], SM1
    v_mfma_f32_16x16x32_bf16 v[16:19], v[24:27], a[40:43], v[16:19]
    v_mfma_f32_16x16x32_bf16 v[20:23], v[24:27], a[44:47], v[20:23]
    s_add_u32 s94, s92, 0xe000
    buffer_load_dwordx4 v[8:11], v60, s[12:15], s94 offen offset:0 sc1
    buffer_load_dwordx4 v[12:15], v60, s[12:15], s94 offen offset:256 sc1
    s_mov_b32 s69, 6
    s_mov_b32 s95, 160516
    s_call_b64 s[60:61], WDN
    s_mov_b32 s96, 147456
    s_call_b64 s[60:61], REC
    s_call_b64 s[60:61], ARR
    s_cmp_eq_u32 s94, 3
    s_cbranch_scc1 Lal_75
    s_cmp_eq_u32 s94, 0
    s_cbranch_scc1 Laf_76
    s_mov_b32 s56, 0x40000000
    s_mov_b32 s57, 0x40000000
    s_call_b64 s[60:61], MST
    s_branch Lad_77
Laf_76:
    s_mov_b32 s96, 156160
    s_add_u32 s56, s90, 0x2c0000
    s_add_u32 s57, s91, 0xb0000
    s_call_b64 s[60:61], MRG
    v_mov_b32 v32, 160520
    v_mov_b32 v33, 7
    ds_write_b32 v32, v33
    s_branch Lad_77
Lal_75:
    s_mov_b32 s96, 147456
    s_add_u32 s56, s90, 0x180000
    s_add_u32 s57, s91, 0x60000
    s_call_b64 s[60:61], MRG
    v_mov_b32 v32, 160516
    v_mov_b32 v33, 7
    ds_write_b32 v32, v33
Lad_77:
    s_waitcnt vmcnt(14)
    s_waitcnt vmcnt(12)
    s_add_u32 s100, s92, 0x1a000
    s_branch Lchk_81
Lretry_80:
    buffer_load_dwordx4 v[52:55], v60, s[12:15], s100 offen offset:0 sc1
    buffer_load_dwordx4 v[56:59], v60, s[12:15], s100 offen offset:256 sc1
    s_waitcnt vmcnt(0)
Lchk_81:
    v_max_u32 v61, v52, v53
    v_max3_u32 v61, v61, v54, v55
    v_max3_u32 v61, v61, v56, v57
    v_max3_u32 v61, v61, v58, v59
    v_cmp_eq_u32 vcc, -1, v61
    s_cbranch_vccz Lok_79
    s_sub_u32 s93, s93, 1
    s_cbranch_scc1 L_end
    s_branch Lretry_80
Lok_79:
Lqok_78:
    v_mfma_f32_16x16x32_bf16 v[24:27], a[208:211], v[52:55], 0
    v_mfma_f32_16x16x32_bf16 v[28:31], a[64:67], v[52:55], 0
    v_mfma_f32_16x16x32_bf16 v[32:35], v[176:179], v[52:55], 0
    v_mfma_f32_16x16x32_bf16 v[36:39], v[64:67], v[52:55], 0
    v_mfma_f32_16x16x32_bf16 v[24:27], a[212:215], v[56:59], v[24:27]
    v_mfma_f32_16x16x32_bf16 v[28:31], a[68:71], v[56:59], v[28:31]
    v_mfma_f32_16x16x32_bf16 v[32:35], v[180:183], v[56:59], v[32:35]
    v_mfma_f32_16x16x32_bf16 v[36:39], v[68:71], v[56:59], v[36:39]
    s_call_b64 s[60:61], SM4
    v_mfma_f32_16x16x32_bf16 v[16:19], v[24:27], a[216:219], v[16:19]
    v_mfma_f32_16x16x32_bf16 v[20:23], v[24:27], a[220:223], v[20:23]
    v_mfma_f32_16x16x32_bf16 v[16:19], v[28:31], a[72:75], v[16:19]
    v_mfma_f32_16x16x32_bf16 v[20:23], v[28:31], a[76:79], v[20:23]
    v_mfma_f32_16x16x32_bf16 v[16:19], v[32:35], v[184:187], v[16:19]
    v_mfma_f32_16x16x32_bf16 v[20:23], v[32:35], v[188:191], v[20:23]
    v_mfma_f32_16x16x32_bf16 v[16:19], v[36:39], v[72:75], v[16:19]
    v_mfma_f32_16x16x32_bf16 v[20:23], v[36:39], v[76:79], v[20:23]
    s_sub_u32 s67, s54, 104
    s_lshl_b32 s94, s67, 11
    s_add_u32 s94, s94, s68
    s_add_u32 s94, s94, 0xa000000
    s_cmp_lt_u32 s67, 8
    s_cselect_b32 s94, s94, 0x40000000
    buffer_load_dwordx4 a[208:211], v2, s[4:7], s94 offen offset:0 nt
    buffer_load_dwordx4 a[212:215], v2, s[4:7], s94 offen offset:256 nt
    buffer_load_dwordx4 a[216:219], v3, s[8:11], s94 offen offset:0 nt
    buffer_load_dwordx4 a[220:223], v3, s[8:11], s94 offen offset:256 nt
    s_sub_u32 s66, s54, 56
    s_lshl_b32 s94, s66, 11
    s_add_u32 s94, s94, s68
    s_add_u32 s94, s94, 0xe000000
    s_cmp_lt_u32 s66, 8
    s_cselect_b32 s94, s94, 0x40000000
    buffer_load_dwordx4 a[64:67], v2, s[4:7], s94 offen offset:0 nt
    buffer_load_dwordx4 a[68:71], v2, s[4:7], s94 offen offset:256 nt
    buffer_load_dwordx4 a[72:75], v3, s[8:11], s94 offen offset:0 nt
    buffer_load_dwordx4 a[76:79], v3, s[8:11], s94 offen offset:256 nt
    s_add_u32 s56, s84, 0xe000000
    s_xor_b32 s57, s56, 6144
    buffer_load_dwordx4 v[176:179], v2, s[4:7], s57 offen offset:0 nt
    buffer_load_dwordx4 v[180:183], v2, s[4:7], s57 offen offset:256 nt
    buffer_load_dwordx4 v[184:187], v3, s[8:11], s57 offen offset:0 nt
    buffer_load_dwordx4 v[188:191], v3, s[8:11], s57 offen offset:256 nt
    v_mfma_f32_16x16x32_bf16 v[24:27], v[80:83], v[52:55], 0
    v_mfma_f32_16x16x32_bf16 v[28:31], a[96:99], v[52:55], 0
    v_mfma_f32_16x16x32_bf16 v[32:35], v[96:99], v[52:55], 0
    v_mfma_f32_16x16x32_bf16 v[36:39], v[160:163], v[52:55], 0
    v_mfma_f32_16x16x32_bf16 v[24:27], v[84:87], v[56:59], v[24:27]
    v_mfma_f32_16x16x32_bf16 v[28:31], a[100:103], v[56:59], v[28:31]
    v_mfma_f32_16x16x32_bf16 v[32:35], v[100:103], v[56:59], v[32:35]
    v_mfma_f32_16x16x32_bf16 v[36:39], v[164:167], v[56:59], v[36:39]
    s_call_b64 s[60:61], SM4
    v_mfma_f32_16x16x32_bf16 v[16:19], v[24:27], v[88:91], v[16:19]
    v_mfma_f32_16x16x32_bf16 v[20:23], v[24:27], v[92:95], v[20:23]
    v_mfma_f32_16x16x32_bf16 v[16:19], v[28:31], a[104:107], v[16:19]
    v_mfma_f32_16x16x32_bf16 v[20:23], v[28:31], a[108:111], v[20:23]
    v_mfma_f32_16x16x32_bf16 v[16:19], v[32:35], v[104:107], v[16:19]
    v_mfma_f32_16x16x32_bf16 v[20:23], v[32:35], v[108:111], v[20:23]
    v_mfma_f32_16x16x32_bf16 v[16:19], v[36:39], v[168:171], v[16:19]
    v_mfma_f32_16x16x32_bf16 v[20:23], v[36:39], v[172:175], v[20:23]
    s_add_u32 s56, s85, 0xe000000
    buffer_load_dwordx4 v[64:67], v2, s[4:7], s56 offen offset:0 nt
    buffer_load_dwordx4 v[68:71], v2, s[4:7], s56 offen offset:256 nt
    buffer_load_dwordx4 v[72:75], v3, s[8:11], s56 offen offset:0 nt
    buffer_load_dwordx4 v[76:79], v3, s[8:11], s56 offen offset:256 nt
    v_mfma_f32_16x16x32_bf16 v[24:27], v[224:227], v[52:55], 0
    v_mfma_f32_16x16x32_bf16 v[28:31], a[112:115], v[52:55], 0
    v_mfma_f32_16x16x32_bf16 v[32:35], a[16:19], v[52:55], 0
    v_mfma_f32_16x16x32_bf16 v[36:39], a[176:179], v[52:55], 0
    v_mfma_f32_16x16x32_bf16 v[24:27], v[228:231], v[56:59], v[24:27]
    v_mfma_f32_16x16x32_bf16 v[28:31], a[116:119], v[56:59], v[28:31]
    v_mfma_f32_16x16x32_bf16 v[32:35], a[20:23], v[56:59], v[32:35]
    v_mfma_f32_16x16x32_bf16 v[36:39], a[180:183], v[56:59], v[36:39]
    s_call_b64 s[60:61], SM4
    v_mfma_f32_16x16x32_bf16 v[16:19], v[24:27], v[232:235], v[16:19]
    v_mfma_f32_16x16x32_bf16 v[20:23], v[24:27], v[236:239], v[20:23]
    v_mfma_f32_16x16x32_bf16 v[16:19], v[28:31], a[120:123], v[16:19]
    v_mfma_f32_16x16x32_bf16 v[20:23], v[28:31], a[124:127], v[20:23]
    v_mfma_f32_16x16x32_bf16 v[16:19], v[32:35], a[24:27], v[16:19]
    v_mfma_f32_16x16x32_bf16 v[20:23], v[32:35], a[28:31], v[20:23]
    v_mfma_f32_16x16x32_bf16 v[16:19], v[36:39], a[184:187], v[16:19]
    v_mfma_f32_16x16x32_bf16 v[20:23], v[36:39], a[188:191], v[20:23]
    s_nop 3
    v_add_u32 v49, 65536, v62
    ds_read_b128 v[224:227], v49 offset:16384
    ds_read_b128 v[228:231], v49 offset:17408
    ds_read_b128 v[232:235], v49 offset:18432
    ds_read_b128 v[236:239], v49 offset:19456
    v_add_u32 v49, 65536, v62
    ds_read_b128 a[112:115], v49 offset:32768
    ds_read_b128 a[116:119], v49 offset:33792
    ds_read_b128 a[120:123], v49 offset:34816
    ds_read_b128 a[124:127], v49 offset:35840
    v_add_u32 v49, 65536, v62
    ds_read_b128 a[16:19], v49 offset:49152
    ds_read_b128 a[20:23], v49 offset:50176
    ds_read_b128 a[24:27], v49 offset:51200
    ds_read_b128 a[28:31], v49 offset:52224
    v_add_u32 v49, 131072, v62
    ds_read_b128 a[176:179], v49 offset:0
    ds_read_b128 a[180:183], v49 offset:1024
    ds_read_b128 a[184:187], v49 offset:2048
    ds_read_b128 a[188:191], v49 offset:3072
    v_mfma_f32_16x16x32_bf16 v[24:27], a[160:163], v[52:55], 0
    v_mfma_f32_16x16x32_bf16 v[24:27], a[164:167], v[56:59], v[24:27]
    s_call_b64 s[60:61], SM1
    v_mfma_f32_16x16x32_bf16 v[16:19], v[24:27], a[168:171], v[16:19]
    v_mfma_f32_16x16x32_bf16 v[20:23], v[24:27], a[172:175], v[20:23]
    s_waitcnt lgkmcnt(0)
    v_mfma_f32_16x16x32_bf16 v[24:27], v[224:227], v[52:55], 0
    v_mfma_f32_16x16x32_bf16 v[28:31], a[112:115], v[52:55], 0
    v_mfma_f32_16x16x32_bf16 v[32:35], a[16:19], v[52:55], 0
    v_mfma_f32_16x16x32_bf16 v[36:39], a[176:179], v[52:55], 0
    v_mfma_f32_16x16x32_bf16 v[24:27], v[228:231], v[56:59], v[24:27]
    v_mfma_f32_16x16x32_bf16 v[28:31], a[116:119], v[56:59], v[28:31]
    v_mfma_f32_16x16x32_bf16 v[32:35], a[20:23], v[56:59], v[32:35]
    v_mfma_f32_16x16x32_bf16 v[36:39], a[180:183], v[56:59], v[36:39]
    s_call_b64 s[60:61], SM4
    v_mfma_f32_16x16x32_bf16 v[16:19], v[24:27], v[232:235], v[16:19]
    v_mfma_f32_16x16x32_bf16 v[20:23], v[24:27], v[236:239], v[20:23]
    v_mfma_f32_16x16x32_bf16 v[16:19], v[28:31], a[120:123], v[16:19]
    v_mfma_f32_16x16x32_bf16 v[20:23], v[28:31], a[124:127], v[20:23]
    v_mfma_f32_16x16x32_bf16 v[16:19], v[32:35], a[24:27], v[16:19]
    v_mfma_f32_16x16x32_bf16 v[20:23], v[32:35], a[28:31], v[20:23]
    v_mfma_f32_16x16x32_bf16 v[16:19], v[36:39], a[184:187], v[16:19]
    v_mfma_f32_16x16x32_bf16 v[20:23], v[36:39], a[188:191], v[20:23]
    s_xor_b32 s57, s56, 2048
    buffer_load_dwordx4 v[80:83], v2, s[4:7], s57 offen offset:0 nt
    buffer_load_dwordx4 v[84:87], v2, s[4:7], s57 offen offset:256 nt
    buffer_load_dwordx4 v[88:91], v3, s[8:11], s57 offen offset:0 nt
    buffer_load_dwordx4 v[92:95], v3, s[8:11], s57 offen offset:256 nt
    s_cmp_ge_u32 s67, 8
    s_cbranch_scc1 Lnx_82
    s_waitcnt vmcnt(16)
    v_mfma_f32_16x16x32_bf16 v[24:27], a[208:211], v[52:55], 0
    v_mfma_f32_16x16x32_bf16 v[24:27], a[212:215], v[56:59], v[24:27]
    s_call_b64 s[60:61], SM1
    v_mfma_f32_16x16x32_bf16 v[16:19], v[24:27], a[216:219], v[16:19]
    v_mfma_f32_16x16x32_bf16 v[20:23], v[24:27], a[220:223], v[20:23]
Lnx_82:
    s_mov_b32 s69, 7
    s_mov_b32 s95, 160520
    s_call_b64 s[60:61], WDN
    s_mov_b32 s96, 156160
    s_call_b64 s[60:61], REC
    s_waitcnt vmcnt(28)
    s_waitcnt vmcnt(24)
    s_waitcnt vmcnt(22)
    s_add_u32 s100, s92, 0xe000
    s_branch Lchk_85
Lretry_84:
    buffer_load_dwordx4 v[8:11], v60, s[12:15], s100 offen offset:0 sc1
    buffer_load_dwordx4 v[12:15], v60, s[12:15], s100 offen offset:256 sc1
    s_waitcnt vmcnt(0)
Lchk_85:
    v_max_u32 v61, v8, v9
    v_max3_u32 v61, v61, v10, v11
    v_max3_u32 v61, v61, v12, v13
    v_max3_u32 v61, v61, v14, v15
    v_cmp_eq_u32 vcc, -1, v61
    s_cbranch_vccz Lok_83
    s_sub_u32 s93, s93, 1
    s_cbranch_scc1 L_end
    s_branch Lretry_84
Lok_83:
    s_waitcnt vmcnt(8)
    s_xor_b32 s57, s56, 4096
    buffer_load_dwordx4 a[96:99], v2, s[4:7], s57 offen offset:0 nt
    buffer_load_dwordx4 a[100:103], v2, s[4:7], s57 offen offset:256 nt
    buffer_load_dwordx4 a[104:107], v3, s[8:11], s57 offen offset:0 nt
    buffer_load_dwordx4 a[108:111], v3, s[8:11], s57 offen offset:256 nt
    v_mfma_f32_16x16x32_bf16 v[24:27], v[144:147], v[8:11], 0
    v_mfma_f32_16x16x32_bf16 v[28:31], v[112:115], v[8:11], 0
    v_mfma_f32_16x16x32_bf16 v[32:35], a[224:227], v[8:11], 0
    v_mfma_f32_16x16x32_bf16 v[36:39], v[176:179], v[8:11], 0
    v_mfma_f32_16x16x32_bf16 v[24:27], v[148:151], v[12:15], v[24:27]
    v_mfma_f32_16x16x32_bf16 v[28:31], v[116:119], v[12:15], v[28:31]
    v_mfma_f32_16x16x32_bf16 v[32:35], a[228:231], v[12:15], v[32:35]
    v_mfma_f32_16x16x32_bf16 v[36:39], v[180:183], v[12:15], v[36:39]
    s_call_b64 s[60:61], SM4
    v_mfma_f32_16x16x32_bf16 v[16:19], v[24:27], v[152:155], v[16:19]
    v_mfma_f32_16x16x32_bf16 v[20:23], v[24:27], v[156:159], v[20:23]
    v_mfma_f32_16x16x32_bf16 v[16:19], v[28:31], v[120:123], v[16:19]
    v_mfma_f32_16x16x32_bf16 v[20:23], v[28:31], v[124:127], v[20:23]
    v_mfma_f32_16x16x32_bf16 v[16:19], v[32:35], a[232:235], v[16:19]
    v_mfma_f32_16x16x32_bf16 v[20:23], v[32:35], a[236:239], v[20:23]
    v_mfma_f32_16x16x32_bf16 v[16:19], v[36:39], v[184:187], v[16:19]
    v_mfma_f32_16x16x32_bf16 v[20:23], v[36:39], v[188:191], v[20:23]
    v_add_u32 v49, 65536, v62
    ds_write_b128 v49, v[144:147] offset:16384
    ds_write_b128 v49, v[148:151] offset:17408
    ds_write_b128 v49, v[152:155] offset:18432
    ds_write_b128 v49, v[156:159] offset:19456
    v_add_u32 v49, 65536, v62
    ds_write_b128 v49, v[112:115] offset:32768
    ds_write_b128 v49, v[116:119] offset:33792
    ds_write_b128 v49, v[120:123] offset:34816
    ds_write_b128 v49, v[124:127] offset:35840
    v_add_u32 v49, 65536, v62
    ds_write_b128 v49, a[224:227] offset:49152
    ds_write_b128 v49, a[228:231] offset:50176
    ds_write_b128 v49, a[232:235] offset:51200
    ds_write_b128 v49, a[236:239] offset:52224
    v_add_u32 v49, 131072, v62
    ds_write_b128 v49, v[176:179] offset:0
    ds_write_b128 v49, v[180:183] offset:1024
    ds_write_b128 v49, v[184:187] offset:2048
    ds_write_b128 v49, v[188:191] offset:3072
    s_waitcnt lgkmcnt(0)
    s_cmp_ge_u32 s66, 8
    s_cbranch_scc1 Lnx_86
    v_mfma_f32_16x16x32_bf16 v[24:27], a[64:67], v[8:11], 0
    v_mfma_f32_16x16x32_bf16 v[24:27], a[68:71], v[12:15], v[24:27]
    s_call_b64 s[60:61], SM1
    v_mfma_f32_16x16x32_bf16 v[16:19], v[24:27], a[72:75], v[16:19]
    v_mfma_f32_16x16x32_bf16 v[20:23], v[24:27], a[76:79], v[20:23]
Lnx_86:
    s_waitcnt vmcnt(8)
    s_xor_b32 s57, s56, 6144
    buffer_load_dwordx4 v[96:99], v2, s[4:7], s57 offen offset:0 nt
    buffer_load_dwordx4 v[100:103], v2, s[4:7], s57 offen offset:256 nt
    buffer_load_dwordx4 v[104:107], v3, s[8:11], s57 offen offset:0 nt
    buffer_load_dwordx4 v[108:111], v3, s[8:11], s57 offen offset:256 nt
    s_waitcnt vmcnt(8)
    s_add_u32 s56, s86, 0xe000000
    buffer_load_dwordx4 v[160:163], v2, s[4:7], s56 offen offset:0 nt
    buffer_load_dwordx4 v[164:167], v2, s[4:7], s56 offen offset:256 nt
    buffer_load_dwordx4 v[168:171], v3, s[8:11], s56 offen offset:0 nt
    buffer_load_dwordx4 v[172:175], v3, s[8:11], s56 offen offset:256 nt
    s_waitcnt vmcnt(8)
    s_xor_b32 s57, s56, 2048
    buffer_load_dwordx4 a[160:163], v2, s[4:7], s57 offen offset:0 nt
    buffer_load_dwordx4 a[164:167], v2, s[4:7], s57 offen offset:256 nt
    buffer_load_dwordx4 a[168:171], v3, s[8:11], s57 offen offset:0 nt
    buffer_load_dwordx4 a[172:175], v3, s[8:11], s57 offen offset:256 nt
    s_waitcnt vmcnt(8)
    s_xor_b32 s57, s56, 4096
    buffer_load_dwordx4 v[224:227], v2, s[4:7], s57 offen offset:0 nt
    buffer_load_dwordx4 v[228:231], v2, s[4:7], s57 offen offset:256 nt
    buffer_load_dwordx4 v[232:235], v3, s[8:11], s57 offen offset:0 nt
    buffer_load_dwordx4 v[236:239], v3, s[8:11], s57 offen offset:256 nt
    v_mfma_f32_16x16x32_bf16 v[24:27], v[64:67], v[8:11], 0
    v_mfma_f32_16x16x32_bf16 v[28:31], v[80:83], v[8:11], 0
    v_mfma_f32_16x16x32_bf16 v[32:35], a[96:99], v[8:11], 0
    v_mfma_f32_16x16x32_bf16 v[36:39], v[96:99], v[8:11], 0
    v_mfma_f32_16x16x32_bf16 v[24:27], v[68:71], v[12:15], v[24:27]
    v_mfma_f32_16x16x32_bf16 v[28:31], v[84:87], v[12:15], v[28:31]
    v_mfma_f32_16x16x32_bf16 v[32:35], a[100:103], v[12:15], v[32:35]
    v_mfma_f32_16x16x32_bf16 v[36:39], v[100:103], v[12:15], v[36:39]
    s_call_b64 s[60:61], SM4
    v_mfma_f32_16x16x32_bf16 v[16:19], v[24:27], v[72:75], v[16:19]
    v_mfma_f32_16x16x32_bf16 v[20:23], v[24:27], v[76:79], v[20:23]
    v_mfma_f32_16x16x32_bf16 v[16:19], v[28:31], v[88:91], v[16:19]
    v_mfma_f32_16x16x32_bf16 v[20:23], v[28:31], v[92:95], v[20:23]
    v_mfma_f32_16x16x32_bf16 v[16:19], v[32:35], a[104:107], v[16:19]
    v_mfma_f32_16x16x32_bf16 v[20:23], v[32:35], a[108:111], v[20:23]
    v_mfma_f32_16x16x32_bf16 v[16:19], v[36:39], v[104:107], v[16:19]
    v_mfma_f32_16x16x32_bf16 v[20:23], v[36:39], v[108:111], v[20:23]
    s_waitcnt vmcnt(8)
    s_xor_b32 s57, s56, 6144
    buffer_load_dwordx4 a[112:115], v2, s[4:7], s57 offen offset:0 nt
    buffer_load_dwordx4 a[116:119], v2, s[4:7], s57 offen offset:256 nt
    buffer_load_dwordx4 a[120:123], v3, s[8:11], s57 offen offset:0 nt
    buffer_load_dwordx4 a[124:127], v3, s[8:11], s57 offen offset:256 nt
    s_waitcnt vmcnt(8)
    s_add_u32 s56, s87, 0xe000000
    buffer_load_dwordx4 a[16:19], v2, s[4:7], s56 offen offset:0 nt
    buffer_load_dwordx4 a[20:23], v2, s[4:7], s56 offen offset:256 nt
    buffer_load_dwordx4 a[24:27], v3, s[8:11], s56 offen offset:0 nt
    buffer_load_dwordx4 a[28:31], v3, s[8:11], s56 offen offset:256 nt
    s_waitcnt vmcnt(8)
    s_xor_b32 s57, s56, 2048
    buffer_load_dwordx4 a[176:179], v2, s[4:7], s57 offen offset:0 nt
    buffer_load_dwordx4 a[180:183], v2, s[4:7], s57 offen offset:256 nt
    buffer_load_dwordx4 a[184:187], v3, s[8:11], s57 offen offset:0 nt
    buffer_load_dwordx4 a[188:191], v3, s[8:11], s57 offen offset:256 nt
    s_waitcnt vmcnt(8)
    s_xor_b32 s57, s56, 4096
    buffer_load_dwordx4 a[208:211], v2, s[4:7], s57 offen offset:0 nt
    buffer_load_dwordx4 a[212:215], v2, s[4:7], s57 offen offset:256 nt
    buffer_load_dwordx4 a[216:219], v3, s[8:11], s57 offen offset:0 nt
    buffer_load_dwordx4 a[220:223], v3, s[8:11], s57 offen offset:256 nt
    v_mfma_f32_16x16x32_bf16 v[24:27], v[160:163], v[8:11], 0
    v_mfma_f32_16x16x32_bf16 v[28:31], a[160:163], v[8:11], 0
    v_mfma_f32_16x16x32_bf16 v[32:35], v[224:227], v[8:11], 0
    v_mfma_f32_16x16x32_bf16 v[36:39], a[112:115], v[8:11], 0
    v_mfma_f32_16x16x32_bf16 v[24:27], v[164:167], v[12:15], v[24:27]
    v_mfma_f32_16x16x32_bf16 v[28:31], a[164:167], v[12:15], v[28:31]
    v_mfma_f32_16x16x32_bf16 v[32:35], v[228:231], v[12:15], v[32:35]
    v_mfma_f32_16x16x32_bf16 v[36:39], a[116:119], v[12:15], v[36:39]
    s_call_b64 s[60:61], SM4
    v_mfma_f32_16x16x32_bf16 v[16:19], v[24:27], v[168:171], v[16:19]
    v_mfma_f32_16x16x32_bf16 v[20:23], v[24:27], v[172:175], v[20:23]
    v_mfma_f32_16x16x32_bf16 v[16:19], v[28:31], a[168:171], v[16:19]
    v_mfma_f32_16x16x32_bf16 v[20:23], v[28:31], a[172:175], v[20:23]
    v_mfma_f32_16x16x32_bf16 v[16:19], v[32:35], v[232:235], v[16:19]
    v_mfma_f32_16x16x32_bf16 v[20:23], v[32:35], v[236:239], v[20:23]
    v_mfma_f32_16x16x32_bf16 v[16:19], v[36:39], a[120:123], v[16:19]
    v_mfma_f32_16x16x32_bf16 v[20:23], v[36:39], a[124:127], v[20:23]
    s_waitcnt vmcnt(8)
    s_xor_b32 s57, s56, 6144
    buffer_load_dwordx4 v[144:147], v2, s[4:7], s57 offen offset:0 nt
    buffer_load_dwordx4 v[148:151], v2, s[4:7], s57 offen offset:256 nt
    buffer_load_dwordx4 v[152:155], v3, s[8:11], s57 offen offset:0 nt
    buffer_load_dwordx4 v[156:159], v3, s[8:11], s57 offen offset:256 nt
    s_waitcnt vmcnt(8)
    s_add_u32 s56, s59, 0xe000000
    buffer_load_dwordx4 v[112:115], v2, s[4:7], s56 offen offset:0 nt
    buffer_load_dwordx4 v[116:119], v2, s[4:7], s56 offen offset:256 nt
    buffer_load_dwordx4 v[120:123], v3, s[8:11], s56 offen offset:0 nt
    buffer_load_dwordx4 v[124:127], v3, s[8:11], s56 offen offset:256 nt
    s_waitcnt vmcnt(4)
    v_mfma_f32_16x16x32_bf16 v[24:27], a[16:19], v[8:11], 0
    v_mfma_f32_16x16x32_bf16 v[28:31], a[176:179], v[8:11], 0
    v_mfma_f32_16x16x32_bf16 v[32:35], a[208:211], v[8:11], 0
    v_mfma_f32_16x16x32_bf16 v[36:39], v[144:147], v[8:11], 0
    v_mfma_f32_16x16x32_bf16 v[24:27], a[20:23], v[12:15], v[24:27]
    v_mfma_f32_16x16x32_bf16 v[28:31], a[180:183], v[12:15], v[28:31]
    v_mfma_f32_16x16x32_bf16 v[32:35], a[212:215], v[12:15], v[32:35]
    v_mfma_f32_16x16x32_bf16 v[36:39], v[148:151], v[12:15], v[36:39]
    s_call_b64 s[60:61], SM4
    v_mfma_f32_16x16x32_bf16 v[16:19], v[24:27], a[24:27], v[16:19]
    v_mfma_f32_16x16x32_bf16 v[20:23], v[24:27], a[28:31], v[20:23]
    v_mfma_f32_16x16x32_bf16 v[16:19], v[28:31], a[184:187], v[16:19]
    v_mfma_f32_16x16x32_bf16 v[20:23], v[28:31], a[188:191], v[20:23]
    v_mfma_f32_16x16x32_bf16 v[16:19], v[32:35], a[216:219], v[16:19]
    v_mfma_f32_16x16x32_bf16 v[20:23], v[32:35], a[220:223], v[20:23]
    v_mfma_f32_16x16x32_bf16 v[16:19], v[36:39], v[152:155], v[16:19]
    v_mfma_f32_16x16x32_bf16 v[20:23], v[36:39], v[156:159], v[20:23]
    s_waitcnt vmcnt(0)
    v_mfma_f32_16x16x32_bf16 v[24:27], v[112:115], v[8:11], 0
    v_mfma_f32_16x16x32_bf16 v[24:27], v[116:119], v[12:15], v[24:27]
    s_call_b64 s[60:61], SM1
    v_mfma_f32_16x16x32_bf16 v[16:19], v[24:27], v[120:123], v[16:19]
    v_mfma_f32_16x16x32_bf16 v[20:23], v[24:27], v[124:127], v[20:23]
    s_mov_b32 s69, 7
    s_mov_b32 s95, 160516
    s_call_b64 s[60:61], WDN
    s_mov_b32 s96, 147456
    s_call_b64 s[60:61], REC
    s_call_b64 s[60:61], ARR
    s_cmp_eq_u32 s94, 3
    s_cbranch_scc1 Lal_87
    s_cmp_eq_u32 s94, 0
    s_cbranch_scc1 Laf_88
    s_mov_b32 s56, 0x40000000
    s_mov_b32 s57, 0x40000000
    s_call_b64 s[60:61], MST
    s_branch Lad_89
Laf_88:
    s_mov_b32 s96, 151808
    s_add_u32 s56, s90, 0x300000
    s_add_u32 s57, s91, 0xc0000
    s_call_b64 s[60:61], MRG
    v_mov_b32 v32, 160520
    v_mov_b32 v33, 8
    ds_write_b32 v32, v33
    s_branch Lad_89
Lal_87:
    s_mov_b32 s96, 147456
    s_add_u32 s56, s90, 0x1c0000
    s_add_u32 s57, s91, 0x70000
    s_call_b64 s[60:61], MRG
    v_mov_b32 v32, 160516
    v_mov_b32 v33, 8
    ds_write_b32 v32, v33
Lad_89:
    s_add_u32 s94, s92, 0x1c000
    buffer_load_dwordx4 v[52:55], v60, s[12:15], s94 offen offset:0 sc1
    buffer_load_dwordx4 v[56:59], v60, s[12:15], s94 offen offset:256 sc1
    s_waitcnt vmcnt(0)
    s_add_u32 s100, s92, 0x1c000
    s_branch Lchk_92
Lretry_91:
    buffer_load_dwordx4 v[52:55], v60, s[12:15], s100 offen offset:0 sc1
    buffer_load_dwordx4 v[56:59], v60, s[12:15], s100 offen offset:256 sc1
    s_waitcnt vmcnt(0)
Lchk_92:
    v_max_u32 v61, v52, v53
    v_max3_u32 v61, v61, v54, v55
    v_max3_u32 v61, v61, v56, v57
    v_max3_u32 v61, v61, v58, v59
    v_cmp_eq_u32 vcc, -1, v61
    s_cbranch_vccz Lok_90
    s_sub_u32 s93, s93, 1
    s_cbranch_scc1 L_end
    s_branch Lretry_91
Lok_90:
    v_mfma_f32_16x16x32_bf16 v[24:27], v[192:195], v[52:55], 0
    v_mfma_f32_16x16x32_bf16 v[28:31], v[208:211], v[52:55], 0
    v_mfma_f32_16x16x32_bf16 v[32:35], v[128:131], v[52:55], 0
    v_mfma_f32_16x16x32_bf16 v[36:39], a[80:83], v[52:55], 0
    v_mfma_f32_16x16x32_bf16 v[24:27], v[196:199], v[56:59], v[24:27]
    v_mfma_f32_16x16x32_bf16 v[28:31], v[212:215], v[56:59], v[28:31]
    v_mfma_f32_16x16x32_bf16 v[32:35], v[132:135], v[56:59], v[32:35]
    v_mfma_f32_16x16x32_bf16 v[36:39], a[84:87], v[56:59], v[36:39]
    s_call_b64 s[60:61], SM4
    v_mfma_f32_16x16x32_bf16 v[16:19], v[24:27], v[200:203], v[16:19]
    v_mfma_f32_16x16x32_bf16 v[20:23], v[24:27], v[204:207], v[20:23]
    v_mfma_f32_16x16x32_bf16 v[16:19], v[28:31], v[216:219], v[16:19]
    v_mfma_f32_16x16x32_bf16 v[20:23], v[28:31], v[220:223], v[20:23]
    v_mfma_f32_16x16x32_bf16 v[16:19], v[32:35], v[136:139], v[16:19]
    v_mfma_f32_16x16x32_bf16 v[20:23], v[32:35], v[140:143], v[20:23]
    v_mfma_f32_16x16x32_bf16 v[16:19], v[36:39], a[88:91], v[16:19]
    v_mfma_f32_16x16x32_bf16 v[20:23], v[36:39], a[92:95], v[20:23]
    s_sub_u32 s67, s54, 112
    s_lshl_b32 s94, s67, 11
    s_add_u32 s94, s94, s68
    s_add_u32 s94, s94, 0xc000000
    s_cmp_lt_u32 s67, 8
    s_cselect_b32 s94, s94, 0x40000000
    buffer_load_dwordx4 a[224:227], v2, s[4:7], s94 offen offset:0 nt
    buffer_load_dwordx4 a[228:231], v2, s[4:7], s94 offen offset:256 nt
    buffer_load_dwordx4 a[232:235], v3, s[8:11], s94 offen offset:0 nt
    buffer_load_dwordx4 a[236:239], v3, s[8:11], s94 offen offset:256 nt
    v_mfma_f32_16x16x32_bf16 v[24:27], a[128:131], v[52:55], 0
    v_mfma_f32_16x16x32_bf16 v[28:31], a[0:3], v[52:55], 0
    v_mfma_f32_16x16x32_bf16 v[32:35], v[240:243], v[52:55], 0
    v_mfma_f32_16x16x32_bf16 v[36:39], a[144:147], v[52:55], 0
    v_mfma_f32_16x16x32_bf16 v[24:27], a[132:135], v[56:59], v[24:27]
    v_mfma_f32_16x16x32_bf16 v[28:31], a[4:7], v[56:59], v[28:31]
    v_mfma_f32_16x16x32_bf16 v[32:35], v[244:247], v[56:59], v[32:35]
    v_mfma_f32_16x16x32_bf16 v[36:39], a[148:151], v[56:59], v[36:39]
    s_call_b64 s[60:61], SM4
    v_mfma_f32_16x16x32_bf16 v[16:19], v[24:27], a[136:139], v[16:19]
    v_mfma_f32_16x16x32_bf16 v[20:23], v[24:27], a[140:143], v[20:23]
    v_mfma_f32_16x16x32_bf16 v[16:19], v[28:31], a[8:11], v[16:19]
    v_mfma_f32_16x16x32_bf16 v[20:23], v[28:31], a[12:15], v[20:23]
    v_mfma_f32_16x16x32_bf16 v[16:19], v[32:35], v[248:251], v[16:19]
    v_mfma_f32_16x16x32_bf16 v[20:23], v[32:35], v[252:255], v[20:23]
    v_mfma_f32_16x16x32_bf16 v[16:19], v[36:39], a[152:155], v[16:19]
    v_mfma_f32_16x16x32_bf16 v[20:23], v[36:39], a[156:159], v[20:23]
    v_mfma_f32_16x16x32_bf16 v[24:27], a[240:243], v[52:55], 0
    v_mfma_f32_16x16x32_bf16 v[28:31], a[192:195], v[52:55], 0
    v_mfma_f32_16x16x32_bf16 v[32:35], a[48:51], v[52:55], 0
    v_mfma_f32_16x16x32_bf16 v[36:39], a[32:35], v[52:55], 0
    v_mfma_f32_16x16x32_bf16 v[24:27], a[244:247], v[56:59], v[24:27]
    v_mfma_f32_16x16x32_bf16 v[28:31], a[196:199], v[56:59], v[28:31]
    v_mfma_f32_16x16x32_bf16 v[32:35], a[52:55], v[56:59], v[32:35]
    v_mfma_f32_16x16x32_bf16 v[36:39], a[36:39], v[56:59], v[36:39]
    s_call_b64 s[60:61], SM4
    v_mfma_f32_16x16x32_bf16 v[16:19], v[24:27], a[248:251], v[16:19]
    v_mfma_f32_16x16x32_bf16 v[20:23], v[24:27], a[252:255], v[20:23]
    v_mfma_f32_16x16x32_bf16 v[16:19], v[28:31], a[200:203], v[16:19]
    v_mfma_f32_16x16x32_bf16 v[20:23], v[28:31], a[204:207], v[20:23]
    v_mfma_f32_16x16x32_bf16 v[16:19], v[32:35], a[56:59], v[16:19]
    v_mfma_f32_16x16x32_bf16 v[20:23], v[32:35], a[60:63], v[20:23]
    v_mfma_f32_16x16x32_bf16 v[16:19], v[36:39], a[40:43], v[16:19]
    v_mfma_f32_16x16x32_bf16 v[20:23], v[36:39], a[44:47], v[20:23]
    s_nop 3
    ds_read_b128 a[240:243], v62 offset:0
    ds_read_b128 a[244:247], v62 offset:1024
    ds_read_b128 a[248:251], v62 offset:2048
    ds_read_b128 a[252:255], v62 offset:3072
    ds_read_b128 a[192:195], v62 offset:16384
    ds_read_b128 a[196:199], v62 offset:17408
    ds_read_b128 a[200:203], v62 offset:18432
    ds_read_b128 a[204:207], v62 offset:19456
    ds_read_b128 a[48:51], v62 offset:32768
    ds_read_b128 a[52:55], v62 offset:33792
    ds_read_b128 a[56:59], v62 offset:34816
    ds_read_b128 a[60:63], v62 offset:35840
    ds_read_b128 a[32:35], v62 offset:49152
    ds_read_b128 a[36:39], v62 offset:50176
    ds_read_b128 a[40:43], v62 offset:51200
    ds_read_b128 a[44:47], v62 offset:52224
    s_waitcnt lgkmcnt(0)
    v_mfma_f32_16x16x32_bf16 v[24:27], a[240:243], v[52:55], 0
    v_mfma_f32_16x16x32_bf16 v[28:31], a[192:195], v[52:55], 0
    v_mfma_f32_16x16x32_bf16 v[32:35], a[48:51], v[52:55], 0
    v_mfma_f32_16x16x32_bf16 v[36:39], a[32:35], v[52:55], 0
    v_mfma_f32_16x16x32_bf16 v[24:27], a[244:247], v[56:59], v[24:27]
    v_mfma_f32_16x16x32_bf16 v[28:31], a[196:199], v[56:59], v[28:31]
    v_mfma_f32_16x16x32_bf16 v[32:35], a[52:55], v[56:59], v[32:35]
    v_mfma_f32_16x16x32_bf16 v[36:39], a[36:39], v[56:59], v[36:39]
    s_call_b64 s[60:61], SM4
    v_mfma_f32_16x16x32_bf16 v[16:19], v[24:27], a[248:251], v[16:19]
    v_mfma_f32_16x16x32_bf16 v[20:23], v[24:27], a[252:255], v[20:23]
    v_mfma_f32_16x16x32_bf16 v[16:19], v[28:31], a[200:203], v[16:19]
    v_mfma_f32_16x16x32_bf16 v[20:23], v[28:31], a[204:207], v[20:23]
    v_mfma_f32_16x16x32_bf16 v[16:19], v[32:35], a[56:59], v[16:19]
    v_mfma_f32_16x16x32_bf16 v[20:23], v[32:35], a[60:63], v[20:23]
    v_mfma_f32_16x16x32_bf16 v[16:19], v[36:39], a[40:43], v[16:19]
    v_mfma_f32_16x16x32_bf16 v[20:23], v[36:39], a[44:47], v[20:23]
    s_nop 3
    v_add_u32 v49, 65536, v62
    ds_read_b128 a[240:243], v49 offset:0
    ds_read_b128 a[244:247], v49 offset:1024
    ds_read_b128 a[248:251], v49 offset:2048
    ds_read_b128 a[252:255], v49 offset:3072
    s_waitcnt lgkmcnt(0)
    v_mfma_f32_16x16x32_bf16 v[24:27], a[240:243], v[52:55], 0
    v_mfma_f32_16x16x32_bf16 v[24:27], a[244:247], v[56:59], v[24:27]
    s_call_b64 s[60:61], SM1
    v_mfma_f32_16x16x32_bf16 v[16:19], v[24:27], a[248:251], v[16:19]
    v_mfma_f32_16x16x32_bf16 v[20:23], v[24:27], a[252:255], v[20:23]
    s_cmp_ge_u32 s67, 8
    s_cbranch_scc1 Lnx_93
    s_waitcnt vmcnt(0)
    v_mfma_f32_16x16x32_bf16 v[24:27], a[224:227], v[52:55], 0
    v_mfma_f32_16x16x32_bf16 v[24:27], a[228:231], v[56:59], v[24:27]
    s_call_b64 s[60:61], SM1
    v_mfma_f32_16x16x32_bf16 v[16:19], v[24:27], a[232:235], v[16:19]
    v_mfma_f32_16x16x32_bf16 v[20:23], v[24:27], a[236:239], v[20:23]
Lnx_93:
    s_mov_b32 s69, 8
    s_mov_b32 s95, 160520
    s_call_b64 s[60:61], WDN
    s_mov_b32 s96, 151808
    s_call_b64 s[60:61], REC
    s_mov_b32 s69, 8
    s_mov_b32 s95, 160516
    s_call_b64 s[60:61], WDN
    s_call_b64 s[60:61], ARR
    s_cmp_eq_u32 s94, 3
    s_cbranch_scc1 Lal_94
    s_cmp_eq_u32 s94, 0
    s_cbranch_scc1 Laf_95
    s_mov_b32 s56, 0x40000000
    s_mov_b32 s57, 0x40000000
    s_call_b64 s[60:61], MST
    s_branch Lad_96
Laf_95:
    s_mov_b32 s96, 156160
    s_add_u32 s56, s90, 0x340000
    s_add_u32 s57, s91, 0xd0000
    s_call_b64 s[60:61], MRG
    v_mov_b32 v32, 160520
    v_mov_b32 v33, 9
    ds_write_b32 v32, v33
    s_branch Lad_96
Lal_94:
    s_mov_b32 s96, 151808
    s_add_u32 s56, s90, 0x380000
    s_add_u32 s57, s91, 0xe0000
    s_call_b64 s[60:61], MRG
    v_mov_b32 v32, 160516
    v_mov_b32 v33, 9
    ds_write_b32 v32, v33
Lad_96:
    s_sub_u32 s67, s54, 0
    s_lshl_b32 s94, s67, 11
    s_add_u32 s94, s94, s68
    s_add_u32 s94, s94, 0xe000000
    s_cmp_lt_u32 s67, 8
    s_cselect_b32 s94, s94, 0x40000000
    buffer_load_dwordx4 v[176:179], v2, s[4:7], s94 offen offset:0 nt
    buffer_load_dwordx4 v[180:183], v2, s[4:7], s94 offen offset:256 nt
    buffer_load_dwordx4 v[184:187], v3, s[8:11], s94 offen offset:0 nt
    buffer_load_dwordx4 v[188:191], v3, s[8:11], s94 offen offset:256 nt
    v_add_u32 v49, 65536, v62
    ds_read_b128 a[64:67], v49 offset:16384
    ds_read_b128 a[68:71], v49 offset:17408
    ds_read_b128 a[72:75], v49 offset:18432
    ds_read_b128 a[76:79], v49 offset:19456
    v_add_u32 v49, 65536, v62
    ds_read_b128 v[192:195], v49 offset:32768
    ds_read_b128 v[196:199], v49 offset:33792
    ds_read_b128 v[200:203], v49 offset:34816
    ds_read_b128 v[204:207], v49 offset:35840
    v_add_u32 v49, 65536, v62
    ds_read_b128 v[208:211], v49 offset:49152
    ds_read_b128 v[212:215], v49 offset:50176
    ds_read_b128 v[216:219], v49 offset:51200
    ds_read_b128 v[220:223], v49 offset:52224
    v_add_u32 v49, 131072, v62
    ds_read_b128 v[128:131], v49 offset:0
    ds_read_b128 v[132:135], v49 offset:1024
    ds_read_b128 v[136:139], v49 offset:2048
    ds_read_b128 v[140:143], v49 offset:3072
    s_waitcnt lgkmcnt(0)
    s_add_u32 s94, s92, 0x1e000
    buffer_load_dwordx4 v[52:55], v60, s[12:15], s94 offen offset:0 sc1
    buffer_load_dwordx4 v[56:59], v60, s[12:15], s94 offen offset:256 sc1
    s_waitcnt vmcnt(0)
    s_add_u32 s100, s92, 0x1e000
    s_branch Lchk_99
Lretry_98:
    buffer_load_dwordx4 v[52:55], v60, s[12:15], s100 offen offset:0 sc1
    buffer_load_dwordx4 v[56:59], v60, s[12:15], s100 offen offset:256 sc1
    s_waitcnt vmcnt(0)
Lchk_99:
    v_max_u32 v61, v52, v53
    v_max3_u32 v61, v61, v54, v55
    v_max3_u32 v61, v61, v56, v57
    v_max3_u32 v61, v61, v58, v59
    v_cmp_eq_u32 vcc, -1, v61
    s_cbranch_vccz Lok_97
    s_sub_u32 s93, s93, 1
    s_cbranch_scc1 L_end
    s_branch Lretry_98
Lok_97:
    v_mfma_f32_16x16x32_bf16 v[24:27], a[64:67], v[52:55], 0
    v_mfma_f32_16x16x32_bf16 v[28:31], v[192:195], v[52:55], 0
    v_mfma_f32_16x16x32_bf16 v[32:35], v[208:211], v[52:55], 0
    v_mfma_f32_16x16x32_bf16 v[36:39], v[128:131], v[52:55], 0
    v_mfma_f32_16x16x32_bf16 v[24:27], a[68:71], v[56:59], v[24:27]
    v_mfma_f32_16x16x32_bf16 v[28:31], v[196:199], v[56:59], v[28:31]
    v_mfma_f32_16x16x32_bf16 v[32:35], v[212:215], v[56:59], v[32:35]
    v_mfma_f32_16x16x32_bf16 v[36:39], v[132:135], v[56:59], v[36:39]
    s_call_b64 s[60:61], SM4
    v_mfma_f32_16x16x32_bf16 v[16:19], v[24:27], a[72:75], v[16:19]
    v_mfma_f32_16x16x32_bf16 v[20:23], v[24:27], a[76:79], v[20:23]
    v_mfma_f32_16x16x32_bf16 v[16:19], v[28:31], v[200:203], v[16:19]
    v_mfma_f32_16x16x32_bf16 v[20:23], v[28:31], v[204:207], v[20:23]
    v_mfma_f32_16x16x32_bf16 v[16:19], v[32:35], v[216:219], v[16:19]
    v_mfma_f32_16x16x32_bf16 v[20:23], v[32:35], v[220:223], v[20:23]
    v_mfma_f32_16x16x32_bf16 v[16:19], v[36:39], v[136:139], v[16:19]
    v_mfma_f32_16x16x32_bf16 v[20:23], v[36:39], v[140:143], v[20:23]
    v_mfma_f32_16x16x32_bf16 v[24:27], v[64:67], v[52:55], 0
    v_mfma_f32_16x16x32_bf16 v[28:31], v[80:83], v[52:55], 0
    v_mfma_f32_16x16x32_bf16 v[32:35], a[96:99], v[52:55], 0
    v_mfma_f32_16x16x32_bf16 v[36:39], v[96:99], v[52:55], 0
    v_mfma_f32_16x16x32_bf16 v[24:27], v[68:71], v[56:59], v[24:27]
    v_mfma_f32_16x16x32_bf16 v[28:31], v[84:87], v[56:59], v[28:31]
    v_mfma_f32_16x16x32_bf16 v[32:35], a[100:103], v[56:59], v[32:35]
    v_mfma_f32_16x16x32_bf16 v[36:39], v[100:103], v[56:59], v[36:39]
    s_call_b64 s[60:61], SM4
    v_mfma_f32_16x16x32_bf16 v[16:19], v[24:27], v[72:75], v[16:19]
    v_mfma_f32_16x16x32_bf16 v[20:23], v[24:27], v[76:79], v[20:23]
    v_mfma_f32_16x16x32_bf16 v[16:19], v[28:31], v[88:91], v[16:19]
    v_mfma_f32_16x16x32_bf16 v[20:23], v[28:31], v[92:95], v[20:23]
    v_mfma_f32_16x16x32_bf16 v[16:19], v[32:35], a[104:107], v[16:19]
    v_mfma_f32_16x16x32_bf16 v[20:23], v[32:35], a[108:111], v[20:23]
    v_mfma_f32_16x16x32_bf16 v[16:19], v[36:39], v[104:107], v[16:19]
    v_mfma_f32_16x16x32_bf16 v[20:23], v[36:39], v[108:111], v[20:23]
    v_mfma_f32_16x16x32_bf16 v[24:27], v[160:163], v[52:55], 0
    v_mfma_f32_16x16x32_bf16 v[28:31], a[160:163], v[52:55], 0
    v_mfma_f32_16x16x32_bf16 v[32:35], v[224:227], v[52:55], 0
    v_mfma_f32_16x16x32_bf16 v[36:39], a[112:115], v[52:55], 0
    v_mfma_f32_16x16x32_bf16 v[24:27], v[164:167], v[56:59], v[24:27]
    v_mfma_f32_16x16x32_bf16 v[28:31], a[164:167], v[56:59], v[28:31]
    v_mfma_f32_16x16x32_bf16 v[32:35], v[228:231], v[56:59], v[32:35]
    v_mfma_f32_16x16x32_bf16 v[36:39], a[116:119], v[56:59], v[36:39]
    s_call_b64 s[60:61], SM4
    v_mfma_f32_16x16x32_bf16 v[16:19], v[24:27], v[168:171], v[16:19]
    v_mfma_f32_16x16x32_bf16 v[20:23], v[24:27], v[172:175], v[20:23]
    v_mfma_f32_16x16x32_bf16 v[16:19], v[28:31], a[168:171], v[16:19]
    v_mfma_f32_16x16x32_bf16 v[20:23], v[28:31], a[172:175], v[20:23]
    v_mfma_f32_16x16x32_bf16 v[16:19], v[32:35], v[232:235], v[16:19]
    v_mfma_f32_16x16x32_bf16 v[20:23], v[32:35], v[236:239], v[20:23]
    v_mfma_f32_16x16x32_bf16 v[16:19], v[36:39], a[120:123], v[16:19]
    v_mfma_f32_16x16x32_bf16 v[20:23], v[36:39], a[124:127], v[20:23]
    v_mfma_f32_16x16x32_bf16 v[24:27], a[16:19], v[52:55], 0
    v_mfma_f32_16x16x32_bf16 v[28:31], a[176:179], v[52:55], 0
    v_mfma_f32_16x16x32_bf16 v[32:35], a[208:211], v[52:55], 0
    v_mfma_f32_16x16x32_bf16 v[36:39], v[144:147], v[52:55], 0
    v_mfma_f32_16x16x32_bf16 v[24:27], a[20:23], v[56:59], v[24:27]
    v_mfma_f32_16x16x32_bf16 v[28:31], a[180:183], v[56:59], v[28:31]
    v_mfma_f32_16x16x32_bf16 v[32:35], a[212:215], v[56:59], v[32:35]
    v_mfma_f32_16x16x32_bf16 v[36:39], v[148:151], v[56:59], v[36:39]
    s_call_b64 s[60:61], SM4
    v_mfma_f32_16x16x32_bf16 v[16:19], v[24:27], a[24:27], v[16:19]
    v_mfma_f32_16x16x32_bf16 v[20:23], v[24:27], a[28:31], v[20:23]
    v_mfma_f32_16x16x32_bf16 v[16:19], v[28:31], a[184:187], v[16:19]
    v_mfma_f32_16x16x32_bf16 v[20:23], v[28:31], a[188:191], v[20:23]
    v_mfma_f32_16x16x32_bf16 v[16:19], v[32:35], a[216:219], v[16:19]
    v_mfma_f32_16x16x32_bf16 v[20:23], v[32:35], a[220:223], v[20:23]
    v_mfma_f32_16x16x32_bf16 v[16:19], v[36:39], v[152:155], v[16:19]
    v_mfma_f32_16x16x32_bf16 v[20:23], v[36:39], v[156:159], v[20:23]
    v_mfma_f32_16x16x32_bf16 v[24:27], v[112:115], v[52:55], 0
    v_mfma_f32_16x16x32_bf16 v[24:27], v[116:119], v[56:59], v[24:27]
    s_call_b64 s[60:61], SM1
    v_mfma_f32_16x16x32_bf16 v[16:19], v[24:27], v[120:123], v[16:19]
    v_mfma_f32_16x16x32_bf16 v[20:23], v[24:27], v[124:127], v[20:23]
    s_cmp_ge_u32 s67, 8
    s_cbranch_scc1 Lnx_100
    v_mfma_f32_16x16x32_bf16 v[24:27], v[176:179], v[52:55], 0
    v_mfma_f32_16x16x32_bf16 v[24:27], v[180:183], v[56:59], v[24:27]
    s_call_b64 s[60:61], SM1
    v_mfma_f32_16x16x32_bf16 v[16:19], v[24:27], v[184:187], v[16:19]
    v_mfma_f32_16x16x32_bf16 v[20:23], v[24:27], v[188:191], v[20:23]
Lnx_100:
    s_mov_b32 s69, 9
    s_mov_b32 s95, 160520
    s_call_b64 s[60:61], WDN
    s_mov_b32 s96, 156160
    s_call_b64 s[60:61], REC
    s_mov_b32 s69, 9
    s_mov_b32 s95, 160516
    s_call_b64 s[60:61], WDN
    s_call_b64 s[60:61], ARR
    s_cmp_eq_u32 s94, 3
    s_cbranch_scc1 Lal_101
    s_mov_b32 s56, 0x40000000
    s_mov_b32 s57, 0x40000000
    s_call_b64 s[60:61], MST
    s_branch Lad_103
Lal_101:
    s_mov_b32 s96, 156160
    s_add_u32 s56, s90, 0x3c0000
    s_add_u32 s57, s91, 0xf0000
    s_call_b64 s[60:61], MRG
    v_mov_b32 v32, 160516
    v_mov_b32 v33, 10
    ds_write_b32 v32, v33
Lad_103:
    s_branch L_end
L_service:
    s_sub_u32 s83, s2, 240
    v_mov_b32 v24, -1
    v_mov_b32 v25, -1
    v_mov_b32 v26, -1
    v_mov_b32 v27, -1
    v_lshrrev_b32 v48, 5, v1
    v_lshlrev_b32 v48, 13, v48
    v_and_b32 v49, 31, v1
    v_lshl_add_u32 v48, v49, 4, v48
    s_lshl_b32 s94, s83, 9
    s_lshl_b32 s95, s52, 15
    s_add_u32 s94, s94, s95
    s_add_u32 s94, s94, 0x490000
    buffer_store_dwordx4 v[24:27], v48, s[12:15], s94 offen sc1
    s_add_u32 s94, s94, 0x4000
    buffer_store_dwordx4 v[24:27], v48, s[12:15], s94 offen sc1
    s_add_u32 s94, s94, 0x4000
    s_mov_b32 s94, 0
    s_call_b64 s[60:61], SCL
    s_mov_b32 s94, 1
    s_call_b64 s[60:61], SCL
    v_lshlrev_b32 v48, 3, v0
    s_lshl_b32 s94, s83, 11
    s_add_u32 s94, s94, 0x4b0000
    buffer_store_dwordx2 v[24:25], v48, s[12:15], s94 offen sc1
    s_lshl_b32 s94, s83, 11
    s_add_u32 s94, s94, 0x410000
    buffer_store_dwordx2 v[24:25], v48, s[12:15], s94 offen sc1
    v_lshlrev_b32 v50, 1, v1
    s_mul_i32 s95, s52, 896
    s_add_u32 s96, s95, 3584
    buffer_load_ushort v8, v50, s[24:27], s95 offen offset:0
    buffer_load_ushort v9, v50, s[24:27], s95 offen offset:128
    buffer_load_ushort v10, v50, s[24:27], s95 offen offset:256
    buffer_load_ushort v11, v50, s[24:27], s95 offen offset:384
    buffer_load_ushort v12, v50, s[24:27], s95 offen offset:512
    buffer_load_ushort v13, v50, s[24:27], s95 offen offset:640
    buffer_load_ushort v14, v50, s[24:27], s95 offen offset:768
    buffer_load_ushort v16, v50, s[24:27], s96 offen offset:0
    buffer_load_ushort v17, v50, s[24:27], s96 offen offset:128
    buffer_load_ushort v18, v50, s[24:27], s96 offen offset:256
    buffer_load_ushort v19, v50, s[24:27], s96 offen offset:384
    buffer_load_ushort v20, v50, s[24:27], s96 offen offset:512
    buffer_load_ushort v21, v50, s[24:27], s96 offen offset:640
    buffer_load_ushort v22, v50, s[24:27], s96 offen offset:768
    v_lshrrev_b32 v41, 4, v1
    v_mul_u32_u24 v41, 0x38000, v41
    v_and_b32 v42, 15, v1
    v_lshl_add_u32 v41, v42, 4, v41
    s_mul_i32 s56, s52, 917504
    s_lshl_b32 s94, s83, 9
    s_add_u32 s56, s56, s94
    buffer_load_dwordx4 a[0:3], v41, s[16:19], s56 offen offset:0
    buffer_load_dwordx4 a[4:7], v41, s[16:19], s56 offen offset:256
    s_add_u32 s56, s56, 8192
    buffer_load_dwordx4 a[8:11], v41, s[16:19], s56 offen offset:0
    buffer_load_dwordx4 a[12:15], v41, s[16:19], s56 offen offset:256
    s_add_u32 s56, s56, 8192
    buffer_load_dwordx4 a[16:19], v41, s[16:19], s56 offen offset:0
    buffer_load_dwordx4 a[20:23], v41, s[16:19], s56 offen offset:256
    s_add_u32 s56, s56, 8192
    buffer_load_dwordx4 a[24:27], v41, s[16:19], s56 offen offset:0
    buffer_load_dwordx4 a[28:31], v41, s[16:19], s56 offen offset:256
    s_add_u32 s56, s56, 8192
    buffer_load_dwordx4 a[32:35], v41, s[16:19], s56 offen offset:0
    buffer_load_dwordx4 a[36:39], v41, s[16:19], s56 offen offset:256
    s_add_u32 s56, s56, 8192
    buffer_load_dwordx4 a[40:43], v41, s[16:19], s56 offen offset:0
    buffer_load_dwordx4 a[44:47], v41, s[16:19], s56 offen offset:256
    s_add_u32 s56, s56, 8192
    buffer_load_dwordx4 a[48:51], v41, s[16:19], s56 offen offset:0
    buffer_load_dwordx4 a[52:55], v41, s[16:19], s56 offen offset:256
    s_add_u32 s56, s56, 8192
    buffer_load_dwordx4 a[56:59], v41, s[16:19], s56 offen offset:0
    buffer_load_dwordx4 a[60:63], v41, s[16:19], s56 offen offset:256
    s_add_u32 s56, s56, 8192
    buffer_load_dwordx4 a[64:67], v41, s[16:19], s56 offen offset:0
    buffer_load_dwordx4 a[68:71], v41, s[16:19], s56 offen offset:256
    s_add_u32 s56, s56, 8192
    buffer_load_dwordx4 a[72:75], v41, s[16:19], s56 offen offset:0
    buffer_load_dwordx4 a[76:79], v41, s[16:19], s56 offen offset:256
    s_add_u32 s56, s56, 8192
    buffer_load_dwordx4 a[80:83], v41, s[16:19], s56 offen offset:0
    buffer_load_dwordx4 a[84:87], v41, s[16:19], s56 offen offset:256
    s_add_u32 s56, s56, 8192
    buffer_load_dwordx4 a[88:91], v41, s[16:19], s56 offen offset:0
    buffer_load_dwordx4 a[92:95], v41, s[16:19], s56 offen offset:256
    s_add_u32 s56, s56, 8192
    buffer_load_dwordx4 a[96:99], v41, s[16:19], s56 offen offset:0
    buffer_load_dwordx4 a[100:103], v41, s[16:19], s56 offen offset:256
    s_add_u32 s56, s56, 8192
    buffer_load_dwordx4 a[104:107], v41, s[16:19], s56 offen offset:0
    buffer_load_dwordx4 a[108:111], v41, s[16:19], s56 offen offset:256
    s_add_u32 s56, s56, 8192
    buffer_load_dwordx4 a[112:115], v41, s[16:19], s56 offen offset:0
    buffer_load_dwordx4 a[116:119], v41, s[16:19], s56 offen offset:256
    s_add_u32 s56, s56, 8192
    s_waitcnt vmcnt(54)
    buffer_load_dwordx4 a[120:123], v41, s[16:19], s56 offen offset:0
    buffer_load_dwordx4 a[124:127], v41, s[16:19], s56 offen offset:256
    s_add_u32 s56, s56, 8192
    s_waitcnt vmcnt(32)
    s_barrier
    v_mov_b32 v48, 0
    v_cmp_eq_u32 vcc, 0, v0
    v_mov_b32 v61, 0x40000000
    s_nop 0
    v_cndmask_b32 v48, v61, v48, vcc
    v_mov_b32 v49, 1
    buffer_store_byte v49, v48, s[32:35], s2 offen sc1
    buffer_load_dwordx4 a[128:131], v41, s[16:19], s56 offen offset:0
    buffer_load_dwordx4 a[132:135], v41, s[16:19], s56 offen offset:256
    s_add_u32 s56, s56, 8192
    buffer_load_dwordx4 a[136:139], v41, s[16:19], s56 offen offset:0
    buffer_load_dwordx4 a[140:143], v41, s[16:19], s56 offen offset:256
    s_add_u32 s56, s56, 8192
    buffer_load_dwordx4 a[144:147], v41, s[16:19], s56 offen offset:0
    buffer_load_dwordx4 a[148:151], v41, s[16:19], s56 offen offset:256
    s_add_u32 s56, s56, 8192
    buffer_load_dwordx4 a[152:155], v41, s[16:19], s56 offen offset:0
    buffer_load_dwordx4 a[156:159], v41, s[16:19], s56 offen offset:256
    s_add_u32 s56, s56, 8192
    buffer_load_dwordx4 a[160:163], v41, s[16:19], s56 offen offset:0
    buffer_load_dwordx4 a[164:167], v41, s[16:19], s56 offen offset:256
    s_add_u32 s56, s56, 8192
    buffer_load_dwordx4 a[168:171], v41, s[16:19], s56 offen offset:0
    buffer_load_dwordx4 a[172:175], v41, s[16:19], s56 offen offset:256
    s_add_u32 s56, s56, 8192
    buffer_load_dwordx4 a[176:179], v41, s[16:19], s56 offen offset:0
    buffer_load_dwordx4 a[180:183], v41, s[16:19], s56 offen offset:256
    s_add_u32 s56, s56, 8192
    buffer_load_dwordx4 a[184:187], v41, s[16:19], s56 offen offset:0
    buffer_load_dwordx4 a[188:191], v41, s[16:19], s56 offen offset:256
    s_add_u32 s56, s56, 8192
    buffer_load_dwordx4 a[192:195], v41, s[16:19], s56 offen offset:0
    buffer_load_dwordx4 a[196:199], v41, s[16:19], s56 offen offset:256
    s_add_u32 s56, s56, 8192
    buffer_load_dwordx4 a[200:203], v41, s[16:19], s56 offen offset:0
    buffer_load_dwordx4 a[204:207], v41, s[16:19], s56 offen offset:256
    s_add_u32 s56, s56, 8192
    buffer_load_dwordx4 a[208:211], v41, s[16:19], s56 offen offset:0
    buffer_load_dwordx4 a[212:215], v41, s[16:19], s56 offen offset:256
    s_add_u32 s56, s56, 8192
    buffer_load_dwordx4 a[216:219], v41, s[16:19], s56 offen offset:0
    buffer_load_dwordx4 a[220:223], v41, s[16:19], s56 offen offset:256
    s_add_u32 s56, s56, 8192
    v_lshrrev_b32 v41, 4, v1
    v_mul_u32_u24 v41, 0x3800, v41
    v_and_b32 v42, 15, v1
    v_lshl_add_u32 v41, v42, 4, v41
    v_cmp_gt_u32 vcc, 14, v42
    v_mov_b32 v61, 0x40000000
    s_nop 0
    v_cndmask_b32 v41, v61, v41, vcc
    s_lshl_b32 s57, s83, 2
    s_add_u32 s57, s57, s52
    s_mul_i32 s57, s57, 57344
    v_lshlrev_b32 v43, 2, v1
    s_lshl_b32 s94, s52, 11
    v_add_u32 v43, s94, v43
    v_add_u32 v44, 98304, v43
    v_add_u32 v43, 114688, v43
    v_lshlrev_b32 v8, 16, v8
    ds_write_b32 v44, v8 offset:0
    v_lshlrev_b32 v9, 16, v9
    ds_write_b32 v44, v9 offset:256
    v_lshlrev_b32 v10, 16, v10
    ds_write_b32 v44, v10 offset:512
    v_lshlrev_b32 v11, 16, v11
    ds_write_b32 v44, v11 offset:768
    v_lshlrev_b32 v12, 16, v12
    ds_write_b32 v44, v12 offset:1024
    v_lshlrev_b32 v13, 16, v13
    ds_write_b32 v44, v13 offset:1280
    v_lshlrev_b32 v14, 16, v14
    ds_write_b32 v44, v14 offset:1536
    v_add_f32 v24, v8, v9
    v_add_f32 v26, v10, v11
    v_add_f32 v25, v12, v13
    v_add_f32 v24, v24, v14
    v_add_f32 v26, v26, v25
    v_add_f32 v24, v24, v26
    s_nop 1
    v_add_f32_dpp v24, v24, v24 row_ror:8 row_mask:0xf bank_mask:0xf
    s_nop 1
    v_add_f32_dpp v24, v24, v24 row_ror:4 row_mask:0xf bank_mask:0xf
    s_nop 1
    v_add_f32_dpp v24, v24, v24 row_ror:2 row_mask:0xf bank_mask:0xf
    s_nop 1
    v_add_f32_dpp v24, v24, v24 row_ror:1 row_mask:0xf bank_mask:0xf
    v_mov_b32 v26, v24
    s_nop 1
    v_permlane16_swap_b32 v24, v26
    s_nop 0
    v_add_f32 v24, v24, v26
    v_mov_b32 v26, v24
    s_nop 1
    v_permlane32_swap_b32 v24, v26
    s_nop 0
    v_add_f32 v24, v24, v26
    v_mul_f32 v24, 0x3b124925, v24
    v_sub_f32 v26, v8, v24
    v_mul_f32 v25, v26, v26
    v_sub_f32 v26, v9, v24
    v_fmac_f32 v25, v26, v26
    v_sub_f32 v26, v10, v24
    v_fmac_f32 v25, v26, v26
    v_sub_f32 v26, v11, v24
    v_fmac_f32 v25, v26, v26
    v_sub_f32 v26, v12, v24
    v_fmac_f32 v25, v26, v26
    v_sub_f32 v26, v13, v24
    v_fmac_f32 v25, v26, v26
    v_sub_f32 v26, v14, v24
    v_fmac_f32 v25, v26, v26
    s_nop 1
    v_add_f32_dpp v25, v25, v25 row_ror:8 row_mask:0xf bank_mask:0xf
    s_nop 1
    v_add_f32_dpp v25, v25, v25 row_ror:4 row_mask:0xf bank_mask:0xf
    s_nop 1
    v_add_f32_dpp v25, v25, v25 row_ror:2 row_mask:0xf bank_mask:0xf
    s_nop 1
    v_add_f32_dpp v25, v25, v25 row_ror:1 row_mask:0xf bank_mask:0xf
    v_mov_b32 v26, v25
    s_nop 1
    v_permlane16_swap_b32 v25, v26
    s_nop 0
    v_add_f32 v25, v25, v26
    v_mov_b32 v26, v25
    s_nop 1
    v_permlane32_swap_b32 v25, v26
    s_nop 0
    v_add_f32 v25, v25, v26
    v_mul_f32 v25, 0x3b124925, v25
    v_cvt_pk_bf16_f32 v24, v24, v24
    v_and_b32 v24, 0xffff0000, v24
    v_cvt_pk_bf16_f32 v25, v25, v25
    v_and_b32 v25, 0xffff0000, v25
    v_add_f32 v25, 0x3727c5ac, v25
    v_cvt_pk_bf16_f32 v25, v25, v25
    v_and_b32 v25, 0xffff0000, v25
    v_sqrt_f32 v25, v25
    s_nop 0
    v_cvt_pk_bf16_f32 v25, v25, v25
    v_and_b32 v25, 0xffff0000, v25
    v_rcp_f32 v25, v25
    s_nop 0
    v_sub_f32 v8, v8, v24
    v_cvt_pk_bf16_f32 v8, v8, v8
    v_and_b32 v8, 0xffff0000, v8
    v_mul_f32 v8, v8, v25
    v_cvt_pk_bf16_f32 v8, v8, v8
    ds_write_b32 v43, v8 offset:0
    v_sub_f32 v9, v9, v24
    v_cvt_pk_bf16_f32 v9, v9, v9
    v_and_b32 v9, 0xffff0000, v9
    v_mul_f32 v9, v9, v25
    v_cvt_pk_bf16_f32 v9, v9, v9
    ds_write_b32 v43, v9 offset:256
    v_sub_f32 v10, v10, v24
    v_cvt_pk_bf16_f32 v10, v10, v10
    v_and_b32 v10, 0xffff0000, v10
    v_mul_f32 v10, v10, v25
    v_cvt_pk_bf16_f32 v10, v10, v10
    ds_write_b32 v43, v10 offset:512
    v_sub_f32 v11, v11, v24
    v_cvt_pk_bf16_f32 v11, v11, v11
    v_and_b32 v11, 0xffff0000, v11
    v_mul_f32 v11, v11, v25
    v_cvt_pk_bf16_f32 v11, v11, v11
    ds_write_b32 v43, v11 offset:768
    v_sub_f32 v12, v12, v24
    v_cvt_pk_bf16_f32 v12, v12, v12
    v_and_b32 v12, 0xffff0000, v12
    v_mul_f32 v12, v12, v25
    v_cvt_pk_bf16_f32 v12, v12, v12
    ds_write_b32 v43, v12 offset:1024
    v_sub_f32 v13, v13, v24
    v_cvt_pk_bf16_f32 v13, v13, v13
    v_and_b32 v13, 0xffff0000, v13
    v_mul_f32 v13, v13, v25
    v_cvt_pk_bf16_f32 v13, v13, v13
    ds_write_b32 v43, v13 offset:1280
    v_sub_f32 v14, v14, v24
    v_cvt_pk_bf16_f32 v14, v14, v14
    v_and_b32 v14, 0xffff0000, v14
    v_mul_f32 v14, v14, v25
    v_cvt_pk_bf16_f32 v14, v14, v14
    ds_write_b32 v43, v14 offset:1536
    v_lshlrev_b32 v16, 16, v16
    ds_write_b32 v44, v16 offset:8192
    v_lshlrev_b32 v17, 16, v17
    ds_write_b32 v44, v17 offset:8448
    v_lshlrev_b32 v18, 16, v18
    ds_write_b32 v44, v18 offset:8704
    v_lshlrev_b32 v19, 16, v19
    ds_write_b32 v44, v19 offset:8960
    v_lshlrev_b32 v20, 16, v20
    ds_write_b32 v44, v20 offset:9216
    v_lshlrev_b32 v21, 16, v21
    ds_write_b32 v44, v21 offset:9472
    v_lshlrev_b32 v22, 16, v22
    ds_write_b32 v44, v22 offset:9728
    v_add_f32 v24, v16, v17
    v_add_f32 v26, v18, v19
    v_add_f32 v25, v20, v21
    v_add_f32 v24, v24, v22
    v_add_f32 v26, v26, v25
    v_add_f32 v24, v24, v26
    s_nop 1
    v_add_f32_dpp v24, v24, v24 row_ror:8 row_mask:0xf bank_mask:0xf
    s_nop 1
    v_add_f32_dpp v24, v24, v24 row_ror:4 row_mask:0xf bank_mask:0xf
    s_nop 1
    v_add_f32_dpp v24, v24, v24 row_ror:2 row_mask:0xf bank_mask:0xf
    s_nop 1
    v_add_f32_dpp v24, v24, v24 row_ror:1 row_mask:0xf bank_mask:0xf
    v_mov_b32 v26, v24
    s_nop 1
    v_permlane16_swap_b32 v24, v26
    s_nop 0
    v_add_f32 v24, v24, v26
    v_mov_b32 v26, v24
    s_nop 1
    v_permlane32_swap_b32 v24, v26
    s_nop 0
    v_add_f32 v24, v24, v26
    v_mul_f32 v24, 0x3b124925, v24
    v_sub_f32 v26, v16, v24
    v_mul_f32 v25, v26, v26
    v_sub_f32 v26, v17, v24
    v_fmac_f32 v25, v26, v26
    v_sub_f32 v26, v18, v24
    v_fmac_f32 v25, v26, v26
    v_sub_f32 v26, v19, v24
    v_fmac_f32 v25, v26, v26
    v_sub_f32 v26, v20, v24
    v_fmac_f32 v25, v26, v26
    v_sub_f32 v26, v21, v24
    v_fmac_f32 v25, v26, v26
    v_sub_f32 v26, v22, v24
    v_fmac_f32 v25, v26, v26
    s_nop 1
    v_add_f32_dpp v25, v25, v25 row_ror:8 row_mask:0xf bank_mask:0xf
    s_nop 1
    v_add_f32_dpp v25, v25, v25 row_ror:4 row_mask:0xf bank_mask:0xf
    s_nop 1
    v_add_f32_dpp v25, v25, v25 row_ror:2 row_mask:0xf bank_mask:0xf
    s_nop 1
    v_add_f32_dpp v25, v25, v25 row_ror:1 row_mask:0xf bank_mask:0xf
    v_mov_b32 v26, v25
    s_nop 1
    v_permlane16_swap_b32 v25, v26
    s_nop 0
    v_add_f32 v25, v25, v26
    v_mov_b32 v26, v25
    s_nop 1
    v_permlane32_swap_b32 v25, v26
    s_nop 0
    v_add_f32 v25, v25, v26
    v_mul_f32 v25, 0x3b124925, v25
    v_cvt_pk_bf16_f32 v24, v24, v24
    v_and_b32 v24, 0xffff0000, v24
    v_cvt_pk_bf16_f32 v25, v25, v25
    v_and_b32 v25, 0xffff0000, v25
    v_add_f32 v25, 0x3727c5ac, v25
    v_cvt_pk_bf16_f32 v25, v25, v25
    v_and_b32 v25, 0xffff0000, v25
    v_sqrt_f32 v25, v25
    s_nop 0
    v_cvt_pk_bf16_f32 v25, v25, v25
    v_and_b32 v25, 0xffff0000, v25
    v_rcp_f32 v25, v25
    s_nop 0
    v_sub_f32 v16, v16, v24
    v_cvt_pk_bf16_f32 v16, v16, v16
    v_and_b32 v16, 0xffff0000, v16
    v_mul_f32 v16, v16, v25
    v_cvt_pk_bf16_f32 v16, v16, v16
    ds_write_b32 v43, v16 offset:8192
    v_sub_f32 v17, v17, v24
    v_cvt_pk_bf16_f32 v17, v17, v17
    v_and_b32 v17, 0xffff0000, v17
    v_mul_f32 v17, v17, v25
    v_cvt_pk_bf16_f32 v17, v17, v17
    ds_write_b32 v43, v17 offset:8448
    v_sub_f32 v18, v18, v24
    v_cvt_pk_bf16_f32 v18, v18, v18
    v_and_b32 v18, 0xffff0000, v18
    v_mul_f32 v18, v18, v25
    v_cvt_pk_bf16_f32 v18, v18, v18
    ds_write_b32 v43, v18 offset:8704
    v_sub_f32 v19, v19, v24
    v_cvt_pk_bf16_f32 v19, v19, v19
    v_and_b32 v19, 0xffff0000, v19
    v_mul_f32 v19, v19, v25
    v_cvt_pk_bf16_f32 v19, v19, v19
    ds_write_b32 v43, v19 offset:8960
    v_sub_f32 v20, v20, v24
    v_cvt_pk_bf16_f32 v20, v20, v20
    v_and_b32 v20, 0xffff0000, v20
    v_mul_f32 v20, v20, v25
    v_cvt_pk_bf16_f32 v20, v20, v20
    ds_write_b32 v43, v20 offset:9216
    v_sub_f32 v21, v21, v24
    v_cvt_pk_bf16_f32 v21, v21, v21
    v_and_b32 v21, 0xffff0000, v21
    v_mul_f32 v21, v21, v25
    v_cvt_pk_bf16_f32 v21, v21, v21
    ds_write_b32 v43, v21 offset:9472
    v_sub_f32 v22, v22, v24
    v_cvt_pk_bf16_f32 v22, v22, v22
    v_and_b32 v22, 0xffff0000, v22
    v_mul_f32 v22, v22, v25
    v_cvt_pk_bf16_f32 v22, v22, v22
    ds_write_b32 v43, v22 offset:9728
    s_add_u32 s56, s57, 7168
    buffer_load_dwordx4 v[128:131], v41, s[20:23], s56 offen offset:1792
    s_waitcnt vmcnt(54)
    buffer_load_dwordx4 v[132:135], v41, s[20:23], s56 offen offset:2016
    buffer_load_dwordx4 v[136:139], v41, s[20:23], s56 offen offset:2240
    buffer_load_dwordx4 v[140:143], v41, s[20:23], s56 offen offset:2464
    buffer_load_dwordx4 v[144:147], v41, s[20:23], s56 offen offset:2688
    s_waitcnt vmcnt(54)
    buffer_load_dwordx4 v[148:151], v41, s[20:23], s56 offen offset:2912
    buffer_load_dwordx4 v[152:155], v41, s[20:23], s56 offen offset:3136
    buffer_load_dwordx4 v[156:159], v41, s[20:23], s56 offen offset:3360
    s_add_u32 s56, s57, 10752
    buffer_load_dwordx4 v[160:163], v41, s[20:23], s56 offen offset:0
    s_waitcnt vmcnt(54)
    buffer_load_dwordx4 v[164:167], v41, s[20:23], s56 offen offset:224
    buffer_load_dwordx4 v[168:171], v41, s[20:23], s56 offen offset:448
    buffer_load_dwordx4 v[172:175], v41, s[20:23], s56 offen offset:672
    buffer_load_dwordx4 v[176:179], v41, s[20:23], s56 offen offset:896
    s_waitcnt vmcnt(54)
    buffer_load_dwordx4 v[180:183], v41, s[20:23], s56 offen offset:1120
    buffer_load_dwordx4 v[184:187], v41, s[20:23], s56 offen offset:1344
    buffer_load_dwordx4 v[188:191], v41, s[20:23], s56 offen offset:1568
    buffer_load_dwordx4 v[192:195], v41, s[20:23], s56 offen offset:1792
    s_waitcnt vmcnt(54)
    buffer_load_dwordx4 v[196:199], v41, s[20:23], s56 offen offset:2016
    buffer_load_dwordx4 v[200:203], v41, s[20:23], s56 offen offset:2240
    buffer_load_dwordx4 v[204:207], v41, s[20:23], s56 offen offset:2464
    buffer_load_dwordx4 v[208:211], v41, s[20:23], s56 offen offset:2688
    s_waitcnt vmcnt(54)
    buffer_load_dwordx4 v[212:215], v41, s[20:23], s56 offen offset:2912
    buffer_load_dwordx4 v[216:219], v41, s[20:23], s56 offen offset:3136
    buffer_load_dwordx4 v[220:223], v41, s[20:23], s56 offen offset:3360
    v_lshrrev_b32 v45, 4, v1
    v_mul_u32_u24 v45, 112, v45
    s_mul_i32 s94, s52, 448
    s_add_u32 s94, s94, 114688
    v_add_u32 v45, s94, v45
    v_and_b32 v46, 8, v1
    v_lshl_add_u32 v40, v46, 8, v45
    v_mov_b32 v62, v45
    s_lshl_b32 s58, s83, 9
    s_add_u32 s58, s58, 0x490000
    v_lshlrev_b32 v42, 4, v1
    s_mul_i32 s94, s52, 24576
    v_add_u32 v42, s94, v42
    s_waitcnt vmcnt(24)
    s_waitcnt lgkmcnt(0)
    s_barrier
    s_add_u32 s56, s57, 0
    buffer_load_dwordx4 a[224:227], v41, s[20:23], s56 offen offset:0
    buffer_load_dwordx4 a[228:231], v41, s[20:23], s56 offen offset:224
    buffer_load_dwordx4 a[232:235], v41, s[20:23], s56 offen offset:448
    buffer_load_dwordx4 a[236:239], v41, s[20:23], s56 offen offset:672
    buffer_load_dwordx4 a[240:243], v41, s[20:23], s56 offen offset:896
    buffer_load_dwordx4 a[244:247], v41, s[20:23], s56 offen offset:1120
    buffer_load_dwordx4 a[248:251], v41, s[20:23], s56 offen offset:1344
    buffer_load_dwordx4 a[252:255], v41, s[20:23], s56 offen offset:1568
    s_add_u32 s56, s57, 7168
    buffer_load_dwordx4 v[224:227], v41, s[20:23], s56 offen offset:0
    buffer_load_dwordx4 v[228:231], v41, s[20:23], s56 offen offset:224
    buffer_load_dwordx4 v[232:235], v41, s[20:23], s56 offen offset:448
    buffer_load_dwordx4 v[236:239], v41, s[20:23], s56 offen offset:672
    buffer_load_dwordx4 v[240:243], v41, s[20:23], s56 offen offset:896
    buffer_load_dwordx4 v[244:247], v41, s[20:23], s56 offen offset:1120
    buffer_load_dwordx4 v[248:251], v41, s[20:23], s56 offen offset:1344
    buffer_load_dwordx4 v[252:255], v41, s[20:23], s56 offen offset:1568
    s_add_u32 s96, s58, 0x0
    s_add_u32 s97, s58, 0x2000
    s_call_b64 s[60:61], QG
    v_add_u32 v40, 4096, v40
    v_and_b32 v47, 3, v1
    v_lshlrev_b32 v47, 2, v47
    buffer_load_dword v46, v47, s[32:35], 0 offen offset:240 sc1
    s_waitcnt vmcnt(18)
    ds_write_b128 v42, v[128:131] offset:0
    ds_write_b128 v42, v[132:135] offset:1024
    ds_write_b128 v42, v[136:139] offset:2048
    ds_write_b128 v42, v[140:143] offset:3072
    ds_write_b128 v42, v[144:147] offset:4096
    ds_write_b128 v42, v[148:151] offset:5120
    ds_write_b128 v42, v[152:155] offset:6144
    ds_write_b128 v42, v[156:159] offset:7168
    ds_write_b128 v42, v[160:163] offset:8192
    ds_write_b128 v42, v[164:167] offset:9216
    ds_write_b128 v42, v[168:171] offset:10240
    ds_write_b128 v42, v[172:175] offset:11264
    ds_write_b128 v42, v[176:179] offset:12288
    ds_write_b128 v42, v[180:183] offset:13312
    ds_write_b128 v42, v[184:187] offset:14336
    ds_write_b128 v42, v[188:191] offset:15360
    ds_write_b128 v42, v[192:195] offset:16384
    ds_write_b128 v42, v[196:199] offset:17408
    ds_write_b128 v42, v[200:203] offset:18432
    ds_write_b128 v42, v[204:207] offset:19456
    ds_write_b128 v42, v[208:211] offset:20480
    ds_write_b128 v42, v[212:215] offset:21504
    ds_write_b128 v42, v[216:219] offset:22528
    ds_write_b128 v42, v[220:223] offset:23552
    s_waitcnt lgkmcnt(0)
    s_mov_b32 s56, s57
    buffer_load_dwordx4 v[128:131], v41, s[20:23], s56 offen offset:1792
    buffer_load_dwordx4 v[132:135], v41, s[20:23], s56 offen offset:2016
    buffer_load_dwordx4 v[136:139], v41, s[20:23], s56 offen offset:2240
    buffer_load_dwordx4 v[140:143], v41, s[20:23], s56 offen offset:2464
    buffer_load_dwordx4 v[144:147], v41, s[20:23], s56 offen offset:2688
    buffer_load_dwordx4 v[148:151], v41, s[20:23], s56 offen offset:2912
    buffer_load_dwordx4 v[152:155], v41, s[20:23], s56 offen offset:3136
    buffer_load_dwordx4 v[156:159], v41, s[20:23], s56 offen offset:3360
    s_add_u32 s56, s57, 3584
    buffer_load_dwordx4 v[160:163], v41, s[20:23], s56 offen offset:0
    buffer_load_dwordx4 v[164:167], v41, s[20:23], s56 offen offset:224
    buffer_load_dwordx4 v[168:171], v41, s[20:23], s56 offen offset:448
    buffer_load_dwordx4 v[172:175], v41, s[20:23], s56 offen offset:672
    buffer_load_dwordx4 v[176:179], v41, s[20:23], s56 offen offset:896
    buffer_load_dwordx4 v[180:183], v41, s[20:23], s56 offen offset:1120
    buffer_load_dwordx4 v[184:187], v41, s[20:23], s56 offen offset:1344
    buffer_load_dwordx4 v[188:191], v41, s[20:23], s56 offen offset:1568
    buffer_load_dwordx4 v[192:195], v41, s[20:23], s56 offen offset:1792
    buffer_load_dwordx4 v[196:199], v41, s[20:23], s56 offen offset:2016
    buffer_load_dwordx4 v[200:203], v41, s[20:23], s56 offen offset:2240
    buffer_load_dwordx4 v[204:207], v41, s[20:23], s56 offen offset:2464
    buffer_load_dwordx4 v[208:211], v41, s[20:23], s56 offen offset:2688
    buffer_load_dwordx4 v[212:215], v41, s[20:23], s56 offen offset:2912
    buffer_load_dwordx4 v[216:219], v41, s[20:23], s56 offen offset:3136
    buffer_load_dwordx4 v[220:223], v41, s[20:23], s56 offen offset:3360
    v_mov_b32 v32, -1
    v_mov_b32 v33, -1
    v_mov_b32 v34, -1
    v_mov_b32 v35, -1
    v_lshlrev_b32 v48, 4, v1
    s_lshl_b32 s94, s83, 11
    s_lshl_b32 s95, s52, 17
    s_add_u32 s94, s94, s95
    s_add_u32 s94, s94, 0x410000
    buffer_store_dwordx4 v[32:35], v48, s[12:15], s94 offen offset:0 sc1
    buffer_store_dwordx4 v[32:35], v48, s[12:15], s94 offen offset:1024 sc1
    s_add_u32 s94, s94, 0x8000
    buffer_store_dwordx4 v[32:35], v48, s[12:15], s94 offen offset:0 sc1
    buffer_store_dwordx4 v[32:35], v48, s[12:15], s94 offen offset:1024 sc1
    s_add_u32 s94, s94, 0x8000
    buffer_store_dwordx4 v[32:35], v48, s[12:15], s94 offen offset:0 sc1
    buffer_store_dwordx4 v[32:35], v48, s[12:15], s94 offen offset:1024 sc1
    s_add_u32 s94, s94, 0x8000
    buffer_store_dwordx4 v[32:35], v48, s[12:15], s94 offen offset:0 sc1
    buffer_store_dwordx4 v[32:35], v48, s[12:15], s94 offen offset:1024 sc1
    s_add_u32 s94, s94, 0x8000
    s_mov_b32 s94, 2
    s_call_b64 s[60:61], SCL
    s_waitcnt vmcnt(50)
    s_mov_b32 s94, 8
    s_call_b64 s[60:61], SCL
    s_add_u32 s96, s58, 0x4000
    s_add_u32 s97, s58, 0x6000
    s_call_b64 s[60:61], QG
    v_add_u32 v40, 4096, v40
    s_add_u32 s96, s58, 0x8000
    s_add_u32 s97, s58, 0xa000
    s_call_b64 s[60:61], QG
    v_add_u32 v40, 4096, v40
    s_add_u32 s96, s58, 0xc000
    s_add_u32 s97, s58, 0xe000
    s_call_b64 s[60:61], QG
    v_add_u32 v40, 4096, v40
    s_waitcnt vmcnt(3)
    s_barrier
    s_branch Lff_105
Lfr_104:
    s_sleep 8
    buffer_load_dword v46, v47, s[32:35], 0 offen offset:240 sc1
    s_sub_u32 s93, s93, 1
    s_cbranch_scc1 L_end
    s_waitcnt vmcnt(0)
Lff_105:
    v_cmp_ne_u32 vcc, 0x01010101, v46
    s_cbranch_vccnz Lfr_104
    s_mov_b32 s86, 0
L_ev:
    s_lshr_b32 s85, s86, 3
    s_mov_b32 s84, s86
    s_add_u32 s66, s86, 6
    s_cmp_ge_u32 s86, 8
    s_cselect_b32 s66, s66, s86
    s_add_u32 s67, s86, 5
    s_sub_u32 s68, s86, 3
    s_cmp_ge_u32 s68, 6
    s_cselect_b32 s87, s66, s67
    s_bitcmp0_b32 s52, 0
    s_cselect_b32 s87, s66, s87
    s_call_b64 s[60:61], COMB
    v_lshrrev_b32 v13, 4, v1
    v_lshlrev_b32 v13, 6, v13
    v_and_b32 v14, 8, v1
    v_lshl_add_u32 v13, v14, 7, v13
    s_lshl_b32 s94, s52, 8
    s_add_u32 s94, s94, 122880
    v_add_u32 v13, s94, v13
    s_lshl_b32 s97, s66, 15
    s_add_u32 s97, s97, 0x410000
    s_lshl_b32 s96, s67, 15
    s_add_u32 s96, s96, 0x410000
    s_cmp_ge_u32 s68, 6
    s_cselect_b32 s96, 0x40000000, s96
    s_waitcnt lgkmcnt(0)
    s_barrier
    s_call_b64 s[60:61], WOG
    s_cmp_eq_u32 s85, 0
    s_cbranch_scc1 L_ev_b
    s_add_u32 s86, s86, 1
    s_cmp_eq_u32 s86, 9
    s_cbranch_scc1 L_ev
    s_cmp_ge_u32 s83, 8
    s_cbranch_scc1 L_sv_done
    s_mov_b32 s84, s83
    s_add_u32 s97, s84, 8
    s_lshl_b32 s97, s97, 15
    s_add_u32 s97, s97, 0x410000
L_ev_b:
    s_lshl_b32 s94, s52, 9
    s_add_u32 s97, s97, s94
    s_mul_i32 s94, s52, 448
    s_cmp_lg_u32 s86, 0
    s_cbranch_scc1 Lnc_106
    v_lshrrev_b32 v12, 2, v1
    v_lshlrev_b32 v14, 7, v12
    v_and_b32 v12, 3, v1
    v_lshl_add_u32 v14, v12, 4, v14
    v_mov_b32 v13, v14
    v_cmp_gt_u32 vcc, 48, v1
    v_mov_b32 v61, 0x40000000
    s_nop 0
    v_cndmask_b32 v13, v61, v13, vcc
    s_mul_i32 s95, s52, 7680
    s_add_u32 s95, s95, 0x4b0000
    s_add_u32 s96, s95, 4096
    s_branch Ltf_108
Ltc_107:
    s_sleep 8
Ltf_108:
    buffer_load_dwordx4 v[32:35], v14, s[12:15], s95 offen offset:0 sc1
    buffer_load_dwordx4 v[36:39], v14, s[12:15], s95 offen offset:2048 sc1
    buffer_load_dwordx4 v[40:43], v14, s[12:15], s96 offen offset:0 sc1
    buffer_load_dwordx4 v[44:47], v13, s[12:15], s96 offen offset:2048 sc1
    s_sub_u32 s93, s93, 1
    s_cbranch_scc1 L_end
    s_waitcnt vmcnt(0)
    v_max_u32 v61, v32, v33
    v_max3_u32 v61, v61, v34, v35
    v_max3_u32 v61, v61, v36, v37
    v_max3_u32 v61, v61, v38, v39
    v_max3_u32 v61, v61, v40, v41
    v_max3_u32 v61, v61, v42, v43
    v_max3_u32 v61, v61, v44, v45
    v_max3_u32 v61, v61, v46, v47
    v_cmp_eq_u32 vcc, -1, v61
    s_cbranch_vccnz Ltc_107
    s_lshr_b32 s95, s52, 1
    s_lshl_b32 s95, s95, 13
    s_and_b32 s96, s52, 1
    s_mul_i32 s96, s96, 3840
    s_add_u32 s95, s95, s96
    s_add_u32 s95, s95, 147456
    v_lshl_add_u32 v14, v1, 4, s95
    ds_write_b128 v14, v[32:35] offset:0
    ds_write_b128 v14, v[36:39] offset:1024
    ds_write_b128 v14, v[40:43] offset:2048
    v_cmp_gt_u32 vcc, 48, v1
    s_and_saveexec_b64 s[80:81], vcc
    ds_write_b128 v14, v[44:47] offset:3072
    s_mov_b64 exec, -1
    s_waitcnt lgkmcnt(0)
Lnc_106:
    v_and_b32 v31, 31, v1
    v_lshrrev_b32 v30, 5, v1
    v_lshlrev_b32 v30, 14, v30
    v_lshl_add_u32 v30, v31, 4, v30
    v_cmp_gt_u32 vcc, 28, v31
    v_mov_b32 v61, 0x40000000
    s_nop 0
    v_cndmask_b32 v30, v61, v30, vcc
    v_lshlrev_b32 v31, 4, v31
    v_add_u32 v31, s94, v31
    s_lshl_b32 s56, s84, 11
    s_add_u32 s56, s56, 98304
    v_add_u32 v29, s56, v31
    ds_read_b128 v[24:27], v29
    v_add_u32 v31, 116736, v31
    v_lshlrev_b32 v28, 2, v1
Lretry_110:
    s_mov_b32 s96, s97
    buffer_load_dwordx4 v[64:67], v30, s[12:15], s96 offen offset:0 sc1
    buffer_load_dwordx4 v[68:71], v30, s[12:15], s96 offen offset:2048 sc1
    s_add_u32 s96, s96, 4096
    buffer_load_dwordx4 v[72:75], v30, s[12:15], s96 offen offset:0 sc1
    buffer_load_dwordx4 v[76:79], v30, s[12:15], s96 offen offset:2048 sc1
    s_add_u32 s96, s96, 4096
    buffer_load_dwordx4 v[80:83], v30, s[12:15], s96 offen offset:0 sc1
    buffer_load_dwordx4 v[84:87], v30, s[12:15], s96 offen offset:2048 sc1
    s_add_u32 s96, s96, 4096
    buffer_load_dwordx4 v[88:91], v30, s[12:15], s96 offen offset:0 sc1
    buffer_load_dwordx4 v[92:95], v30, s[12:15], s96 offen offset:2048 sc1
    s_waitcnt vmcnt(0)
    v_max_u32 v61, v64, v65
    v_max3_u32 v61, v61, v66, v67
    v_max3_u32 v61, v61, v68, v69
    v_max3_u32 v61, v61, v70, v71
    v_max3_u32 v61, v61, v72, v73
    v_max3_u32 v61, v61, v74, v75
    v_max3_u32 v61, v61, v76, v77
    v_max3_u32 v61, v61, v78, v79
    v_max3_u32 v61, v61, v80, v81
    v_max3_u32 v61, v61, v82, v83
    v_max3_u32 v61, v61, v84, v85
    v_max3_u32 v61, v61, v86, v87
    v_max3_u32 v61, v61, v88, v89
    v_max3_u32 v61, v61, v90, v91
    v_max3_u32 v61, v61, v92, v93
    v_max3_u32 v61, v61, v94, v95
    v_cmp_eq_u32 vcc, -1, v61
    s_cbranch_vccz Lok_109
    s_sub_u32 s93, s93, 1
    s_cbranch_scc1 L_end
    s_branch Lretry_110
Lok_109:
    v_pk_add_f32 v[8:9], v[64:65], v[80:81]
    v_pk_add_f32 v[10:11], v[66:67], v[82:83]
    v_pk_add_f32 v[12:13], v[68:69], v[84:85]
    v_pk_add_f32 v[14:15], v[70:71], v[86:87]
    v_pk_add_f32 v[16:17], v[72:73], v[88:89]
    v_pk_add_f32 v[18:19], v[74:75], v[90:91]
    v_pk_add_f32 v[20:21], v[76:77], v[92:93]
    v_pk_add_f32 v[22:23], v[78:79], v[94:95]
    v_pk_add_f32 v[8:9], v[8:9], v[16:17]
    v_pk_add_f32 v[10:11], v[10:11], v[18:19]
    v_pk_add_f32 v[12:13], v[12:13], v[20:21]
    v_pk_add_f32 v[14:15], v[14:15], v[22:23]
    v_pk_add_f32 v[8:9], v[8:9], v[12:13]
    v_pk_add_f32 v[10:11], v[10:11], v[14:15]
    v_mov_b32 v12, v8
    v_mov_b32 v13, v9
    v_mov_b32 v14, v10
    v_mov_b32 v15, v11
    s_waitcnt lgkmcnt(0)
    v_permlane32_swap_b32 v8, v12
    v_permlane32_swap_b32 v9, v13
    v_permlane32_swap_b32 v10, v14
    v_permlane32_swap_b32 v11, v15
    v_cmp_gt_u32 vcc, 28, v1
    v_add_f32 v8, v8, v12
    v_cvt_pk_bf16_f32 v8, v8, v8
    v_and_b32 v8, 0xffff0000, v8
    v_add_f32 v8, v8, v24
    v_cvt_pk_bf16_f32 v8, v8, v8
    v_and_b32 v8, 0xffff0000, v8
    v_add_f32 v9, v9, v13
    v_cvt_pk_bf16_f32 v9, v9, v9
    v_and_b32 v9, 0xffff0000, v9
    v_add_f32 v9, v9, v25
    v_cvt_pk_bf16_f32 v9, v9, v9
    v_and_b32 v9, 0xffff0000, v9
    v_add_f32 v10, v10, v14
    v_cvt_pk_bf16_f32 v10, v10, v10
    v_and_b32 v10, 0xffff0000, v10
    v_add_f32 v10, v10, v26
    v_cvt_pk_bf16_f32 v10, v10, v10
    v_and_b32 v10, 0xffff0000, v10
    v_add_f32 v11, v11, v15
    v_cvt_pk_bf16_f32 v11, v11, v11
    v_and_b32 v11, 0xffff0000, v11
    v_add_f32 v11, v11, v27
    v_cvt_pk_bf16_f32 v11, v11, v11
    v_and_b32 v11, 0xffff0000, v11
    s_and_saveexec_b64 s[80:81], vcc
    ds_write_b128 v31, v[8:11]
    s_mov_b64 exec, -1
    v_add_u32 v29, 116736, v28
    s_waitcnt lgkmcnt(0)
    s_barrier
    ds_read_b32 v8, v29 offset:0
    ds_read_b32 v9, v29 offset:256
    ds_read_b32 v10, v29 offset:512
    ds_read_b32 v11, v29 offset:768
    ds_read_b32 v12, v29 offset:1024
    ds_read_b32 v13, v29 offset:1280
    ds_read_b32 v14, v29 offset:1536
    s_mov_b32 s95, 121344
    s_waitcnt lgkmcnt(0)
    v_readfirstlane_b32 s70, v8
    v_mov_b32 v51, 0
    s_mov_b32 s71, s70
    v_pk_add_f32 v[44:45], v[8:9], s[70:71] neg_lo:[0,1] neg_hi:[0,1]
    v_pk_add_f32 v[46:47], v[10:11], s[70:71] neg_lo:[0,1] neg_hi:[0,1]
    v_pk_add_f32 v[48:49], v[12:13], s[70:71] neg_lo:[0,1] neg_hi:[0,1]
    v_subrev_f32 v50, s70, v14
    v_pk_add_f32 v[52:53], v[44:45], v[46:47]
    v_pk_mul_f32 v[54:55], v[44:45], v[44:45]
    v_pk_add_f32 v[44:45], v[48:49], v[50:51]
    v_pk_fma_f32 v[54:55], v[46:47], v[46:47], v[54:55]
    v_pk_fma_f32 v[54:55], v[48:49], v[48:49], v[54:55]
    v_pk_fma_f32 v[54:55], v[50:51], v[50:51], v[54:55]
    v_pk_add_f32 v[52:53], v[52:53], v[44:45]
    v_add_f32 v52, v52, v53
    v_add_f32 v53, v54, v55
    s_nop 0
    v_add_f32_dpp v52, v52, v52 row_ror:8 row_mask:0xf bank_mask:0xf
    v_add_f32_dpp v53, v53, v53 row_ror:8 row_mask:0xf bank_mask:0xf
    s_nop 0
    v_add_f32_dpp v52, v52, v52 row_ror:4 row_mask:0xf bank_mask:0xf
    v_add_f32_dpp v53, v53, v53 row_ror:4 row_mask:0xf bank_mask:0xf
    s_nop 0
    v_add_f32_dpp v52, v52, v52 row_ror:2 row_mask:0xf bank_mask:0xf
    v_add_f32_dpp v53, v53, v53 row_ror:2 row_mask:0xf bank_mask:0xf
    s_nop 0
    v_add_f32_dpp v52, v52, v52 row_ror:1 row_mask:0xf bank_mask:0xf
    v_add_f32_dpp v53, v53, v53 row_ror:1 row_mask:0xf bank_mask:0xf
    v_mov_b32 v54, v52
    v_mov_b32 v55, v53
    s_nop 0
    v_permlane16_swap_b32 v52, v54
    v_permlane16_swap_b32 v53, v55
    v_pk_add_f32 v[52:53], v[52:53], v[54:55]
    v_mov_b32 v54, v52
    v_mov_b32 v55, v53
    s_nop 0
    v_permlane32_swap_b32 v52, v54
    v_permlane32_swap_b32 v53, v55
    v_pk_add_f32 v[52:53], v[52:53], v[54:55]
    v_mul_f32 v52, 0x3b124925, v52
    v_mul_f32 v53, 0x3b124925, v53
    v_fma_f32 v53, -v52, v52, v53
    v_add_f32 v52, s70, v52
    v_max_f32 v53, 0, v53
    v_cvt_pk_bf16_f32 v53, v52, v53
    v_lshlrev_b32 v52, 16, v53
    v_and_b32 v53, 0xffff0000, v53
    v_add_f32 v53, 0x3727c5ac, v53
    v_cvt_pk_bf16_f32 v53, v53, v53
    v_and_b32 v53, 0xffff0000, v53
    v_sqrt_f32 v53, v53
    v_sub_f32 v50, v14, v52
    v_pk_add_f32 v[44:45], v[8:9], v[52:53] op_sel:[0,0] op_sel_hi:[1,0] neg_lo:[0,1] neg_hi:[0,1]
    v_pk_add_f32 v[46:47], v[10:11], v[52:53] op_sel:[0,0] op_sel_hi:[1,0] neg_lo:[0,1] neg_hi:[0,1]
    v_pk_add_f32 v[48:49], v[12:13], v[52:53] op_sel:[0,0] op_sel_hi:[1,0] neg_lo:[0,1] neg_hi:[0,1]
    v_cvt_pk_bf16_f32 v53, v53, v53
    v_and_b32 v53, 0xffff0000, v53
    v_rcp_f32 v53, v53
    v_cvt_pk_bf16_f32 v45, v44, v45
    v_cvt_pk_bf16_f32 v47, v46, v47
    v_cvt_pk_bf16_f32 v49, v48, v49
    v_cvt_pk_bf16_f32 v51, v50, v51
    v_lshlrev_b32 v44, 16, v45
    v_and_b32 v45, 0xffff0000, v45
    v_lshlrev_b32 v46, 16, v47
    v_and_b32 v47, 0xffff0000, v47
    v_lshlrev_b32 v48, 16, v49
    v_and_b32 v49, 0xffff0000, v49
    v_lshlrev_b32 v50, 16, v51
    v_pk_mul_f32 v[44:45], v[44:45], v[52:53] op_sel:[0,1] op_sel_hi:[1,1]
    v_pk_mul_f32 v[46:47], v[46:47], v[52:53] op_sel:[0,1] op_sel_hi:[1,1]
    v_pk_mul_f32 v[48:49], v[48:49], v[52:53] op_sel:[0,1] op_sel_hi:[1,1]
    v_mul_f32 v50, v50, v53
    v_cvt_pk_bf16_f32 v17, v44, v45
    v_cvt_pk_bf16_f32 v19, v46, v47
    v_cvt_pk_bf16_f32 v21, v48, v49
    v_cvt_pk_bf16_f32 v22, v50, v50
    v_lshlrev_b32 v16, 16, v17
    v_and_b32 v17, 0xffff0000, v17
    v_lshlrev_b32 v18, 16, v19
    v_and_b32 v19, 0xffff0000, v19
    v_lshlrev_b32 v20, 16, v21
    v_and_b32 v21, 0xffff0000, v21
    v_and_b32 v22, 0xffff0000, v22
    v_readfirstlane_b32 s70, v16
    v_mov_b32 v51, 0
    s_mov_b32 s71, s70
    v_pk_add_f32 v[44:45], v[16:17], s[70:71] neg_lo:[0,1] neg_hi:[0,1]
    v_pk_add_f32 v[46:47], v[18:19], s[70:71] neg_lo:[0,1] neg_hi:[0,1]
    v_pk_add_f32 v[48:49], v[20:21], s[70:71] neg_lo:[0,1] neg_hi:[0,1]
    v_subrev_f32 v50, s70, v22
    v_pk_add_f32 v[52:53], v[44:45], v[46:47]
    v_pk_mul_f32 v[54:55], v[44:45], v[44:45]
    v_pk_add_f32 v[44:45], v[48:49], v[50:51]
    v_pk_fma_f32 v[54:55], v[46:47], v[46:47], v[54:55]
    v_pk_fma_f32 v[54:55], v[48:49], v[48:49], v[54:55]
    v_pk_fma_f32 v[54:55], v[50:51], v[50:51], v[54:55]
    v_pk_add_f32 v[52:53], v[52:53], v[44:45]
    v_add_f32 v52, v52, v53
    v_add_f32 v53, v54, v55
    s_nop 0
    v_add_f32_dpp v52, v52, v52 row_ror:8 row_mask:0xf bank_mask:0xf
    v_add_f32_dpp v53, v53, v53 row_ror:8 row_mask:0xf bank_mask:0xf
    s_nop 0
    v_add_f32_dpp v52, v52, v52 row_ror:4 row_mask:0xf bank_mask:0xf
    v_add_f32_dpp v53, v53, v53 row_ror:4 row_mask:0xf bank_mask:0xf
    s_nop 0
    v_add_f32_dpp v52, v52, v52 row_ror:2 row_mask:0xf bank_mask:0xf
    v_add_f32_dpp v53, v53, v53 row_ror:2 row_mask:0xf bank_mask:0xf
    s_nop 0
    v_add_f32_dpp v52, v52, v52 row_ror:1 row_mask:0xf bank_mask:0xf
    v_add_f32_dpp v53, v53, v53 row_ror:1 row_mask:0xf bank_mask:0xf
    v_mov_b32 v54, v52
    v_mov_b32 v55, v53
    s_nop 0
    v_permlane16_swap_b32 v52, v54
    v_permlane16_swap_b32 v53, v55
    v_pk_add_f32 v[52:53], v[52:53], v[54:55]
    v_mov_b32 v54, v52
    v_mov_b32 v55, v53
    s_nop 0
    v_permlane32_swap_b32 v52, v54
    v_permlane32_swap_b32 v53, v55
    v_pk_add_f32 v[52:53], v[52:53], v[54:55]
    v_mul_f32 v52, 0x3b124925, v52
    v_mul_f32 v53, 0x3b124925, v53
    v_fma_f32 v53, -v52, v52, v53
    v_add_f32 v52, s70, v52
    v_max_f32 v53, 0, v53
    v_cvt_pk_bf16_f32 v53, v52, v53
    v_lshlrev_b32 v52, 16, v53
    v_and_b32 v53, 0xffff0000, v53
    v_add_f32 v53, 0x3727c5ac, v53
    v_cvt_pk_bf16_f32 v53, v53, v53
    v_and_b32 v53, 0xffff0000, v53
    v_sqrt_f32 v53, v53
    v_sub_f32 v50, v22, v52
    v_pk_add_f32 v[44:45], v[16:17], v[52:53] op_sel:[0,0] op_sel_hi:[1,0] neg_lo:[0,1] neg_hi:[0,1]
    v_pk_add_f32 v[46:47], v[18:19], v[52:53] op_sel:[0,0] op_sel_hi:[1,0] neg_lo:[0,1] neg_hi:[0,1]
    v_pk_add_f32 v[48:49], v[20:21], v[52:53] op_sel:[0,0] op_sel_hi:[1,0] neg_lo:[0,1] neg_hi:[0,1]
    v_cvt_pk_bf16_f32 v53, v53, v53
    v_and_b32 v53, 0xffff0000, v53
    v_rcp_f32 v53, v53
    v_cvt_pk_bf16_f32 v45, v44, v45
    v_cvt_pk_bf16_f32 v47, v46, v47
    v_cvt_pk_bf16_f32 v49, v48, v49
    v_cvt_pk_bf16_f32 v51, v50, v51
    v_lshlrev_b32 v44, 16, v45
    v_and_b32 v45, 0xffff0000, v45
    v_lshlrev_b32 v46, 16, v47
    v_and_b32 v47, 0xffff0000, v47
    v_lshlrev_b32 v48, 16, v49
    v_and_b32 v49, 0xffff0000, v49
    v_lshlrev_b32 v50, 16, v51
    v_pk_mul_f32 v[44:45], v[44:45], v[52:53] op_sel:[0,1] op_sel_hi:[1,1]
    v_pk_mul_f32 v[46:47], v[46:47], v[52:53] op_sel:[0,1] op_sel_hi:[1,1]
    v_pk_mul_f32 v[48:49], v[48:49], v[52:53] op_sel:[0,1] op_sel_hi:[1,1]
    v_mul_f32 v50, v50, v53
    v_cvt_pk_bf16_f32 v17, v44, v45
    v_cvt_pk_bf16_f32 v19, v46, v47
    v_cvt_pk_bf16_f32 v21, v48, v49
    v_cvt_pk_bf16_f32 v22, v50, v50
    v_lshlrev_b32 v16, 16, v17
    v_and_b32 v17, 0xffff0000, v17
    v_lshlrev_b32 v18, 16, v19
    v_and_b32 v19, 0xffff0000, v19
    v_lshlrev_b32 v20, 16, v21
    v_and_b32 v21, 0xffff0000, v21
    v_and_b32 v22, 0xffff0000, v22
    s_movk_i32 s97, 13056
    s_movk_i32 s96, 3839
    v_mov_b32 v31, 163326
    s_mov_b64 s[80:81], 0
    v_bfe_u32 v32, v16, 16, 15
    v_lshrrev_b32 v60, 31, v16
    v_subrev_u32 v23, s97, v32
    v_lshl_add_u32 v60, v60, 12, v32
    v_cmp_le_u32 vcc, s96, v23
    v_lshl_add_u32 v60, v60, 1, s95
    v_cmp_ne_u32 s[64:65], 0, v32
    v_cndmask_b32 v60, v60, v31, vcc
    s_and_b64 s[64:65], s[64:65], vcc
    ds_read_u16 v32, v60
    s_or_b64 s[80:81], s[80:81], s[64:65]
    v_bfe_u32 v33, v17, 16, 15
    v_lshrrev_b32 v60, 31, v17
    v_subrev_u32 v23, s97, v33
    v_lshl_add_u32 v60, v60, 12, v33
    v_cmp_le_u32 vcc, s96, v23
    v_lshl_add_u32 v60, v60, 1, s95
    v_cmp_ne_u32 s[64:65], 0, v33
    v_cndmask_b32 v60, v60, v31, vcc
    s_and_b64 s[64:65], s[64:65], vcc
    ds_read_u16 v33, v60
    s_or_b64 s[80:81], s[80:81], s[64:65]
    v_bfe_u32 v34, v18, 16, 15
    v_lshrrev_b32 v60, 31, v18
    v_subrev_u32 v23, s97, v34
    v_lshl_add_u32 v60, v60, 12, v34
    v_cmp_le_u32 vcc, s96, v23
    v_lshl_add_u32 v60, v60, 1, s95
    v_cmp_ne_u32 s[64:65], 0, v34
    v_cndmask_b32 v60, v60, v31, vcc
    s_and_b64 s[64:65], s[64:65], vcc
    ds_read_u16 v34, v60
    s_or_b64 s[80:81], s[80:81], s[64:65]
    v_bfe_u32 v35, v19, 16, 15
    v_lshrrev_b32 v60, 31, v19
    v_subrev_u32 v23, s97, v35
    v_lshl_add_u32 v60, v60, 12, v35
    v_cmp_le_u32 vcc, s96, v23
    v_lshl_add_u32 v60, v60, 1, s95
    v_cmp_ne_u32 s[64:65], 0, v35
    v_cndmask_b32 v60, v60, v31, vcc
    s_and_b64 s[64:65], s[64:65], vcc
    ds_read_u16 v35, v60
    s_or_b64 s[80:81], s[80:81], s[64:65]
    v_bfe_u32 v36, v20, 16, 15
    v_lshrrev_b32 v60, 31, v20
    v_subrev_u32 v23, s97, v36
    v_lshl_add_u32 v60, v60, 12, v36
    v_cmp_le_u32 vcc, s96, v23
    v_lshl_add_u32 v60, v60, 1, s95
    v_cmp_ne_u32 s[64:65], 0, v36
    v_cndmask_b32 v60, v60, v31, vcc
    s_and_b64 s[64:65], s[64:65], vcc
    ds_read_u16 v36, v60
    s_or_b64 s[80:81], s[80:81], s[64:65]
    v_bfe_u32 v37, v21, 16, 15
    v_lshrrev_b32 v60, 31, v21
    v_subrev_u32 v23, s97, v37
    v_lshl_add_u32 v60, v60, 12, v37
    v_cmp_le_u32 vcc, s96, v23
    v_lshl_add_u32 v60, v60, 1, s95
    v_cmp_ne_u32 s[64:65], 0, v37
    v_cndmask_b32 v60, v60, v31, vcc
    s_and_b64 s[64:65], s[64:65], vcc
    ds_read_u16 v37, v60
    s_or_b64 s[80:81], s[80:81], s[64:65]
    v_bfe_u32 v38, v22, 16, 15
    v_lshrrev_b32 v60, 31, v22
    v_subrev_u32 v23, s97, v38
    v_lshl_add_u32 v60, v60, 12, v38
    v_cmp_le_u32 vcc, s96, v23
    v_lshl_add_u32 v60, v60, 1, s95
    v_cmp_ne_u32 s[64:65], 0, v38
    v_cndmask_b32 v60, v60, v31, vcc
    s_and_b64 s[64:65], s[64:65], vcc
    ds_read_u16 v38, v60
    s_or_b64 s[80:81], s[80:81], s[64:65]
    s_waitcnt lgkmcnt(0)
    s_cbranch_scc0 Ltok_111
    v_add_u32 v30, 119296, v28
    ds_write_b32 v30, v16 offset:0
    ds_write_b32 v30, v17 offset:256
    ds_write_b32 v30, v18 offset:512
    ds_write_b32 v30, v19 offset:768
    ds_write_b32 v30, v20 offset:1024
    ds_write_b32 v30, v21 offset:1280
    ds_write_b32 v30, v22 offset:1536
    s_barrier
    v_lshlrev_b32 v48, 4, v0
    buffer_load_dwordx4 v[64:67], v48, s[36:39], 0 offen
    buffer_load_dwordx4 v[68:71], v48, s[40:43], 0 offen
    buffer_load_dwordx4 v[72:75], v48, s[44:47], 0 offen
    v_mov_b32 v49, 0
    buffer_load_ushort v76, v49, s[48:51], 0 offen
    s_waitcnt vmcnt(0)
    v_lshlrev_b32 v80, 16, v64
    v_lshlrev_b32 v81, 16, v68
    v_and_b32 v82, 0xffff0000, v64
    v_and_b32 v83, 0xffff0000, v68
    v_lshlrev_b32 v96, 16, v72
    v_and_b32 v97, 0xffff0000, v72
    v_lshlrev_b32 v84, 16, v65
    v_lshlrev_b32 v85, 16, v69
    v_and_b32 v86, 0xffff0000, v65
    v_and_b32 v87, 0xffff0000, v69
    v_lshlrev_b32 v98, 16, v73
    v_and_b32 v99, 0xffff0000, v73
    v_lshlrev_b32 v88, 16, v66
    v_lshlrev_b32 v89, 16, v70
    v_and_b32 v90, 0xffff0000, v66
    v_and_b32 v91, 0xffff0000, v70
    v_lshlrev_b32 v100, 16, v74
    v_and_b32 v101, 0xffff0000, v74
    v_lshlrev_b32 v92, 16, v67
    v_lshlrev_b32 v93, 16, v71
    v_and_b32 v94, 0xffff0000, v67
    v_and_b32 v95, 0xffff0000, v71
    v_lshlrev_b32 v102, 16, v75
    v_and_b32 v103, 0xffff0000, v75
    v_lshlrev_b32 v76, 16, v76
    v_lshlrev_b32 v48, 6, v0
    v_add_u32 v48, 124928, v48
    v_lshlrev_b32 v49, 5, v0
    v_add_u32 v49, 139264, v49
    v_readfirstlane_b32 s78, v76
    v_cmp_gt_u32 vcc, 224, v0
    s_and_saveexec_b64 s[64:65], vcc
    ds_write_b128 v48, v[80:83] offset:0
    ds_write_b128 v48, v[84:87] offset:16
    ds_write_b128 v48, v[88:91] offset:32
    ds_write_b128 v48, v[92:95] offset:48
    ds_write_b128 v49, v[96:99] offset:0
    ds_write_b128 v49, v[100:103] offset:16
    s_mov_b64 exec, -1
    s_mov_b32 s76, 0xbdd2d3e8
    s_mov_b32 s77, 0xbdd2d3e8
    s_waitcnt lgkmcnt(0)
    s_barrier
    s_mov_b32 s87, 0
Lfb_112:
    s_mul_i32 s94, s52, 112
    s_add_u32 s94, s94, s87
    v_and_b32 v60, 3, v1
    v_lshl_add_u32 v60, v60, 1, s94
    v_lshlrev_b32 v48, 2, v60
    v_add_u32 v48, 119296, v48
    ds_read_b64 v[52:53], v48
    s_call_b64 s[60:61], TINP
    s_mov_b32 s94, 14
    s_call_b64 s[60:61], TBL
    s_call_b64 s[60:61], TFIN
    v_lshlrev_b32 v48, 1, v60
    v_add_u32 v48, 121344, v48
    ds_write_b32 v48, v24
    s_add_u32 s87, s87, 8
    s_cmp_lt_u32 s87, 112
    s_cbranch_scc1 Lfb_112
    s_waitcnt lgkmcnt(0)
    s_barrier
    v_lshlrev_b32 v28, 2, v1
    v_add_u32 v29, 116736, v28
    v_lshlrev_b32 v30, 1, v1
    v_add_u32 v30, 121344, v30
    ds_read_b32 v8, v29 offset:0
    ds_read_u16 v32, v30 offset:0
    ds_read_b32 v9, v29 offset:256
    ds_read_u16 v33, v30 offset:128
    ds_read_b32 v10, v29 offset:512
    ds_read_u16 v34, v30 offset:256
    ds_read_b32 v11, v29 offset:768
    ds_read_u16 v35, v30 offset:384
    ds_read_b32 v12, v29 offset:1024
    ds_read_u16 v36, v30 offset:512
    ds_read_b32 v13, v29 offset:1280
    ds_read_u16 v37, v30 offset:640
    ds_read_b32 v14, v29 offset:1536
    ds_read_u16 v38, v30 offset:768
    s_waitcnt lgkmcnt(0)
Ltok_111:
    v_lshlrev_b32 v32, 16, v32
    v_add_f32 v8, v8, v32
    v_cvt_pk_bf16_f32 v8, v8, v8
    v_lshlrev_b32 v33, 16, v33
    v_add_f32 v9, v9, v33
    v_cvt_pk_bf16_f32 v9, v9, v9
    v_lshlrev_b32 v34, 16, v34
    v_add_f32 v10, v10, v34
    v_cvt_pk_bf16_f32 v10, v10, v10
    v_lshlrev_b32 v35, 16, v35
    v_add_f32 v11, v11, v35
    v_cvt_pk_bf16_f32 v11, v11, v11
    v_lshlrev_b32 v36, 16, v36
    v_add_f32 v12, v12, v36
    v_cvt_pk_bf16_f32 v12, v12, v12
    v_lshlrev_b32 v37, 16, v37
    v_add_f32 v13, v13, v37
    v_cvt_pk_bf16_f32 v13, v13, v13
    v_lshlrev_b32 v38, 16, v38
    v_add_f32 v14, v14, v38
    v_cvt_pk_bf16_f32 v14, v14, v14
    s_cmp_eq_u32 s85, 0
    s_cbranch_scc1 L_ev_q
    v_lshlrev_b32 v40, 1, v1
    s_mul_i32 s94, s84, 896
    s_cmp_eq_u32 s52, 0
    s_cselect_b32 s94, s94, 0x40000000
    buffer_store_short v8, v40, s[28:31], s94 offen offset:0
    buffer_store_short v9, v40, s[28:31], s94 offen offset:128
    buffer_store_short v10, v40, s[28:31], s94 offen offset:256
    buffer_store_short v11, v40, s[28:31], s94 offen offset:384
    buffer_store_short v12, v40, s[28:31], s94 offen offset:512
    buffer_store_short v13, v40, s[28:31], s94 offen offset:640
    buffer_store_short v14, v40, s[28:31], s94 offen offset:768
    s_branch L_sv_done
L_ev_q:
    v_add_u32 v29, s56, v28
    v_add_u32 v30, 114688, v28
    v_and_b32 v8, 0xffff0000, v8
    ds_write_b32 v29, v8 offset:0
    v_and_b32 v9, 0xffff0000, v9
    ds_write_b32 v29, v9 offset:256
    v_and_b32 v10, 0xffff0000, v10
    ds_write_b32 v29, v10 offset:512
    v_and_b32 v11, 0xffff0000, v11
    ds_write_b32 v29, v11 offset:768
    v_and_b32 v12, 0xffff0000, v12
    ds_write_b32 v29, v12 offset:1024
    v_and_b32 v13, 0xffff0000, v13
    ds_write_b32 v29, v13 offset:1280
    v_and_b32 v14, 0xffff0000, v14
    ds_write_b32 v29, v14 offset:1536
    v_readfirstlane_b32 s70, v8
    v_mov_b32 v51, 0
    s_mov_b32 s71, s70
    v_pk_add_f32 v[44:45], v[8:9], s[70:71] neg_lo:[0,1] neg_hi:[0,1]
    v_pk_add_f32 v[46:47], v[10:11], s[70:71] neg_lo:[0,1] neg_hi:[0,1]
    v_pk_add_f32 v[48:49], v[12:13], s[70:71] neg_lo:[0,1] neg_hi:[0,1]
    v_subrev_f32 v50, s70, v14
    v_pk_add_f32 v[52:53], v[44:45], v[46:47]
    v_pk_mul_f32 v[54:55], v[44:45], v[44:45]
    v_pk_add_f32 v[44:45], v[48:49], v[50:51]
    v_pk_fma_f32 v[54:55], v[46:47], v[46:47], v[54:55]
    v_pk_fma_f32 v[54:55], v[48:49], v[48:49], v[54:55]
    v_pk_fma_f32 v[54:55], v[50:51], v[50:51], v[54:55]
    v_pk_add_f32 v[52:53], v[52:53], v[44:45]
    v_add_f32 v52, v52, v53
    v_add_f32 v53, v54, v55
    s_nop 0
    v_add_f32_dpp v52, v52, v52 row_ror:8 row_mask:0xf bank_mask:0xf
    v_add_f32_dpp v53, v53, v53 row_ror:8 row_mask:0xf bank_mask:0xf
    s_nop 0
    v_add_f32_dpp v52, v52, v52 row_ror:4 row_mask:0xf bank_mask:0xf
    v_add_f32_dpp v53, v53, v53 row_ror:4 row_mask:0xf bank_mask:0xf
    s_nop 0
    v_add_f32_dpp v52, v52, v52 row_ror:2 row_mask:0xf bank_mask:0xf
    v_add_f32_dpp v53, v53, v53 row_ror:2 row_mask:0xf bank_mask:0xf
    s_nop 0
    v_add_f32_dpp v52, v52, v52 row_ror:1 row_mask:0xf bank_mask:0xf
    v_add_f32_dpp v53, v53, v53 row_ror:1 row_mask:0xf bank_mask:0xf
    v_mov_b32 v54, v52
    v_mov_b32 v55, v53
    s_nop 0
    v_permlane16_swap_b32 v52, v54
    v_permlane16_swap_b32 v53, v55
    v_pk_add_f32 v[52:53], v[52:53], v[54:55]
    v_mov_b32 v54, v52
    v_mov_b32 v55, v53
    s_nop 0
    v_permlane32_swap_b32 v52, v54
    v_permlane32_swap_b32 v53, v55
    v_pk_add_f32 v[52:53], v[52:53], v[54:55]
    v_mul_f32 v52, 0x3b124925, v52
    v_mul_f32 v53, 0x3b124925, v53
    v_fma_f32 v53, -v52, v52, v53
    v_add_f32 v52, s70, v52
    v_max_f32 v53, 0, v53
    v_cvt_pk_bf16_f32 v53, v52, v53
    v_lshlrev_b32 v52, 16, v53
    v_and_b32 v53, 0xffff0000, v53
    v_add_f32 v53, 0x3727c5ac, v53
    v_cvt_pk_bf16_f32 v53, v53, v53
    v_and_b32 v53, 0xffff0000, v53
    v_sqrt_f32 v53, v53
    v_sub_f32 v50, v14, v52
    v_pk_add_f32 v[44:45], v[8:9], v[52:53] op_sel:[0,0] op_sel_hi:[1,0] neg_lo:[0,1] neg_hi:[0,1]
    v_pk_add_f32 v[46:47], v[10:11], v[52:53] op_sel:[0,0] op_sel_hi:[1,0] neg_lo:[0,1] neg_hi:[0,1]
    v_pk_add_f32 v[48:49], v[12:13], v[52:53] op_sel:[0,0] op_sel_hi:[1,0] neg_lo:[0,1] neg_hi:[0,1]
    v_cvt_pk_bf16_f32 v53, v53, v53
    v_and_b32 v53, 0xffff0000, v53
    v_rcp_f32 v53, v53
    v_cvt_pk_bf16_f32 v45, v44, v45
    v_cvt_pk_bf16_f32 v47, v46, v47
    v_cvt_pk_bf16_f32 v49, v48, v49
    v_cvt_pk_bf16_f32 v51, v50, v51
    v_lshlrev_b32 v44, 16, v45
    v_and_b32 v45, 0xffff0000, v45
    v_lshlrev_b32 v46, 16, v47
    v_and_b32 v47, 0xffff0000, v47
    v_lshlrev_b32 v48, 16, v49
    v_and_b32 v49, 0xffff0000, v49
    v_lshlrev_b32 v50, 16, v51
    v_pk_mul_f32 v[44:45], v[44:45], v[52:53] op_sel:[0,1] op_sel_hi:[1,1]
    v_pk_mul_f32 v[46:47], v[46:47], v[52:53] op_sel:[0,1] op_sel_hi:[1,1]
    v_pk_mul_f32 v[48:49], v[48:49], v[52:53] op_sel:[0,1] op_sel_hi:[1,1]
    v_mul_f32 v50, v50, v53
    v_cvt_pk_bf16_f32 v16, v44, v44
    v_cvt_pk_bf16_f32 v17, v45, v45
    v_cvt_pk_bf16_f32 v18, v46, v46
    v_cvt_pk_bf16_f32 v19, v47, v47
    v_cvt_pk_bf16_f32 v20, v48, v48
    v_cvt_pk_bf16_f32 v21, v49, v49
    v_cvt_pk_bf16_f32 v22, v50, v50
    ds_write_b32 v30, v16 offset:0
    ds_write_b32 v30, v17 offset:256
    ds_write_b32 v30, v18 offset:512
    ds_write_b32 v30, v19 offset:768
    ds_write_b32 v30, v20 offset:1024
    ds_write_b32 v30, v21 offset:1280
    ds_write_b32 v30, v22 offset:1536
    v_mov_b32 v40, v62
    s_add_u32 s96, s84, 8
    s_lshl_b32 s96, s96, 13
    s_add_u32 s96, s96, s58
    s_mov_b32 s97, 0x40000000
    s_waitcnt lgkmcnt(0)
    s_call_b64 s[60:61], QG
    s_cmp_ge_u32 s86, 2
    s_cbranch_scc1 Lc_113
    s_cmp_eq_u32 s86, 0
    s_cselect_b32 s94, 3, 6
    s_call_b64 s[60:61], SCL
    s_cmp_eq_u32 s86, 0
    s_cselect_b32 s94, 9, 12
    s_call_b64 s[60:61], SCL
    s_cmp_eq_u32 s86, 0
    s_cselect_b32 s94, 4, 7
    s_call_b64 s[60:61], SCL
    s_cmp_eq_u32 s86, 0
    s_cselect_b32 s94, 10, 13
    s_call_b64 s[60:61], SCL
    s_cmp_eq_u32 s86, 0
    s_cselect_b32 s94, 5, 14
    s_call_b64 s[60:61], SCL
    s_cmp_eq_u32 s86, 0
    s_cselect_b32 s94, 11, 15
    s_call_b64 s[60:61], SCL
Lc_113:
    s_add_u32 s86, s86, 1
    s_branch L_ev
L_sv_done:
L_end:
    s_endpgm
SM4:
    s_nop 3
    v_mov_b32_dpp v40, v24 quad_perm:[0,0,0,0] row_mask:0xf bank_mask:0xf
    v_add_f32_dpp v40, v25, v40 quad_perm:[1,1,1,1] row_mask:0xf bank_mask:0xf
    v_add_f32_dpp v40, v26, v40 quad_perm:[2,2,2,2] row_mask:0xf bank_mask:0xf
    v_add_f32_dpp v40, v27, v40 quad_perm:[3,3,3,3] row_mask:0xf bank_mask:0xf
    v_mov_b32_dpp v41, v28 quad_perm:[0,0,0,0] row_mask:0xf bank_mask:0xf
    v_add_f32_dpp v41, v29, v41 quad_perm:[1,1,1,1] row_mask:0xf bank_mask:0xf
    v_add_f32_dpp v41, v30, v41 quad_perm:[2,2,2,2] row_mask:0xf bank_mask:0xf
    v_add_f32_dpp v41, v31, v41 quad_perm:[3,3,3,3] row_mask:0xf bank_mask:0xf
    v_mov_b32_dpp v42, v32 quad_perm:[0,0,0,0] row_mask:0xf bank_mask:0xf
    v_add_f32_dpp v42, v33, v42 quad_perm:[1,1,1,1] row_mask:0xf bank_mask:0xf
    v_add_f32_dpp v42, v34, v42 quad_perm:[2,2,2,2] row_mask:0xf bank_mask:0xf
    v_add_f32_dpp v42, v35, v42 quad_perm:[3,3,3,3] row_mask:0xf bank_mask:0xf
    v_mov_b32_dpp v43, v36 quad_perm:[0,0,0,0] row_mask:0xf bank_mask:0xf
    v_add_f32_dpp v43, v37, v43 quad_perm:[1,1,1,1] row_mask:0xf bank_mask:0xf
    v_add_f32_dpp v43, v38, v43 quad_perm:[2,2,2,2] row_mask:0xf bank_mask:0xf
    v_add_f32_dpp v43, v39, v43 quad_perm:[3,3,3,3] row_mask:0xf bank_mask:0xf
    v_cvt_pk_bf16_f32 v40, v40, v40
    v_and_b32 v40, 0xffff0000, v40
    v_cvt_pk_bf16_f32 v41, v41, v41
    v_and_b32 v41, 0xffff0000, v41
    v_cvt_pk_bf16_f32 v42, v42, v42
    v_and_b32 v42, 0xffff0000, v42
    v_cvt_pk_bf16_f32 v43, v43, v43
    v_and_b32 v43, 0xffff0000, v43
    v_max_f32 v44, v40, v41
    v_max_f32 v44, v44, v42
    v_max_f32 v44, v44, v43
    v_cmp_gt_f32 vcc, v44, v45
    s_cbranch_vccz Lsk_114
    s_call_b64 s[62:63], RESCALE
Lsk_114:
    v_fma_f32 v40, v40, s55, -v46
    v_fma_f32 v41, v41, s55, -v46
    v_fma_f32 v42, v42, s55, -v46
    v_fma_f32 v43, v43, s55, -v46
    v_exp_f32 v40, v40
    v_exp_f32 v41, v41
    v_exp_f32 v42, v42
    v_exp_f32 v43, v43
    s_nop 0
    v_add_f32 v47, v47, v40
    v_cvt_pk_bf16_f32 v40, v40, v40
    v_add_f32 v47, v47, v41
    v_cvt_pk_bf16_f32 v41, v41, v41
    v_add_f32 v47, v47, v42
    v_cvt_pk_bf16_f32 v42, v42, v42
    v_add_f32 v47, v47, v43
    v_cvt_pk_bf16_f32 v43, v43, v43
    v_and_b32 v24, v40, v4
    v_and_b32 v25, v40, v5
    v_and_b32 v26, v40, v6
    v_and_b32 v27, v40, v7
    v_and_b32 v28, v41, v4
    v_and_b32 v29, v41, v5
    v_and_b32 v30, v41, v6
    v_and_b32 v31, v41, v7
    v_and_b32 v32, v42, v4
    v_and_b32 v33, v42, v5
    v_and_b32 v34, v42, v6
    v_and_b32 v35, v42, v7
    v_and_b32 v36, v43, v4
    v_and_b32 v37, v43, v5
    v_and_b32 v38, v43, v6
    v_and_b32 v39, v43, v7
    s_nop 0
    s_setpc_b64 s[60:61]
SM3:
    s_nop 4
    v_mov_b32_dpp v40, v24 quad_perm:[0,0,0,0] row_mask:0xf bank_mask:0xf
    v_add_f32_dpp v40, v25, v40 quad_perm:[1,1,1,1] row_mask:0xf bank_mask:0xf
    v_add_f32_dpp v40, v26, v40 quad_perm:[2,2,2,2] row_mask:0xf bank_mask:0xf
    v_add_f32_dpp v40, v27, v40 quad_perm:[3,3,3,3] row_mask:0xf bank_mask:0xf
    v_mov_b32_dpp v41, v28 quad_perm:[0,0,0,0] row_mask:0xf bank_mask:0xf
    v_add_f32_dpp v41, v29, v41 quad_perm:[1,1,1,1] row_mask:0xf bank_mask:0xf
    v_add_f32_dpp v41, v30, v41 quad_perm:[2,2,2,2] row_mask:0xf bank_mask:0xf
    v_add_f32_dpp v41, v31, v41 quad_perm:[3,3,3,3] row_mask:0xf bank_mask:0xf
    v_mov_b32_dpp v42, v32 quad_perm:[0,0,0,0] row_mask:0xf bank_mask:0xf
    v_add_f32_dpp v42, v33, v42 quad_perm:[1,1,1,1] row_mask:0xf bank_mask:0xf
    v_add_f32_dpp v42, v34, v42 quad_perm:[2,2,2,2] row_mask:0xf bank_mask:0xf
    v_add_f32_dpp v42, v35, v42 quad_perm:[3,3,3,3] row_mask:0xf bank_mask:0xf
    v_cvt_pk_bf16_f32 v40, v40, v40
    v_and_b32 v40, 0xffff0000, v40
    v_cvt_pk_bf16_f32 v41, v41, v41
    v_and_b32 v41, 0xffff0000, v41
    v_cvt_pk_bf16_f32 v42, v42, v42
    v_and_b32 v42, 0xffff0000, v42
    v_max_f32 v44, v40, v41
    v_max_f32 v44, v44, v42
    v_cmp_gt_f32 vcc, v44, v45
    s_cbranch_vccz Lsk_115
    s_call_b64 s[62:63], RESCALE
Lsk_115:
    v_fma_f32 v40, v40, s55, -v46
    v_fma_f32 v41, v41, s55, -v46
    v_fma_f32 v42, v42, s55, -v46
    v_exp_f32 v40, v40
    v_exp_f32 v41, v41
    v_exp_f32 v42, v42
    s_nop 0
    v_add_f32 v47, v47, v40
    v_cvt_pk_bf16_f32 v40, v40, v40
    v_add_f32 v47, v47, v41
    v_cvt_pk_bf16_f32 v41, v41, v41
    v_add_f32 v47, v47, v42
    v_cvt_pk_bf16_f32 v42, v42, v42
    v_and_b32 v24, v40, v4
    v_and_b32 v25, v40, v5
    v_and_b32 v26, v40, v6
    v_and_b32 v27, v40, v7
    v_and_b32 v28, v41, v4
    v_and_b32 v29, v41, v5
    v_and_b32 v30, v41, v6
    v_and_b32 v31, v41, v7
    v_and_b32 v32, v42, v4
    v_and_b32 v33, v42, v5
    v_and_b32 v34, v42, v6
    v_and_b32 v35, v42, v7
    s_nop 0
    s_setpc_b64 s[60:61]
SM2:
    s_nop 5
    v_mov_b32_dpp v40, v24 quad_perm:[0,0,0,0] row_mask:0xf bank_mask:0xf
    v_add_f32_dpp v40, v25, v40 quad_perm:[1,1,1,1] row_mask:0xf bank_mask:0xf
    v_add_f32_dpp v40, v26, v40 quad_perm:[2,2,2,2] row_mask:0xf bank_mask:0xf
    v_add_f32_dpp v40, v27, v40 quad_perm:[3,3,3,3] row_mask:0xf bank_mask:0xf
    v_mov_b32_dpp v41, v28 quad_perm:[0,0,0,0] row_mask:0xf bank_mask:0xf
    v_add_f32_dpp v41, v29, v41 quad_perm:[1,1,1,1] row_mask:0xf bank_mask:0xf
    v_add_f32_dpp v41, v30, v41 quad_perm:[2,2,2,2] row_mask:0xf bank_mask:0xf
    v_add_f32_dpp v41, v31, v41 quad_perm:[3,3,3,3] row_mask:0xf bank_mask:0xf
    v_cvt_pk_bf16_f32 v40, v40, v40
    v_and_b32 v40, 0xffff0000, v40
    v_cvt_pk_bf16_f32 v41, v41, v41
    v_and_b32 v41, 0xffff0000, v41
    v_max_f32 v44, v40, v41
    v_cmp_gt_f32 vcc, v44, v45
    s_cbranch_vccz Lsk_116
    s_call_b64 s[62:63], RESCALE
Lsk_116:
    v_fma_f32 v40, v40, s55, -v46
    v_fma_f32 v41, v41, s55, -v46
    v_exp_f32 v40, v40
    v_exp_f32 v41, v41
    s_nop 0
    v_add_f32 v47, v47, v40
    v_cvt_pk_bf16_f32 v40, v40, v40
    v_add_f32 v47, v47, v41
    v_cvt_pk_bf16_f32 v41, v41, v41
    v_and_b32 v24, v40, v4
    v_and_b32 v25, v40, v5
    v_and_b32 v26, v40, v6
    v_and_b32 v27, v40, v7
    v_and_b32 v28, v41, v4
    v_and_b32 v29, v41, v5
    v_and_b32 v30, v41, v6
    v_and_b32 v31, v41, v7
    s_nop 0
    s_setpc_b64 s[60:61]
SM1:
    s_nop 6
    v_mov_b32_dpp v40, v24 quad_perm:[0,0,0,0] row_mask:0xf bank_mask:0xf
    v_add_f32_dpp v40, v25, v40 quad_perm:[1,1,1,1] row_mask:0xf bank_mask:0xf
    v_add_f32_dpp v40, v26, v40 quad_perm:[2,2,2,2] row_mask:0xf bank_mask:0xf
    v_add_f32_dpp v40, v27, v40 quad_perm:[3,3,3,3] row_mask:0xf bank_mask:0xf
    v_cvt_pk_bf16_f32 v40, v40, v40
    v_and_b32 v40, 0xffff0000, v40
    v_mov_b32 v44, v40
    v_cmp_gt_f32 vcc, v44, v45
    s_cbranch_vccz Lsk_117
    s_call_b64 s[62:63], RESCALE
Lsk_117:
    v_fma_f32 v40, v40, s55, -v46
    v_exp_f32 v40, v40
    s_nop 0
    v_add_f32 v47, v47, v40
    v_cvt_pk_bf16_f32 v40, v40, v40
    v_and_b32 v24, v40, v4
    v_and_b32 v25, v40, v5
    v_and_b32 v26, v40, v6
    v_and_b32 v27, v40, v7
    s_nop 0
    s_setpc_b64 s[60:61]
RESCALE:
    v_mov_b32 v48, v44
    s_nop 1
    v_permlane16_swap_b32 v44, v48
    s_nop 0
    v_max_f32 v44, v44, v48
    v_mov_b32 v48, v44
    s_nop 1
    v_permlane32_swap_b32 v44, v48
    s_nop 0
    v_max_f32 v44, v44, v48
    v_mul_f32 v44, s55, v44
    v_ceil_f32 v44, v44
    v_max_f32 v44, v44, v46
    v_sub_f32 v48, v46, v44
    v_exp_f32 v48, v48
    v_mov_b32 v46, v44
    v_mul_f32 v45, 0x41317218, v44
    v_mul_f32 v47, v47, v48
    v_readlane_b32 s94, v48, 0
    v_readlane_b32 s95, v48, 8
    s_nop 1
    v_mov_b32 v49, s94
    v_mov_b32 v61, s95
    v_cndmask_b32 v49, v49, v61, s[98:99]
    v_mul_f32 v16, v16, v49
    v_mul_f32 v17, v17, v49
    v_mul_f32 v18, v18, v49
    v_mul_f32 v19, v19, v49
    v_mul_f32 v20, v20, v49
    v_mul_f32 v21, v21, v49
    v_mul_f32 v22, v22, v49
    v_mul_f32 v23, v23, v49
    s_setpc_b64 s[62:63]
REC:
    v_mov_b32 v48, v47
    s_nop 1
    v_permlane16_swap_b32 v47, v48
    s_nop 0
    v_add_f32 v47, v47, v48
    v_mov_b32 v48, v47
    s_nop 1
    v_permlane32_swap_b32 v47, v48
    s_nop 0
    v_add_f32 v47, v47, v48
    v_cvt_pk_bf16_f32 v24, v16, v17
    v_cvt_pk_bf16_f32 v25, v18, v19
    v_cvt_pk_bf16_f32 v26, v20, v21
    v_cvt_pk_bf16_f32 v27, v22, v23
    s_lshl_b32 s94, s52, 10
    s_add_u32 s94, s94, s96
    v_lshl_add_u32 v30, v1, 4, s94
    v_permlane16_swap_b32 v24, v26
    v_permlane16_swap_b32 v25, v27
    v_and_b32 v31, 8, v1
    s_lshl_b32 s94, s52, 3
    s_add_u32 s94, s94, s96
    v_lshl_add_u32 v31, v31, 2, s94
    ds_write_b128 v30, v[24:27]
    ds_write_b64 v31, v[46:47] offset:4096
    s_waitcnt lgkmcnt(0)
INIT:
    v_mov_b32 v16, 0
    v_mov_b32 v17, 0
    v_mov_b32 v18, 0
    v_mov_b32 v19, 0
    v_mov_b32 v20, 0
    v_mov_b32 v21, 0
    v_mov_b32 v22, 0
    v_mov_b32 v23, 0
    v_mov_b32 v47, 0
    v_mov_b32 v45, 0xff61b1e6
    v_mul_f32 v46, s55, v45
    s_setpc_b64 s[60:61]
MRG:
    v_lshl_add_u32 v48, v1, 4, s96
    v_and_b32 v49, 32, v1
    v_add_u32 v49, s96, v49
    ds_read_b128 v[40:43], v49 offset:4096
    ds_read_b128 v[44:47], v49 offset:4112
    ds_read_b128 v[24:27], v48 offset:0
    ds_read_b128 v[28:31], v48 offset:1024
    ds_read_b128 v[32:35], v48 offset:2048
    ds_read_b128 v[36:39], v48 offset:3072
    s_waitcnt lgkmcnt(4)
    v_max3_f32 v48, v40, v42, v44
    v_max_f32 v48, v48, v46
    v_sub_f32 v40, v40, v48
    v_sub_f32 v42, v42, v48
    v_sub_f32 v44, v44, v48
    v_sub_f32 v46, v46, v48
    v_exp_f32 v40, v40
    v_exp_f32 v42, v42
    v_exp_f32 v44, v44
    v_exp_f32 v46, v46
    s_nop 0
    v_mul_f32 v49, v40, v41
    v_fmac_f32 v49, v42, v43
    v_fmac_f32 v49, v44, v45
    v_fmac_f32 v49, v46, v47
    s_waitcnt lgkmcnt(0)
    v_lshlrev_b32 v61, 16, v24
    v_and_b32 v24, 0xffff0000, v24
    v_fmac_f32 v16, v61, v40
    v_fmac_f32 v17, v24, v40
    v_lshlrev_b32 v61, 16, v25
    v_and_b32 v25, 0xffff0000, v25
    v_fmac_f32 v18, v61, v40
    v_fmac_f32 v19, v25, v40
    v_lshlrev_b32 v61, 16, v26
    v_and_b32 v26, 0xffff0000, v26
    v_fmac_f32 v20, v61, v40
    v_fmac_f32 v21, v26, v40
    v_lshlrev_b32 v61, 16, v27
    v_and_b32 v27, 0xffff0000, v27
    v_fmac_f32 v22, v61, v40
    v_fmac_f32 v23, v27, v40
    v_lshlrev_b32 v61, 16, v28
    v_and_b32 v28, 0xffff0000, v28
    v_fmac_f32 v16, v61, v42
    v_fmac_f32 v17, v28, v42
    v_lshlrev_b32 v61, 16, v29
    v_and_b32 v29, 0xffff0000, v29
    v_fmac_f32 v18, v61, v42
    v_fmac_f32 v19, v29, v42
    v_lshlrev_b32 v61, 16, v30
    v_and_b32 v30, 0xffff0000, v30
    v_fmac_f32 v20, v61, v42
    v_fmac_f32 v21, v30, v42
    v_lshlrev_b32 v61, 16, v31
    v_and_b32 v31, 0xffff0000, v31
    v_fmac_f32 v22, v61, v42
    v_fmac_f32 v23, v31, v42
    v_lshlrev_b32 v61, 16, v32
    v_and_b32 v32, 0xffff0000, v32
    v_fmac_f32 v16, v61, v44
    v_fmac_f32 v17, v32, v44
    v_lshlrev_b32 v61, 16, v33
    v_and_b32 v33, 0xffff0000, v33
    v_fmac_f32 v18, v61, v44
    v_fmac_f32 v19, v33, v44
    v_lshlrev_b32 v61, 16, v34
    v_and_b32 v34, 0xffff0000, v34
    v_fmac_f32 v20, v61, v44
    v_fmac_f32 v21, v34, v44
    v_lshlrev_b32 v61, 16, v35
    v_and_b32 v35, 0xffff0000, v35
    v_fmac_f32 v22, v61, v44
    v_fmac_f32 v23, v35, v44
    v_lshlrev_b32 v61, 16, v36
    v_and_b32 v36, 0xffff0000, v36
    v_fmac_f32 v16, v61, v46
    v_fmac_f32 v17, v36, v46
    v_lshlrev_b32 v61, 16, v37
    v_and_b32 v37, 0xffff0000, v37
    v_fmac_f32 v18, v61, v46
    v_fmac_f32 v19, v37, v46
    v_lshlrev_b32 v61, 16, v38
    v_and_b32 v38, 0xffff0000, v38
    v_fmac_f32 v20, v61, v46
    v_fmac_f32 v21, v38, v46
    v_lshlrev_b32 v61, 16, v39
    v_and_b32 v39, 0xffff0000, v39
    v_fmac_f32 v22, v61, v46
    v_fmac_f32 v23, v39, v46
    v_cvt_pk_bf16_f32 v24, v16, v17
    v_cvt_pk_bf16_f32 v25, v18, v19
    v_cvt_pk_bf16_f32 v26, v20, v21
    v_cvt_pk_bf16_f32 v27, v22, v23
    v_min_u32 v24, -2, v24
    v_min_u32 v25, -2, v25
    v_min_u32 v26, -2, v26
    v_min_u32 v27, -2, v27
MST:
    buffer_store_dwordx4 v[24:27], v50, s[12:15], s56 offen sc1
    buffer_store_dwordx2 v[48:49], v51, s[12:15], s57 offen sc1
    s_branch INIT
ARR:
    v_mov_b32 v48, 160512
    v_mov_b32 v49, 1
    s_mov_b64 exec, 1
    ds_add_rtn_u32 v49, v48, v49
    s_mov_b64 exec, -1
    s_waitcnt lgkmcnt(0)
    v_readfirstlane_b32 s94, v49
    s_nop 3
    s_and_b32 s94, s94, 3
    s_setpc_b64 s[60:61]
WDN:
    v_mov_b32 v48, s95
    ds_read_b32 v49, v48
    s_sub_u32 s93, s93, 1
    s_cbranch_scc1 L_end
    s_waitcnt lgkmcnt(0)
    v_cmp_gt_u32 vcc, s69, v49
    s_cbranch_vccnz WDN
    s_setpc_b64 s[60:61]
TBL:
    ds_read_b128 v[64:67], v58 offset:0
    ds_read_b128 v[68:71], v58 offset:16
    ds_read_b128 v[72:75], v59 offset:0
TBL_loop:
    s_waitcnt lgkmcnt(0)
    ds_read_b128 v[76:79], v58 offset:512
    ds_read_b128 v[80:83], v58 offset:528
    ds_read_b128 v[84:87], v59 offset:256
    v_pk_mul_f32 v[88:89], v[52:53], v[64:65] op_sel:[0,0] op_sel_hi:[1,0]
    v_pk_mul_f32 v[90:91], v[52:53], v[66:67] op_sel:[0,0] op_sel_hi:[1,0]
    v_pk_mul_f32 v[92:93], v[52:53], v[68:69] op_sel:[0,0] op_sel_hi:[1,0]
    v_pk_mul_f32 v[94:95], v[52:53], v[70:71] op_sel:[0,0] op_sel_hi:[1,0]
    v_cvt_pk_bf16_f32 v89, v88, v89
    v_cvt_pk_bf16_f32 v91, v90, v91
    v_cvt_pk_bf16_f32 v93, v92, v93
    v_cvt_pk_bf16_f32 v95, v94, v95
    v_lshlrev_b32 v88, 16, v89
    v_and_b32 v89, 0xffff0000, v89
    v_lshlrev_b32 v90, 16, v91
    v_and_b32 v91, 0xffff0000, v91
    v_lshlrev_b32 v92, 16, v93
    v_and_b32 v93, 0xffff0000, v93
    v_lshlrev_b32 v94, 16, v95
    v_and_b32 v95, 0xffff0000, v95
    v_pk_add_f32 v[88:89], v[88:89], v[64:65] op_sel:[0,1] op_sel_hi:[1,1]
    v_pk_add_f32 v[90:91], v[90:91], v[66:67] op_sel:[0,1] op_sel_hi:[1,1]
    v_pk_add_f32 v[92:93], v[92:93], v[68:69] op_sel:[0,1] op_sel_hi:[1,1]
    v_pk_add_f32 v[94:95], v[94:95], v[70:71] op_sel:[0,1] op_sel_hi:[1,1]
    v_cvt_pk_bf16_f32 v89, v88, v89
    v_cvt_pk_bf16_f32 v91, v90, v91
    v_cvt_pk_bf16_f32 v93, v92, v93
    v_cvt_pk_bf16_f32 v95, v94, v95
    v_lshlrev_b32 v88, 16, v89
    v_and_b32 v89, 0xffff0000, v89
    v_lshlrev_b32 v90, 16, v91
    v_and_b32 v91, 0xffff0000, v91
    v_lshlrev_b32 v92, 16, v93
    v_and_b32 v93, 0xffff0000, v93
    v_lshlrev_b32 v94, 16, v95
    v_and_b32 v95, 0xffff0000, v95
    v_pk_mul_f32 v[96:97], v[88:89], v[88:89]
    v_pk_mul_f32 v[98:99], v[90:91], v[90:91]
    v_pk_mul_f32 v[100:101], v[92:93], v[92:93]
    v_pk_mul_f32 v[102:103], v[94:95], v[94:95]
    v_pk_fma_f32 v[96:97], v[96:97], s[76:77], v[56:57] op_sel:[0,0,0] op_sel_hi:[1,1,0]
    v_pk_fma_f32 v[98:99], v[98:99], s[76:77], v[56:57] op_sel:[0,0,0] op_sel_hi:[1,1,0]
    v_pk_fma_f32 v[100:101], v[100:101], s[76:77], v[56:57] op_sel:[0,0,0] op_sel_hi:[1,1,0]
    v_pk_fma_f32 v[102:103], v[102:103], s[76:77], v[56:57] op_sel:[0,0,0] op_sel_hi:[1,1,0]
    v_pk_mul_f32 v[96:97], v[88:89], v[96:97]
    v_pk_mul_f32 v[98:99], v[90:91], v[98:99]
    v_pk_mul_f32 v[100:101], v[92:93], v[100:101]
    v_pk_mul_f32 v[102:103], v[94:95], v[102:103]
    v_exp_f32 v96, v96
    v_exp_f32 v97, v97
    v_exp_f32 v98, v98
    v_exp_f32 v99, v99
    v_exp_f32 v100, v100
    v_exp_f32 v101, v101
    v_exp_f32 v102, v102
    v_exp_f32 v103, v103
    v_pk_add_f32 v[96:97], v[96:97], 1.0 op_sel_hi:[1,0]
    v_pk_add_f32 v[98:99], v[98:99], 1.0 op_sel_hi:[1,0]
    v_pk_add_f32 v[100:101], v[100:101], 1.0 op_sel_hi:[1,0]
    v_pk_add_f32 v[102:103], v[102:103], 1.0 op_sel_hi:[1,0]
    v_rcp_f32 v96, v96
    v_rcp_f32 v97, v97
    v_rcp_f32 v98, v98
    v_rcp_f32 v99, v99
    v_rcp_f32 v100, v100
    v_rcp_f32 v101, v101
    v_rcp_f32 v102, v102
    v_rcp_f32 v103, v103
    v_pk_mul_f32 v[96:97], v[88:89], v[96:97]
    v_pk_mul_f32 v[98:99], v[90:91], v[98:99]
    v_pk_mul_f32 v[100:101], v[92:93], v[100:101]
    v_pk_mul_f32 v[102:103], v[94:95], v[102:103]
    v_cvt_pk_bf16_f32 v97, v96, v97
    v_cvt_pk_bf16_f32 v99, v98, v99
    v_cvt_pk_bf16_f32 v101, v100, v101
    v_cvt_pk_bf16_f32 v103, v102, v103
    v_lshlrev_b32 v96, 16, v97
    v_and_b32 v97, 0xffff0000, v97
    v_lshlrev_b32 v98, 16, v99
    v_and_b32 v99, 0xffff0000, v99
    v_lshlrev_b32 v100, 16, v101
    v_and_b32 v101, 0xffff0000, v101
    v_lshlrev_b32 v102, 16, v103
    v_and_b32 v103, 0xffff0000, v103
    v_pk_fma_f32 v[54:55], v[96:97], v[72:73], v[54:55] op_sel:[0,0,0] op_sel_hi:[1,0,1]
    v_pk_fma_f32 v[54:55], v[98:99], v[72:73], v[54:55] op_sel:[0,1,0] op_sel_hi:[1,1,1]
    v_pk_fma_f32 v[54:55], v[100:101], v[74:75], v[54:55] op_sel:[0,0,0] op_sel_hi:[1,0,1]
    v_pk_fma_f32 v[54:55], v[102:103], v[74:75], v[54:55] op_sel:[0,1,0] op_sel_hi:[1,1,1]
    s_waitcnt lgkmcnt(0)
    ds_read_b128 v[64:67], v58 offset:1024
    ds_read_b128 v[68:71], v58 offset:1040
    ds_read_b128 v[72:75], v59 offset:512
    v_add_u32 v58, 1024, v58
    v_add_u32 v59, 512, v59
    v_pk_mul_f32 v[88:89], v[52:53], v[76:77] op_sel:[0,0] op_sel_hi:[1,0]
    v_pk_mul_f32 v[90:91], v[52:53], v[78:79] op_sel:[0,0] op_sel_hi:[1,0]
    v_pk_mul_f32 v[92:93], v[52:53], v[80:81] op_sel:[0,0] op_sel_hi:[1,0]
    v_pk_mul_f32 v[94:95], v[52:53], v[82:83] op_sel:[0,0] op_sel_hi:[1,0]
    v_cvt_pk_bf16_f32 v89, v88, v89
    v_cvt_pk_bf16_f32 v91, v90, v91
    v_cvt_pk_bf16_f32 v93, v92, v93
    v_cvt_pk_bf16_f32 v95, v94, v95
    v_lshlrev_b32 v88, 16, v89
    v_and_b32 v89, 0xffff0000, v89
    v_lshlrev_b32 v90, 16, v91
    v_and_b32 v91, 0xffff0000, v91
    v_lshlrev_b32 v92, 16, v93
    v_and_b32 v93, 0xffff0000, v93
    v_lshlrev_b32 v94, 16, v95
    v_and_b32 v95, 0xffff0000, v95
    v_pk_add_f32 v[88:89], v[88:89], v[76:77] op_sel:[0,1] op_sel_hi:[1,1]
    v_pk_add_f32 v[90:91], v[90:91], v[78:79] op_sel:[0,1] op_sel_hi:[1,1]
    v_pk_add_f32 v[92:93], v[92:93], v[80:81] op_sel:[0,1] op_sel_hi:[1,1]
    v_pk_add_f32 v[94:95], v[94:95], v[82:83] op_sel:[0,1] op_sel_hi:[1,1]
    v_cvt_pk_bf16_f32 v89, v88, v89
    v_cvt_pk_bf16_f32 v91, v90, v91
    v_cvt_pk_bf16_f32 v93, v92, v93
    v_cvt_pk_bf16_f32 v95, v94, v95
    v_lshlrev_b32 v88, 16, v89
    v_and_b32 v89, 0xffff0000, v89
    v_lshlrev_b32 v90, 16, v91
    v_and_b32 v91, 0xffff0000, v91
    v_lshlrev_b32 v92, 16, v93
    v_and_b32 v93, 0xffff0000, v93
    v_lshlrev_b32 v94, 16, v95
    v_and_b32 v95, 0xffff0000, v95
    v_pk_mul_f32 v[96:97], v[88:89], v[88:89]
    v_pk_mul_f32 v[98:99], v[90:91], v[90:91]
    v_pk_mul_f32 v[100:101], v[92:93], v[92:93]
    v_pk_mul_f32 v[102:103], v[94:95], v[94:95]
    v_pk_fma_f32 v[96:97], v[96:97], s[76:77], v[56:57] op_sel:[0,0,0] op_sel_hi:[1,1,0]
    v_pk_fma_f32 v[98:99], v[98:99], s[76:77], v[56:57] op_sel:[0,0,0] op_sel_hi:[1,1,0]
    v_pk_fma_f32 v[100:101], v[100:101], s[76:77], v[56:57] op_sel:[0,0,0] op_sel_hi:[1,1,0]
    v_pk_fma_f32 v[102:103], v[102:103], s[76:77], v[56:57] op_sel:[0,0,0] op_sel_hi:[1,1,0]
    v_pk_mul_f32 v[96:97], v[88:89], v[96:97]
    v_pk_mul_f32 v[98:99], v[90:91], v[98:99]
    v_pk_mul_f32 v[100:101], v[92:93], v[100:101]
    v_pk_mul_f32 v[102:103], v[94:95], v[102:103]
    v_exp_f32 v96, v96
    v_exp_f32 v97, v97
    v_exp_f32 v98, v98
    v_exp_f32 v99, v99
    v_exp_f32 v100, v100
    v_exp_f32 v101, v101
    v_exp_f32 v102, v102
    v_exp_f32 v103, v103
    v_pk_add_f32 v[96:97], v[96:97], 1.0 op_sel_hi:[1,0]
    v_pk_add_f32 v[98:99], v[98:99], 1.0 op_sel_hi:[1,0]
    v_pk_add_f32 v[100:101], v[100:101], 1.0 op_sel_hi:[1,0]
    v_pk_add_f32 v[102:103], v[102:103], 1.0 op_sel_hi:[1,0]
    v_rcp_f32 v96, v96
    v_rcp_f32 v97, v97
    v_rcp_f32 v98, v98
    v_rcp_f32 v99, v99
    v_rcp_f32 v100, v100
    v_rcp_f32 v101, v101
    v_rcp_f32 v102, v102
    v_rcp_f32 v103, v103
    v_pk_mul_f32 v[96:97], v[88:89], v[96:97]
    v_pk_mul_f32 v[98:99], v[90:91], v[98:99]
    v_pk_mul_f32 v[100:101], v[92:93], v[100:101]
    v_pk_mul_f32 v[102:103], v[94:95], v[102:103]
    v_cvt_pk_bf16_f32 v97, v96, v97
    v_cvt_pk_bf16_f32 v99, v98, v99
    v_cvt_pk_bf16_f32 v101, v100, v101
    v_cvt_pk_bf16_f32 v103, v102, v103
    v_lshlrev_b32 v96, 16, v97
    v_and_b32 v97, 0xffff0000, v97
    v_lshlrev_b32 v98, 16, v99
    v_and_b32 v99, 0xffff0000, v99
    v_lshlrev_b32 v100, 16, v101
    v_and_b32 v101, 0xffff0000, v101
    v_lshlrev_b32 v102, 16, v103
    v_and_b32 v103, 0xffff0000, v103
    v_pk_fma_f32 v[54:55], v[96:97], v[84:85], v[54:55] op_sel:[0,0,0] op_sel_hi:[1,0,1]
    v_pk_fma_f32 v[54:55], v[98:99], v[84:85], v[54:55] op_sel:[0,1,0] op_sel_hi:[1,1,1]
    v_pk_fma_f32 v[54:55], v[100:101], v[86:87], v[54:55] op_sel:[0,0,0] op_sel_hi:[1,0,1]
    v_pk_fma_f32 v[54:55], v[102:103], v[86:87], v[54:55] op_sel:[0,1,0] op_sel_hi:[1,1,1]
    s_sub_u32 s94, s94, 1
    s_cmp_lg_u32 s94, 0
    s_cbranch_scc1 TBL_loop
    s_waitcnt lgkmcnt(0)
    s_setpc_b64 s[60:61]
TINI:
    v_mov_b32 v56, 0xc0135761
    s_lshl_b32 s3, s2, 2
    s_add_u32 s3, s3, s52
    s_cmp_ge_u32 s3, 480
    s_cselect_b32 s95, 1, 0
    s_mul_i32 s97, s95, 480
    s_sub_u32 s3, s3, s97
    s_lshl_b32 s95, s95, 31
    s_lshl_b32 s3, s3, 3
    v_and_b32 v52, 3, v1
    v_lshl_add_u32 v52, v52, 1, s3
    v_add_u32 v52, 13056, v52
    v_lshl_or_b32 v52, v52, 16, s95
    v_add_u32 v53, 0x10000, v52
    v_cmp_eq_u32 vcc, 0xc1ff0000, v53
    s_nop 1
    v_cndmask_b32 v53, v53, 0, vcc
TINP:
    v_mov_b32 v56, 0xc0135761
    v_mov_b32 v54, 0
    v_mov_b32 v55, 0
    v_lshrrev_b32 v59, 2, v1
    v_lshlrev_b32 v58, 5, v59
    v_add_u32 v58, 124928, v58
    v_lshlrev_b32 v59, 4, v59
    v_add_u32 v59, 139264, v59
    s_setpc_b64 s[60:61]
TFIN:
    s_nop 1
    v_add_f32_dpp v54, v54, v54 row_ror:8 row_mask:0xf bank_mask:0xf
    s_nop 1
    v_add_f32_dpp v54, v54, v54 row_ror:4 row_mask:0xf bank_mask:0xf
    v_mov_b32 v24, v54
    s_nop 1
    v_permlane16_swap_b32 v54, v24
    s_nop 0
    v_add_f32 v54, v54, v24
    v_mov_b32 v24, v54
    s_nop 1
    v_permlane32_swap_b32 v54, v24
    s_nop 0
    v_add_f32 v54, v54, v24
    s_nop 1
    v_add_f32_dpp v55, v55, v55 row_ror:8 row_mask:0xf bank_mask:0xf
    s_nop 1
    v_add_f32_dpp v55, v55, v55 row_ror:4 row_mask:0xf bank_mask:0xf
    v_mov_b32 v24, v55
    s_nop 1
    v_permlane16_swap_b32 v55, v24
    s_nop 0
    v_add_f32 v55, v55, v24
    v_mov_b32 v24, v55
    s_nop 1
    v_permlane32_swap_b32 v55, v24
    s_nop 0
    v_add_f32 v55, v55, v24
    v_cvt_pk_bf16_f32 v54, v54, v54
    v_and_b32 v54, 0xffff0000, v54
    v_add_f32 v54, s78, v54
    v_cvt_pk_bf16_f32 v55, v55, v55
    v_and_b32 v55, 0xffff0000, v55
    v_add_f32 v55, s78, v55
    v_cvt_pk_bf16_f32 v54, v54, v55
    v_and_b32 v24, 0xffff, v54
    v_lshrrev_b32 v54, 16, v54
    v_min_u32 v24, 0xfffe, v24
    v_min_u32 v54, 0xfffe, v54
    v_lshl_or_b32 v24, v54, 16, v24
    s_nop 0
    s_setpc_b64 s[60:61]
QG:
    ds_read_b128 v[96:99], v40 offset:0
    ds_read_b128 v[100:103], v40 offset:16
    ds_read_b128 v[104:107], v40 offset:32
    ds_read_b128 v[108:111], v40 offset:48
    ds_read_b128 v[112:115], v40 offset:64
    ds_read_b128 v[116:119], v40 offset:80
    ds_read_b128 v[120:123], v40 offset:96
    s_waitcnt lgkmcnt(6)
    v_and_b32 v32, v96, v4
    v_and_b32 v33, v96, v5
    v_and_b32 v34, v96, v6
    v_and_b32 v35, v96, v7
    v_and_b32 v36, v97, v4
    v_and_b32 v37, v97, v5
    v_and_b32 v38, v97, v6
    v_and_b32 v39, v97, v7
    v_mfma_f32_16x16x32_bf16 v[8:11], v[32:35], a[0:3], 0
    v_mfma_f32_16x16x32_bf16 v[12:15], v[32:35], a[4:7], 0
    v_and_b32 v32, v98, v4
    v_and_b32 v33, v98, v5
    v_and_b32 v34, v98, v6
    v_and_b32 v35, v98, v7
    v_mfma_f32_16x16x32_bf16 v[8:11], v[36:39], a[8:11], v[8:11]
    v_mfma_f32_16x16x32_bf16 v[12:15], v[36:39], a[12:15], v[12:15]
    v_and_b32 v36, v99, v4
    v_and_b32 v37, v99, v5
    v_and_b32 v38, v99, v6
    v_and_b32 v39, v99, v7
    v_mfma_f32_16x16x32_bf16 v[8:11], v[32:35], a[16:19], v[8:11]
    v_mfma_f32_16x16x32_bf16 v[12:15], v[32:35], a[20:23], v[12:15]
    s_waitcnt lgkmcnt(5)
    v_and_b32 v32, v100, v4
    v_and_b32 v33, v100, v5
    v_and_b32 v34, v100, v6
    v_and_b32 v35, v100, v7
    v_mfma_f32_16x16x32_bf16 v[8:11], v[36:39], a[24:27], v[8:11]
    v_mfma_f32_16x16x32_bf16 v[12:15], v[36:39], a[28:31], v[12:15]
    v_and_b32 v36, v101, v4
    v_and_b32 v37, v101, v5
    v_and_b32 v38, v101, v6
    v_and_b32 v39, v101, v7
    v_mfma_f32_16x16x32_bf16 v[8:11], v[32:35], a[32:35], v[8:11]
    v_mfma_f32_16x16x32_bf16 v[12:15], v[32:35], a[36:39], v[12:15]
    v_and_b32 v32, v102, v4
    v_and_b32 v33, v102, v5
    v_and_b32 v34, v102, v6
    v_and_b32 v35, v102, v7
    v_mfma_f32_16x16x32_bf16 v[8:11], v[36:39], a[40:43], v[8:11]
    v_mfma_f32_16x16x32_bf16 v[12:15], v[36:39], a[44:47], v[12:15]
    v_and_b32 v36, v103, v4
    v_and_b32 v37, v103, v5
    v_and_b32 v38, v103, v6
    v_and_b32 v39, v103, v7
    v_mfma_f32_16x16x32_bf16 v[8:11], v[32:35], a[48:51], v[8:11]
    v_mfma_f32_16x16x32_bf16 v[12:15], v[32:35], a[52:55], v[12:15]
    s_waitcnt lgkmcnt(4)
    v_and_b32 v32, v104, v4
    v_and_b32 v33, v104, v5
    v_and_b32 v34, v104, v6
    v_and_b32 v35, v104, v7
    v_mfma_f32_16x16x32_bf16 v[8:11], v[36:39], a[56:59], v[8:11]
    v_mfma_f32_16x16x32_bf16 v[12:15], v[36:39], a[60:63], v[12:15]
    v_and_b32 v36, v105, v4
    v_and_b32 v37, v105, v5
    v_and_b32 v38, v105, v6
    v_and_b32 v39, v105, v7
    v_mfma_f32_16x16x32_bf16 v[8:11], v[32:35], a[64:67], v[8:11]
    v_mfma_f32_16x16x32_bf16 v[12:15], v[32:35], a[68:71], v[12:15]
    v_and_b32 v32, v106, v4
    v_and_b32 v33, v106, v5
    v_and_b32 v34, v106, v6
    v_and_b32 v35, v106, v7
    v_mfma_f32_16x16x32_bf16 v[8:11], v[36:39], a[72:75], v[8:11]
    v_mfma_f32_16x16x32_bf16 v[12:15], v[36:39], a[76:79], v[12:15]
    v_and_b32 v36, v107, v4
    v_and_b32 v37, v107, v5
    v_and_b32 v38, v107, v6
    v_and_b32 v39, v107, v7
    v_mfma_f32_16x16x32_bf16 v[8:11], v[32:35], a[80:83], v[8:11]
    v_mfma_f32_16x16x32_bf16 v[12:15], v[32:35], a[84:87], v[12:15]
    s_waitcnt lgkmcnt(3)
    v_and_b32 v32, v108, v4
    v_and_b32 v33, v108, v5
    v_and_b32 v34, v108, v6
    v_and_b32 v35, v108, v7
    v_mfma_f32_16x16x32_bf16 v[8:11], v[36:39], a[88:91], v[8:11]
    v_mfma_f32_16x16x32_bf16 v[12:15], v[36:39], a[92:95], v[12:15]
    v_and_b32 v36, v109, v4
    v_and_b32 v37, v109, v5
    v_and_b32 v38, v109, v6
    v_and_b32 v39, v109, v7
    v_mfma_f32_16x16x32_bf16 v[8:11], v[32:35], a[96:99], v[8:11]
    v_mfma_f32_16x16x32_bf16 v[12:15], v[32:35], a[100:103], v[12:15]
    v_and_b32 v32, v110, v4
    v_and_b32 v33, v110, v5
    v_and_b32 v34, v110, v6
    v_and_b32 v35, v110, v7
    v_mfma_f32_16x16x32_bf16 v[8:11], v[36:39], a[104:107], v[8:11]
    v_mfma_f32_16x16x32_bf16 v[12:15], v[36:39], a[108:111], v[12:15]
    v_and_b32 v36, v111, v4
    v_and_b32 v37, v111, v5
    v_and_b32 v38, v111, v6
    v_and_b32 v39, v111, v7
    v_mfma_f32_16x16x32_bf16 v[8:11], v[32:35], a[112:115], v[8:11]
    v_mfma_f32_16x16x32_bf16 v[12:15], v[32:35], a[116:119], v[12:15]
    s_waitcnt lgkmcnt(2)
    v_and_b32 v32, v112, v4
    v_and_b32 v33, v112, v5
    v_and_b32 v34, v112, v6
    v_and_b32 v35, v112, v7
    v_mfma_f32_16x16x32_bf16 v[8:11], v[36:39], a[120:123], v[8:11]
    v_mfma_f32_16x16x32_bf16 v[12:15], v[36:39], a[124:127], v[12:15]
    v_and_b32 v36, v113, v4
    v_and_b32 v37, v113, v5
    v_and_b32 v38, v113, v6
    v_and_b32 v39, v113, v7
    v_mfma_f32_16x16x32_bf16 v[8:11], v[32:35], a[128:131], v[8:11]
    v_mfma_f32_16x16x32_bf16 v[12:15], v[32:35], a[132:135], v[12:15]
    v_and_b32 v32, v114, v4
    v_and_b32 v33, v114, v5
    v_and_b32 v34, v114, v6
    v_and_b32 v35, v114, v7
    v_mfma_f32_16x16x32_bf16 v[8:11], v[36:39], a[136:139], v[8:11]
    v_mfma_f32_16x16x32_bf16 v[12:15], v[36:39], a[140:143], v[12:15]
    v_and_b32 v36, v115, v4
    v_and_b32 v37, v115, v5
    v_and_b32 v38, v115, v6
    v_and_b32 v39, v115, v7
    v_mfma_f32_16x16x32_bf16 v[8:11], v[32:35], a[144:147], v[8:11]
    v_mfma_f32_16x16x32_bf16 v[12:15], v[32:35], a[148:151], v[12:15]
    s_waitcnt lgkmcnt(1)
    v_and_b32 v32, v116, v4
    v_and_b32 v33, v116, v5
    v_and_b32 v34, v116, v6
    v_and_b32 v35, v116, v7
    v_mfma_f32_16x16x32_bf16 v[8:11], v[36:39], a[152:155], v[8:11]
    v_mfma_f32_16x16x32_bf16 v[12:15], v[36:39], a[156:159], v[12:15]
    v_and_b32 v36, v117, v4
    v_and_b32 v37, v117, v5
    v_and_b32 v38, v117, v6
    v_and_b32 v39, v117, v7
    v_mfma_f32_16x16x32_bf16 v[8:11], v[32:35], a[160:163], v[8:11]
    v_mfma_f32_16x16x32_bf16 v[12:15], v[32:35], a[164:167], v[12:15]
    v_and_b32 v32, v118, v4
    v_and_b32 v33, v118, v5
    v_and_b32 v34, v118, v6
    v_and_b32 v35, v118, v7
    v_mfma_f32_16x16x32_bf16 v[8:11], v[36:39], a[168:171], v[8:11]
    v_mfma_f32_16x16x32_bf16 v[12:15], v[36:39], a[172:175], v[12:15]
    v_and_b32 v36, v119, v4
    v_and_b32 v37, v119, v5
    v_and_b32 v38, v119, v6
    v_and_b32 v39, v119, v7
    v_mfma_f32_16x16x32_bf16 v[8:11], v[32:35], a[176:179], v[8:11]
    v_mfma_f32_16x16x32_bf16 v[12:15], v[32:35], a[180:183], v[12:15]
    s_waitcnt lgkmcnt(0)
    v_and_b32 v32, v120, v4
    v_and_b32 v33, v120, v5
    v_and_b32 v34, v120, v6
    v_and_b32 v35, v120, v7
    v_mfma_f32_16x16x32_bf16 v[8:11], v[36:39], a[184:187], v[8:11]
    v_mfma_f32_16x16x32_bf16 v[12:15], v[36:39], a[188:191], v[12:15]
    v_and_b32 v36, v121, v4
    v_and_b32 v37, v121, v5
    v_and_b32 v38, v121, v6
    v_and_b32 v39, v121, v7
    v_mfma_f32_16x16x32_bf16 v[8:11], v[32:35], a[192:195], v[8:11]
    v_mfma_f32_16x16x32_bf16 v[12:15], v[32:35], a[196:199], v[12:15]
    v_and_b32 v32, v122, v4
    v_and_b32 v33, v122, v5
    v_and_b32 v34, v122, v6
    v_and_b32 v35, v122, v7
    v_mfma_f32_16x16x32_bf16 v[8:11], v[36:39], a[200:203], v[8:11]
    v_mfma_f32_16x16x32_bf16 v[12:15], v[36:39], a[204:207], v[12:15]
    v_and_b32 v36, v123, v4
    v_and_b32 v37, v123, v5
    v_and_b32 v38, v123, v6
    v_and_b32 v39, v123, v7
    v_mfma_f32_16x16x32_bf16 v[8:11], v[32:35], a[208:211], v[8:11]
    v_mfma_f32_16x16x32_bf16 v[12:15], v[32:35], a[212:215], v[12:15]
    s_nop 1
    v_mfma_f32_16x16x32_bf16 v[8:11], v[36:39], a[216:219], v[8:11]
    v_mfma_f32_16x16x32_bf16 v[12:15], v[36:39], a[220:223], v[12:15]
    v_and_b32 v16, 15, v1
    v_lshlrev_b32 v16, 5, v16
    v_and_b32 v17, 16, v1
    v_add_u32 v16, v16, v17
    v_and_b32 v17, 32, v1
    v_lshl_add_u32 v16, v17, 5, v16
    s_lshl_b32 s94, s52, 11
    s_add_u32 s94, s94, 131072
    v_add_u32 v16, s94, v16
    v_lshlrev_b32 v17, 3, v0
    v_add_u32 v17, 131072, v17
    ds_write_b128 v16, v[8:11] offset:0
    ds_write_b128 v16, v[12:15] offset:512
    v_lshlrev_b32 v18, 2, v1
    v_and_b32 v19, 3, v1
    v_cmp_eq_u32 vcc, 0, v19
    v_mov_b32 v61, 0x40000000
    s_nop 0
    v_cndmask_b32 v18, v61, v18, vcc
    s_and_b32 s94, s52, 1
    s_lshl_b32 s94, s94, 8
    s_cmp_ge_u32 s52, 2
    s_cselect_b32 s95, s97, s96
    s_add_u32 s95, s95, s94
    s_waitcnt lgkmcnt(0)
    s_barrier
    ds_read_b64 v[24:25], v17 offset:0
    ds_read_b64 v[26:27], v17 offset:2048
    ds_read_b64 v[28:29], v17 offset:4096
    ds_read_b64 v[30:31], v17 offset:6144
    s_waitcnt lgkmcnt(0)
    v_pk_add_f32 v[24:25], v[24:25], v[26:27]
    v_pk_add_f32 v[28:29], v[28:29], v[30:31]
    v_pk_add_f32 v[24:25], v[24:25], v[28:29]
    v_cvt_pk_bf16_f32 v24, v24, v25
    v_min_u32 v24, -2, v24
    s_nop 1
    v_mov_b32_dpp v25, v24 quad_perm:[1,1,1,1] row_mask:0xf bank_mask:0xf
    v_mov_b32_dpp v26, v24 quad_perm:[2,2,2,2] row_mask:0xf bank_mask:0xf
    v_mov_b32_dpp v27, v24 quad_perm:[3,3,3,3] row_mask:0xf bank_mask:0xf
    buffer_store_dwordx4 v[24:27], v18, s[12:15], s95 offen sc1
    s_barrier
    s_setpc_b64 s[60:61]
SCL:
    v_mov_b32 v32, -1
    v_mov_b32 v33, -1
    v_mov_b32 v34, -1
    v_mov_b32 v35, -1
    s_lshl_b32 s94, s94, 4
    s_add_u32 s94, s94, s83
    s_lshl_b32 s95, s94, 14
    s_lshl_b32 s96, s52, 12
    s_add_u32 s95, s95, s96
    v_lshlrev_b32 v36, 4, v1
    buffer_store_dwordx4 v[32:35], v36, s[12:15], s95 offen offset:0 sc1
    buffer_store_dwordx4 v[32:35], v36, s[12:15], s95 offen offset:1024 sc1
    buffer_store_dwordx4 v[32:35], v36, s[12:15], s95 offen offset:2048 sc1
    buffer_store_dwordx4 v[32:35], v36, s[12:15], s95 offen offset:3072 sc1
    s_lshl_b32 s94, s94, 12
    s_lshl_b32 s96, s52, 10
    s_add_u32 s94, s94, s96
    s_add_u32 s94, s94, 0x500000
    buffer_store_dwordx4 v[32:35], v36, s[12:15], s94 offen sc1
    s_nop 0
    s_setpc_b64 s[60:61]
COMB:
    s_lshl_b32 s94, s87, 4
    s_add_u32 s94, s94, s83
    s_lshl_b32 s56, s94, 14
    s_lshr_b32 s95, s52, 1
    s_lshl_b32 s96, s95, 8
    s_add_u32 s56, s56, s96
    s_lshl_b32 s57, s94, 12
    s_add_u32 s57, s57, 0x500000
    v_lshrrev_b32 v40, 4, v1
    v_lshlrev_b32 v41, 5, v40
    v_lshlrev_b32 v40, 12, v40
    v_and_b32 v42, 15, v1
    v_lshl_add_u32 v40, v42, 4, v40
    v_mov_b32 v39, v40
    v_cmp_gt_u32 vcc, 48, v1
    v_mov_b32 v61, 0x40000000
    s_nop 0
    v_cndmask_b32 v39, v61, v39, vcc
    v_lshlrev_b32 v17, 5, v42
    v_and_b32 v18, 16, v1
    v_add_u32 v17, v17, v18
    s_lshl_b32 s95, s95, 9
    v_add_u32 v17, s95, v17
    v_and_b32 v43, 31, v1
    v_lshlrev_b32 v42, 7, v43
    v_cmp_gt_u32 vcc, 30, v43
    v_mov_b32 v61, 0x40000000
    s_nop 0
    v_cndmask_b32 v42, v61, v42, vcc
    s_lshl_b32 s94, s52, 7
    s_add_u32 s94, s94, 118784
    v_add_u32 v41, s94, v41
    v_lshl_add_u32 v38, v43, 2, s94
    v_add_u32 v18, 122880, v17
    s_and_b32 s95, s52, 1
    s_lshl_b32 s95, s95, 10
    v_add_u32 v18, s95, v18
Lretry_119:
    buffer_load_dwordx2 v[2:3], v42, s[12:15], s57 offen sc1
    buffer_load_dwordx4 v[64:67], v40, s[12:15], s56 offen offset:0 sc1
    buffer_load_dwordx4 v[68:71], v40, s[12:15], s56 offen offset:512 sc1
    buffer_load_dwordx4 v[72:75], v40, s[12:15], s56 offen offset:1024 sc1
    buffer_load_dwordx4 v[76:79], v40, s[12:15], s56 offen offset:1536 sc1
    buffer_load_dwordx4 v[80:83], v40, s[12:15], s56 offen offset:2048 sc1
    buffer_load_dwordx4 v[84:87], v40, s[12:15], s56 offen offset:2560 sc1
    buffer_load_dwordx4 v[88:91], v39, s[12:15], s56 offen offset:3072 sc1
    buffer_load_dwordx4 v[92:95], v39, s[12:15], s56 offen offset:3584 sc1
    s_waitcnt vmcnt(0)
    v_max_u32 v61, v2, v3
    v_max3_u32 v61, v61, v64, v65
    v_max3_u32 v61, v61, v66, v67
    v_max3_u32 v61, v61, v68, v69
    v_max3_u32 v61, v61, v70, v71
    v_max3_u32 v61, v61, v72, v73
    v_max3_u32 v61, v61, v74, v75
    v_max3_u32 v61, v61, v76, v77
    v_max3_u32 v61, v61, v78, v79
    v_max3_u32 v61, v61, v80, v81
    v_max3_u32 v61, v61, v82, v83
    v_max3_u32 v61, v61, v84, v85
    v_max3_u32 v61, v61, v86, v87
    v_max3_u32 v61, v61, v88, v89
    v_max3_u32 v61, v61, v90, v91
    v_max3_u32 v61, v61, v92, v93
    v_max3_u32 v61, v61, v94, v95
    v_cmp_eq_u32 vcc, -1, v61
    s_cbranch_vccz Lok_118
    s_sub_u32 s93, s93, 1
    s_cbranch_scc1 L_end
    s_branch Lretry_119
Lok_118:
    v_cmp_gt_u32 vcc, 30, v43
    v_mov_b32 v13, 0xff61b1e6
    s_nop 0
    v_cndmask_b32 v8, v13, v2, vcc
    v_mov_b32 v12, v8
    s_nop 1
    v_max_f32_dpp v12, v12, v12 row_ror:8 row_mask:0xf bank_mask:0xf
    s_nop 1
    v_max_f32_dpp v12, v12, v12 row_ror:4 row_mask:0xf bank_mask:0xf
    s_nop 1
    v_max_f32_dpp v12, v12, v12 row_ror:2 row_mask:0xf bank_mask:0xf
    s_nop 1
    v_max_f32_dpp v12, v12, v12 row_ror:1 row_mask:0xf bank_mask:0xf
    v_mov_b32 v13, v12
    s_nop 1
    v_permlane16_swap_b32 v12, v13
    s_nop 0
    v_max_f32 v12, v12, v13
    v_sub_f32 v8, v8, v12
    v_exp_f32 v8, v8
    s_nop 0
    v_cvt_pk_bf16_f32 v24, v8, v8
    ds_write_b32 v38, v24
    v_mul_f32 v12, v8, v3
    s_waitcnt lgkmcnt(0)
    ds_read_b128 v[20:23], v41
    ds_read_b128 v[24:27], v41 offset:16
    s_nop 1
    v_add_f32_dpp v12, v12, v12 row_ror:8 row_mask:0xf bank_mask:0xf
    s_nop 1
    v_add_f32_dpp v12, v12, v12 row_ror:4 row_mask:0xf bank_mask:0xf
    s_nop 1
    v_add_f32_dpp v12, v12, v12 row_ror:2 row_mask:0xf bank_mask:0xf
    s_nop 1
    v_add_f32_dpp v12, v12, v12 row_ror:1 row_mask:0xf bank_mask:0xf
    v_mov_b32 v13, v12
    s_nop 1
    v_permlane16_swap_b32 v12, v13
    s_nop 0
    v_add_f32 v12, v12, v13
    v_rcp_f32 v12, v12
    s_waitcnt lgkmcnt(0)
    v_and_b32 v28, v20, v4
    v_and_b32 v29, v20, v5
    v_and_b32 v30, v20, v6
    v_and_b32 v31, v20, v7
    v_and_b32 v32, v21, v4
    v_and_b32 v33, v21, v5
    v_and_b32 v34, v21, v6
    v_and_b32 v35, v21, v7
    v_mfma_f32_16x16x32_bf16 v[8:11], v[28:31], v[64:67], 0
    v_and_b32 v28, v22, v4
    v_and_b32 v29, v22, v5
    v_and_b32 v30, v22, v6
    v_and_b32 v31, v22, v7
    v_mfma_f32_16x16x32_bf16 v[8:11], v[32:35], v[68:71], v[8:11]
    v_and_b32 v32, v23, v4
    v_and_b32 v33, v23, v5
    v_and_b32 v34, v23, v6
    v_and_b32 v35, v23, v7
    v_mfma_f32_16x16x32_bf16 v[8:11], v[28:31], v[72:75], v[8:11]
    v_and_b32 v28, v24, v4
    v_and_b32 v29, v24, v5
    v_and_b32 v30, v24, v6
    v_and_b32 v31, v24, v7
    v_mfma_f32_16x16x32_bf16 v[8:11], v[32:35], v[76:79], v[8:11]
    v_and_b32 v32, v25, v4
    v_and_b32 v33, v25, v5
    v_and_b32 v34, v25, v6
    v_and_b32 v35, v25, v7
    v_mfma_f32_16x16x32_bf16 v[8:11], v[28:31], v[80:83], v[8:11]
    v_and_b32 v28, v26, v4
    v_and_b32 v29, v26, v5
    v_and_b32 v30, v26, v6
    v_and_b32 v31, v26, v7
    v_mfma_f32_16x16x32_bf16 v[8:11], v[32:35], v[84:87], v[8:11]
    v_and_b32 v32, v27, v4
    v_and_b32 v33, v27, v5
    v_and_b32 v34, v27, v6
    v_and_b32 v35, v27, v7
    v_mfma_f32_16x16x32_bf16 v[8:11], v[28:31], v[88:91], v[8:11]
    s_nop 1
    v_mfma_f32_16x16x32_bf16 v[8:11], v[32:35], v[92:95], v[8:11]
    s_nop 7
    v_mul_f32 v8, v8, v12
    v_mul_f32 v9, v9, v12
    v_mul_f32 v10, v10, v12
    v_mul_f32 v11, v11, v12
    v_cvt_pk_bf16_f32 v8, v8, v8
    v_cvt_pk_bf16_f32 v9, v9, v9
    v_cvt_pk_bf16_f32 v10, v10, v10
    v_cvt_pk_bf16_f32 v11, v11, v11
    ds_write_b128 v18, v[8:11]
    s_setpc_b64 s[60:61]
WOG:
    v_lshlrev_b32 v19, 4, v1
    s_mul_i32 s94, s52, 24576
    v_add_u32 v19, s94, v19
    ds_read_b128 v[24:27], v13 offset:0
    ds_read_b128 v[28:31], v13 offset:16
    ds_read_b128 v[32:35], v13 offset:32
    ds_read_b128 v[36:39], v13 offset:48
    ds_read_b128 v[96:99], v19 offset:0
    ds_read_b128 v[100:103], v19 offset:1024
    ds_read_b128 v[104:107], v19 offset:2048
    ds_read_b128 v[108:111], v19 offset:3072
    ds_read_b128 v[112:115], v19 offset:4096
    ds_read_b128 v[116:119], v19 offset:5120
    ds_read_b128 v[120:123], v19 offset:6144
    ds_read_b128 v[124:127], v19 offset:7168
    s_waitcnt lgkmcnt(8)
    v_and_b32 v8, v24, v4
    v_and_b32 v9, v24, v5
    v_and_b32 v10, v24, v6
    v_and_b32 v11, v24, v7
    v_and_b32 v40, v25, v4
    v_and_b32 v41, v25, v5
    v_and_b32 v42, v25, v6
    v_and_b32 v43, v25, v7
    v_mfma_f32_16x16x32_bf16 v[44:47], v[8:11], a[224:227], 0
    v_mfma_f32_16x16x32_bf16 v[48:51], v[8:11], a[228:231], 0
    v_mfma_f32_16x16x32_bf16 v[52:55], v[8:11], a[232:235], 0
    v_mfma_f32_16x16x32_bf16 v[56:59], v[8:11], a[236:239], 0
    v_and_b32 v8, v26, v4
    v_and_b32 v9, v26, v5
    v_and_b32 v10, v26, v6
    v_and_b32 v11, v26, v7
    v_mfma_f32_16x16x32_bf16 v[44:47], v[40:43], a[240:243], v[44:47]
    v_mfma_f32_16x16x32_bf16 v[48:51], v[40:43], a[244:247], v[48:51]
    v_mfma_f32_16x16x32_bf16 v[52:55], v[40:43], a[248:251], v[52:55]
    v_mfma_f32_16x16x32_bf16 v[56:59], v[40:43], a[252:255], v[56:59]
    v_and_b32 v40, v34, v4
    v_and_b32 v41, v34, v5
    v_and_b32 v42, v34, v6
    v_and_b32 v43, v34, v7
    v_mfma_f32_16x16x32_bf16 v[44:47], v[8:11], v[128:131], v[44:47]
    v_mfma_f32_16x16x32_bf16 v[48:51], v[8:11], v[132:135], v[48:51]
    v_mfma_f32_16x16x32_bf16 v[52:55], v[8:11], v[136:139], v[52:55]
    v_mfma_f32_16x16x32_bf16 v[56:59], v[8:11], v[140:143], v[56:59]
    v_and_b32 v8, v35, v4
    v_and_b32 v9, v35, v5
    v_and_b32 v10, v35, v6
    v_and_b32 v11, v35, v7
    s_waitcnt lgkmcnt(0)
    v_mfma_f32_16x16x32_bf16 v[44:47], v[40:43], v[96:99], v[44:47]
    v_mfma_f32_16x16x32_bf16 v[48:51], v[40:43], v[100:103], v[48:51]
    v_mfma_f32_16x16x32_bf16 v[52:55], v[40:43], v[104:107], v[52:55]
    v_mfma_f32_16x16x32_bf16 v[56:59], v[40:43], v[108:111], v[56:59]
    v_and_b32 v40, v27, v4
    v_and_b32 v41, v27, v5
    v_and_b32 v42, v27, v6
    v_and_b32 v43, v27, v7
    v_mfma_f32_16x16x32_bf16 v[44:47], v[8:11], v[112:115], v[44:47]
    v_mfma_f32_16x16x32_bf16 v[48:51], v[8:11], v[116:119], v[48:51]
    v_mfma_f32_16x16x32_bf16 v[52:55], v[8:11], v[120:123], v[52:55]
    v_mfma_f32_16x16x32_bf16 v[56:59], v[8:11], v[124:127], v[56:59]
    v_and_b32 v8, v28, v4
    v_and_b32 v9, v28, v5
    v_and_b32 v10, v28, v6
    v_and_b32 v11, v28, v7
    v_mfma_f32_16x16x32_bf16 v[44:47], v[40:43], v[144:147], v[44:47]
    v_mfma_f32_16x16x32_bf16 v[48:51], v[40:43], v[148:151], v[48:51]
    v_mfma_f32_16x16x32_bf16 v[52:55], v[40:43], v[152:155], v[52:55]
    v_mfma_f32_16x16x32_bf16 v[56:59], v[40:43], v[156:159], v[56:59]
    ds_read_b128 v[96:99], v19 offset:8192
    ds_read_b128 v[100:103], v19 offset:9216
    ds_read_b128 v[104:107], v19 offset:10240
    ds_read_b128 v[108:111], v19 offset:11264
    ds_read_b128 v[112:115], v19 offset:12288
    ds_read_b128 v[116:119], v19 offset:13312
    ds_read_b128 v[120:123], v19 offset:14336
    ds_read_b128 v[124:127], v19 offset:15360
    v_and_b32 v40, v29, v4
    v_and_b32 v41, v29, v5
    v_and_b32 v42, v29, v6
    v_and_b32 v43, v29, v7
    v_mfma_f32_16x16x32_bf16 v[44:47], v[8:11], v[160:163], v[44:47]
    v_mfma_f32_16x16x32_bf16 v[48:51], v[8:11], v[164:167], v[48:51]
    v_mfma_f32_16x16x32_bf16 v[52:55], v[8:11], v[168:171], v[52:55]
    v_mfma_f32_16x16x32_bf16 v[56:59], v[8:11], v[172:175], v[56:59]
    v_and_b32 v8, v36, v4
    v_and_b32 v9, v36, v5
    v_and_b32 v10, v36, v6
    v_and_b32 v11, v36, v7
    v_mfma_f32_16x16x32_bf16 v[44:47], v[40:43], v[176:179], v[44:47]
    v_mfma_f32_16x16x32_bf16 v[48:51], v[40:43], v[180:183], v[48:51]
    v_mfma_f32_16x16x32_bf16 v[52:55], v[40:43], v[184:187], v[52:55]
    v_mfma_f32_16x16x32_bf16 v[56:59], v[40:43], v[188:191], v[56:59]
    v_and_b32 v40, v37, v4
    v_and_b32 v41, v37, v5
    v_and_b32 v42, v37, v6
    v_and_b32 v43, v37, v7
    s_waitcnt lgkmcnt(0)
    v_mfma_f32_16x16x32_bf16 v[44:47], v[8:11], v[96:99], v[44:47]
    v_mfma_f32_16x16x32_bf16 v[48:51], v[8:11], v[100:103], v[48:51]
    v_mfma_f32_16x16x32_bf16 v[52:55], v[8:11], v[104:107], v[52:55]
    v_mfma_f32_16x16x32_bf16 v[56:59], v[8:11], v[108:111], v[56:59]
    v_and_b32 v8, v30, v4
    v_and_b32 v9, v30, v5
    v_and_b32 v10, v30, v6
    v_and_b32 v11, v30, v7
    v_mfma_f32_16x16x32_bf16 v[44:47], v[40:43], v[112:115], v[44:47]
    v_mfma_f32_16x16x32_bf16 v[48:51], v[40:43], v[116:119], v[48:51]
    v_mfma_f32_16x16x32_bf16 v[52:55], v[40:43], v[120:123], v[52:55]
    v_mfma_f32_16x16x32_bf16 v[56:59], v[40:43], v[124:127], v[56:59]
    v_and_b32 v40, v31, v4
    v_and_b32 v41, v31, v5
    v_and_b32 v42, v31, v6
    v_and_b32 v43, v31, v7
    v_mfma_f32_16x16x32_bf16 v[44:47], v[8:11], v[192:195], v[44:47]
    v_mfma_f32_16x16x32_bf16 v[48:51], v[8:11], v[196:199], v[48:51]
    v_mfma_f32_16x16x32_bf16 v[52:55], v[8:11], v[200:203], v[52:55]
    v_mfma_f32_16x16x32_bf16 v[56:59], v[8:11], v[204:207], v[56:59]
    ds_read_b128 v[96:99], v19 offset:16384
    ds_read_b128 v[100:103], v19 offset:17408
    ds_read_b128 v[104:107], v19 offset:18432
    ds_read_b128 v[108:111], v19 offset:19456
    ds_read_b128 v[112:115], v19 offset:20480
    ds_read_b128 v[116:119], v19 offset:21504
    ds_read_b128 v[120:123], v19 offset:22528
    ds_read_b128 v[124:127], v19 offset:23552
    v_and_b32 v8, v32, v4
    v_and_b32 v9, v32, v5
    v_and_b32 v10, v32, v6
    v_and_b32 v11, v32, v7
    v_mfma_f32_16x16x32_bf16 v[44:47], v[40:43], v[208:211], v[44:47]
    v_mfma_f32_16x16x32_bf16 v[48:51], v[40:43], v[212:215], v[48:51]
    v_mfma_f32_16x16x32_bf16 v[52:55], v[40:43], v[216:219], v[52:55]
    v_mfma_f32_16x16x32_bf16 v[56:59], v[40:43], v[220:223], v[56:59]
    v_and_b32 v40, v38, v4
    v_and_b32 v41, v38, v5
    v_and_b32 v42, v38, v6
    v_and_b32 v43, v38, v7
    v_mfma_f32_16x16x32_bf16 v[44:47], v[8:11], v[224:227], v[44:47]
    v_mfma_f32_16x16x32_bf16 v[48:51], v[8:11], v[228:231], v[48:51]
    v_mfma_f32_16x16x32_bf16 v[52:55], v[8:11], v[232:235], v[52:55]
    v_mfma_f32_16x16x32_bf16 v[56:59], v[8:11], v[236:239], v[56:59]
    v_and_b32 v8, v39, v4
    v_and_b32 v9, v39, v5
    v_and_b32 v10, v39, v6
    v_and_b32 v11, v39, v7
    s_waitcnt lgkmcnt(0)
    v_mfma_f32_16x16x32_bf16 v[44:47], v[40:43], v[96:99], v[44:47]
    v_mfma_f32_16x16x32_bf16 v[48:51], v[40:43], v[100:103], v[48:51]
    v_mfma_f32_16x16x32_bf16 v[52:55], v[40:43], v[104:107], v[52:55]
    v_mfma_f32_16x16x32_bf16 v[56:59], v[40:43], v[108:111], v[56:59]
    v_and_b32 v40, v33, v4
    v_and_b32 v41, v33, v5
    v_and_b32 v42, v33, v6
    v_and_b32 v43, v33, v7
    v_mfma_f32_16x16x32_bf16 v[44:47], v[8:11], v[112:115], v[44:47]
    v_mfma_f32_16x16x32_bf16 v[48:51], v[8:11], v[116:119], v[48:51]
    v_mfma_f32_16x16x32_bf16 v[52:55], v[8:11], v[120:123], v[52:55]
    v_mfma_f32_16x16x32_bf16 v[56:59], v[8:11], v[124:127], v[56:59]
    s_nop 1
    v_mfma_f32_16x16x32_bf16 v[44:47], v[40:43], v[240:243], v[44:47]
    v_mfma_f32_16x16x32_bf16 v[48:51], v[40:43], v[244:247], v[48:51]
    v_mfma_f32_16x16x32_bf16 v[52:55], v[40:43], v[248:251], v[52:55]
    v_mfma_f32_16x16x32_bf16 v[56:59], v[40:43], v[252:255], v[56:59]
    v_and_b32 v16, 15, v1
    v_lshlrev_b32 v16, 5, v16
    v_and_b32 v17, 16, v1
    v_add_u32 v16, v16, v17
    v_and_b32 v17, 32, v1
    v_lshl_add_u32 v16, v17, 6, v16
    s_lshl_b32 s94, s52, 12
    s_add_u32 s94, s94, 131072
    v_add_u32 v16, s94, v16
    ds_write_b128 v16, v[44:47] offset:0
    ds_write_b128 v16, v[48:51] offset:512
    ds_write_b128 v16, v[52:55] offset:1024
    ds_write_b128 v16, v[56:59] offset:1536
    v_and_b32 v18, 31, v1
    v_lshlrev_b32 v18, 4, v18
    v_lshl_add_u32 v17, v17, 6, v18
    s_lshl_b32 s94, s52, 9
    s_add_u32 s95, s94, 131072
    v_add_u32 v17, s95, v17
    v_mov_b32 v20, s97
    v_mov_b32 v21, s96
    v_cndmask_b32 v20, v20, v21, s[98:99]
    v_add_u32 v18, v18, v20
    s_lshl_b32 s95, s83, 11
    s_add_u32 s94, s94, s95
    s_waitcnt lgkmcnt(0)
    s_barrier
    ds_read_b128 v[24:27], v17 offset:0
    ds_read_b128 v[28:31], v17 offset:4096
    ds_read_b128 v[32:35], v17 offset:8192
    ds_read_b128 v[36:39], v17 offset:12288
    s_waitcnt lgkmcnt(0)
    v_pk_add_f32 v[24:25], v[24:25], v[28:29]
    v_pk_add_f32 v[32:33], v[32:33], v[36:37]
    v_pk_add_f32 v[26:27], v[26:27], v[30:31]
    v_pk_add_f32 v[34:35], v[34:35], v[38:39]
    v_pk_add_f32 v[24:25], v[24:25], v[32:33]
    v_pk_add_f32 v[26:27], v[26:27], v[34:35]
    buffer_store_dwordx4 v[24:27], v18, s[12:15], s94 offen sc1
    s_nop 0
    s_setpc_b64 s[60:61]
L_code_end:
.section .rodata,"a"
.p2align 6
.amdhsa_kernel interleave_layers__gqa_block_cached__mixer_token_mlp__decode_kernel
  .amdhsa_next_free_vgpr 512
  .amdhsa_next_free_sgpr 102
  .amdhsa_accum_offset 256
  .amdhsa_group_segment_fixed_size 0
  .amdhsa_kernarg_size 104
  .amdhsa_user_sgpr_count 2
  .amdhsa_user_sgpr_kernarg_segment_ptr 1
  .amdhsa_system_sgpr_workgroup_id_x 1
.end_amdhsa_kernel
```
